```python
import torch

def _softmax(x, axis=-1):
    return torch.softmax(x, dim=axis)
def _gelu(x):
    return torch.nn.functional.gelu(x, approximate="tanh")
def _silu(x):
    return torch.nn.functional.silu(x)
def _sigmoid(x):
    return torch.sigmoid(x)
def _layernorm(x, axis=-1, eps=1e-5):
    m = x.mean(dim=axis, keepdim=True)
    v = x.var(dim=axis, keepdim=True, unbiased=False)
    return (x - m) / torch.sqrt(v + eps)
def _scatter_add(tgt, idx, src, axis=0):
    return tgt.clone().index_add_(axis, idx, src)
def _segment_sum(src, seg, n):
    out = torch.zeros((n,) + src.shape[1:], dtype=src.dtype)
    return out.index_add_(0, seg, src)
def _pad(x, pw):
    flat = tuple(v for pair in reversed(pw) for v in pair)
    return torch.nn.functional.pad(x, flat)

kernel_name = 'interleave_layers__grouped_kv_mqa__dense_activation_gelu__prompt'

def setup_inputs():

    _w = (lambda a: (lambda t: t.to(torch.bfloat16) if t.is_floating_point() else t)(torch.as_tensor(a)))
    def _A_setup():
        B, S, D, H = 1, 2048, 448, 16
        Dh = D // H
        return {
            "x": _w((lambda *s: torch.randn(*s, dtype=torch.bfloat16) * 0.05)(B, S, D)),
            "wq": _w((lambda *s: torch.randn(*s, dtype=torch.bfloat16) * 0.05)(D, H * Dh)),
            "wk": _w((lambda *s: torch.randn(*s, dtype=torch.bfloat16) * 0.05)(D, Dh)),
            "wv": _w((lambda *s: torch.randn(*s, dtype=torch.bfloat16) * 0.05)(D, Dh)),
            "wo": _w((lambda *s: torch.randn(*s, dtype=torch.bfloat16) * 0.05)(H * Dh, D)),
        }
    _A_in = _A_setup()

    def _B_setup():
        B, S, D, F = 1, 2048, 448, 1792
        return {
            "x": _w((lambda *s: torch.randn(*s, dtype=torch.bfloat16) * 0.05)(B, S, D)),
            "w1": _w((lambda *s: torch.randn(*s, dtype=torch.bfloat16) * 0.8)(D, F) * (D ** -0.5)),
            "b1": _w((lambda *s: torch.randn(*s, dtype=torch.bfloat16) * 12.8)(F) * 0.01),
            "w2": _w((lambda *s: torch.randn(*s, dtype=torch.bfloat16) * 0.2)(F, D) * (F ** -0.5)),
            "b2": _w((lambda *s: torch.randn(*s, dtype=torch.bfloat16) * 1.6)(D) * 0.01),
        }
    _B_in = _B_setup()

    return {
        "A_x": _A_in["x"],
        "A_wq": _A_in["wq"],
        "A_wk": _A_in["wk"],
        "A_wv": _A_in["wv"],
        "A_wo": _A_in["wo"],
        "B_x": _B_in["x"],
        "B_w1": _B_in["w1"],
        "B_b1": _B_in["b1"],
        "B_w2": _B_in["w2"],
        "B_b2": _B_in["b2"],
    }

def reference(A_x, A_wq, A_wk, A_wv, A_wo, B_x, B_w1, B_b1, B_w2, B_b2):
    def _A_ref(x, wq, wk, wv, wo):
        B, S, D = x.shape
        H = 16
        Dh = D // H
        q = (lambda x, *d: x.permute(*d))((x @ wq).reshape(B, S, H, Dh), 0, 2, 1, 3)
        k = x @ wk
        v = x @ wv
        scores = torch.einsum("bhqd,bkd->bhqk", q, k) * (Dh ** -0.5)
        p = _softmax(scores, axis=-1)
        o = torch.einsum("bhqk,bkd->bhqd", p, v)
        return (lambda x, *d: x.permute(*d))(o, 0, 2, 1, 3).reshape(B, S, H * Dh) @ wo

    def _B_ref(x, w1, b1, w2, b2):
        h = torch.einsum("bsd,df->bsf", x, w1) + b1
        h = _gelu(h)
        return torch.einsum("bsf,fd->bsd", h, w2) + b2

    x = A_x
    x = x + _A_ref(_layernorm(x, axis=-1), A_wq, A_wk, A_wv, A_wo)
    x = x + _B_ref(_layernorm(x, axis=-1), B_w1, B_b1, B_w2, B_b2)
    x = x + _A_ref(_layernorm(x, axis=-1), A_wq, A_wk, A_wv, A_wo)
    x = x + _B_ref(_layernorm(x, axis=-1), B_w1, B_b1, B_w2, B_b2)
    return x
```

```asm
; @launch kernel=qkv1_kernel grid=(256,1,1) block=(256,1,1) lds=133120
; @launch kernel=x_kernel grid=(256,1,1) block=(256,1,1) lds=163840
.amdgcn_target "amdgcn-amd-amdhsa--gfx950"
.text
.p2align 8
.globl qkv1_kernel
.type qkv1_kernel,@function
qkv1_kernel:
    s_cmp_ge_u32 s2, 256
    s_cbranch_scc1 q1_end
    s_load_dwordx16 s[68:83], s[0:1], 0
    s_load_dwordx2 s[84:85], s[0:1], 64
    s_load_dwordx2 s[86:87], s[0:1], 96
    s_getpc_b64 s[88:89]
q1_pc0:
    v_lshlrev_b32 v152, 7, v0
    v_min_u32 v152, x_kernel-q1_pc0-4, v152
    global_load_dword v153, v152, s[88:89]
    v_lshrrev_b32 v1, 6, v0
    s_nop 0
    v_readfirstlane_b32 s8, v1
    v_and_b32 v1, 63, v0
    v_lshlrev_b32 v2, 4, v1
    v_and_b32 v3, 15, v1
    v_lshrrev_b32 v4, 4, v1
    s_and_b32 s9, s2, 7
    s_lshl_b32 s9, s9, 1
    s_lshr_b32 s10, s2, 7
    s_add_u32 s9, s9, s10
    s_bfe_u32 s10, s2, 0x40003
    s_mov_b32 s51, 6524928
    s_mov_b32 s52, 4296704
    s_lshr_b32 s53, s10, 3
    s_lshl_b32 s53, s53, 2
    s_lshl_b32 s56, s9, 3
    s_add_u32 s53, s53, s56
    s_add_u32 s53, s53, s8
    s_and_b32 s54, s10, 7
    v_lshrrev_b32 v5, 3, v1
    v_and_b32 v6, 7, v1
    v_xor_b32 v8, v6, v4
    v_xor_b32 v7, 4, v8
    v_mul_u32_u24 v9, 896, v5
    v_lshl_add_u32 v246, v8, 4, v9
    v_lshl_add_u32 v247, v7, 4, v9
    v_add_u32 v247, 7168, v247
    s_lshl_b32 s56, s8, 11
    s_add_u32 s55, s56, 57344
    s_mov_b32 s58, s56
    s_mul_i32 s50, s53, 14336
    v_bfe_u32 v7, v1, 4, 1
    v_lshlrev_b32 v7, 1, v7
    v_xor_b32 v6, v6, v7
    s_lshl_b32 s56, s8, 4
    v_add_u32 v5, s56, v5
    s_cmp_eq_u32 s54, 7
    s_cbranch_scc1 q1_akv
    v_mul_u32_u24 v9, 896, v5
    s_lshl_b32 s56, s54, 7
    v_add_u32 v9, s56, v9
    v_lshl_add_u32 v10, v6, 4, v9
    v_xor_b32 v7, 4, v6
    v_lshl_add_u32 v11, v7, 4, v9
    v_add_u32 v11, 7168, v11
    s_mov_b32 s57, 57344
    s_waitcnt lgkmcnt(0)
    v_mov_b32 v12, s70
    v_mov_b32 v13, s71
    v_mov_b32 v14, s70
    v_mov_b32 v15, s71
    s_branch q1_adone
q1_akv:
    v_and_b32 v7, 3, v6
    v_lshlrev_b32 v7, 4, v7
    v_min_u32 v7, 40, v7
    v_mad_u32_u24 v10, v5, 56, v7
    v_add_u32 v11, 448, v10
    s_mov_b32 s57, 3584
    v_cmp_gt_u32 vcc, 4, v6
    s_waitcnt lgkmcnt(0)
    v_mov_b32 v16, s72
    v_mov_b32 v17, s73
    v_mov_b32 v18, s74
    v_mov_b32 v19, s75
    v_cndmask_b32 v12, v18, v16, vcc
    v_cndmask_b32 v13, v19, v17, vcc
    v_cndmask_b32 v14, v16, v18, vcc
    v_cndmask_b32 v15, v17, v19, vcc
q1_adone:
    v_add_co_u32 v240, vcc, v12, v10
    s_nop 1
    v_addc_co_u32 v241, vcc, 0, v13, vcc
    v_add_co_u32 v242, vcc, v14, v11
    s_nop 1
    v_addc_co_u32 v243, vcc, 0, v15, vcc
    s_mov_b32 s12, s68
    s_and_b32 s13, s69, 0xffff
    s_mov_b32 s14, 1835008
    s_mov_b32 s15, 0x20000
    s_mov_b32 m0, s55
    s_add_u32 s55, s55, 8192
    buffer_load_dwordx4 v246, s[12:15], s50 offen lds
    s_add_u32 m0, m0, 1024
    s_nop 0
    buffer_load_dwordx4 v247, s[12:15], s50 offen lds
    s_mov_b32 m0, s58
    s_add_u32 s50, s50, 128
    global_load_lds_dwordx4 v[240:241], off
    s_add_u32 m0, m0, 1024
    s_add_u32 s58, s58, 8192
    global_load_lds_dwordx4 v[242:243], off
    v_add_co_u32 v240, vcc, s57, v240
    s_nop 1
    v_addc_co_u32 v241, vcc, 0, v241, vcc
    v_add_co_u32 v242, vcc, s57, v242
    s_nop 1
    v_addc_co_u32 v243, vcc, 0, v243, vcc
    s_mov_b32 m0, s55
    s_add_u32 s55, s55, 8192
    buffer_load_dwordx4 v246, s[12:15], s50 offen lds
    s_add_u32 m0, m0, 1024
    s_nop 0
    buffer_load_dwordx4 v247, s[12:15], s50 offen lds
    s_mov_b32 m0, s58
    s_add_u32 s50, s50, 128
    global_load_lds_dwordx4 v[240:241], off
    s_add_u32 m0, m0, 1024
    s_add_u32 s58, s58, 8192
    global_load_lds_dwordx4 v[242:243], off
    v_add_co_u32 v240, vcc, s57, v240
    s_nop 1
    v_addc_co_u32 v241, vcc, 0, v241, vcc
    v_add_co_u32 v242, vcc, s57, v242
    s_nop 1
    v_addc_co_u32 v243, vcc, 0, v243, vcc
    s_mov_b32 m0, s55
    s_add_u32 s55, s55, 8192
    buffer_load_dwordx4 v246, s[12:15], s50 offen lds
    s_add_u32 m0, m0, 1024
    s_nop 0
    buffer_load_dwordx4 v247, s[12:15], s50 offen lds
    s_mov_b32 m0, s58
    s_add_u32 s50, s50, 128
    global_load_lds_dwordx4 v[240:241], off
    s_add_u32 m0, m0, 1024
    s_add_u32 s58, s58, 8192
    global_load_lds_dwordx4 v[242:243], off
    v_add_co_u32 v240, vcc, s57, v240
    s_nop 1
    v_addc_co_u32 v241, vcc, 0, v241, vcc
    v_add_co_u32 v242, vcc, s57, v242
    s_nop 1
    v_addc_co_u32 v243, vcc, 0, v243, vcc
    s_mov_b32 m0, s55
    s_add_u32 s55, s55, 8192
    buffer_load_dwordx4 v246, s[12:15], s50 offen lds
    s_add_u32 m0, m0, 1024
    s_nop 0
    buffer_load_dwordx4 v247, s[12:15], s50 offen lds
    s_mov_b32 m0, s58
    s_add_u32 s50, s50, 128
    global_load_lds_dwordx4 v[240:241], off
    s_add_u32 m0, m0, 1024
    s_add_u32 s58, s58, 8192
    global_load_lds_dwordx4 v[242:243], off
    v_add_co_u32 v240, vcc, s57, v240
    s_nop 1
    v_addc_co_u32 v241, vcc, 0, v241, vcc
    v_add_co_u32 v242, vcc, s57, v242
    s_nop 1
    v_addc_co_u32 v243, vcc, 0, v243, vcc
    s_mov_b32 s4, s86
    s_and_b32 s5, s87, 0xffff
    s_mov_b32 s6, 14127104
    s_mov_b32 s7, 0x20000
    s_lshl_b32 s49, s2, 2
    s_add_u32 s49, s49, s8
    s_mov_b32 s16, s76
    s_and_b32 s17, s77, 0xffff
    s_mov_b32 s18, 401408
    s_mov_b32 s19, 0x20000
    s_mov_b32 s44, 896
    s_mov_b32 s47, 1
    s_mov_b32 s36, 0
    s_cmp_ge_u32 s49, 112
    s_cbranch_scc1 q1_p1
    s_lshr_b32 s45, s49, 4
    s_lshl_b32 s45, s45, 7
    s_and_b32 s46, s49, 15
    s_mul_i32 s46, s46, 25088
    s_add_u32 s45, s45, s46
    s_add_u32 s46, s45, 14336
    s_lshl_b32 s48, s49, 12
    s_add_u32 s48, s48, 0
    s_branch q1_pd
q1_p1:
    s_sub_u32 s49, s49, 112
    s_cmp_ge_u32 s49, 392
    s_cbranch_scc1 q1_p2
    s_mov_b32 s16, s80
    s_and_b32 s17, s81, 0xffff
    s_mov_b32 s18, 1605632
    s_mov_b32 s19, 0x20000
    s_mov_b32 s44, 3584
    s_mov_b32 s47, 2
    s_mul_i32 s48, s49, 2341
    s_lshr_b32 s48, s48, 16
    s_mul_i32 s45, s48, 28
    s_sub_u32 s49, s49, s45
    s_mul_i32 s45, s48, 114688
    s_lshl_b32 s46, s49, 7
    s_add_u32 s45, s45, s46
    s_add_u32 s46, s45, 57344
    s_mov_b32 s36, s48
    s_mov_b32 s48, 458752
    s_branch q1_pd
q1_p2:
    s_sub_u32 s49, s49, 392
    s_mov_b32 s47, 0
    s_mov_b32 s45, 0
    s_mov_b32 s46, 0
    s_mov_b32 s48, 0
    s_cmp_ge_u32 s49, 392
    s_cbranch_scc1 q1_pd
    s_mov_b32 s16, s84
    s_and_b32 s17, s85, 0xffff
    s_mov_b32 s18, 1605632
    s_mov_b32 s19, 0x20000
    s_mov_b32 s47, 3
    s_mul_i32 s48, s49, 9363
    s_lshr_b32 s48, s48, 16
    s_mul_i32 s45, s48, 7
    s_sub_u32 s49, s49, s45
    s_mul_i32 s45, s48, 147
    s_lshr_b32 s45, s45, 10
    s_mul_i32 s46, s45, 7
    s_sub_u32 s46, s48, s46
    s_mul_i32 s45, s45, 224
    s_lshl_b32 s56, s46, 5
    s_cmp_ge_u32 s46, 3
    s_cselect_b32 s59, 16, 0
    s_add_u32 s56, s56, s59
    s_cmp_eq_u32 s46, 6
    s_cselect_b32 s56, 96, s56
    s_cselect_b32 s59, 112, 16
    s_add_u32 s45, s45, s56
    s_add_u32 s46, s45, s59
    s_mul_i32 s45, s45, 896
    s_mul_i32 s46, s46, 896
    s_lshl_b32 s56, s49, 7
    s_add_u32 s45, s45, s56
    s_add_u32 s46, s46, s56
    s_mul_i32 s56, s49, 229376
    s_lshl_b32 s48, s48, 12
    s_add_u32 s48, s48, s56
    s_add_u32 s48, s48, 2068480
q1_pd:
    v_lshrrev_b32 v5, 3, v1
    v_mul_lo_u32 v5, v5, s44
    v_and_b32 v6, 7, v1
    v_lshlrev_b32 v7, 1, v4
    v_xor_b32 v6, v6, v7
    v_lshl_add_u32 v248, v6, 4, v5
    s_lshl_b32 s44, s44, 3
    v_add_u32 v249, s44, v248
    s_lshl_b32 s56, s8, 12
    s_add_u32 m0, s56, 114688
    s_nop 0
    buffer_load_dwordx4 v248, s[16:19], s45 offen lds
    s_add_u32 m0, m0, 1024
    s_nop 0
    buffer_load_dwordx4 v249, s[16:19], s45 offen lds
    s_add_u32 m0, m0, 1024
    s_nop 0
    buffer_load_dwordx4 v248, s[16:19], s46 offen lds
    s_add_u32 m0, m0, 1024
    s_nop 0
    buffer_load_dwordx4 v249, s[16:19], s46 offen lds
    v_mov_b32 v36, 0x3f803f80
    v_mov_b32 v37, 0x3f803f80
    v_mov_b32 v38, 0x3f803f80
    v_mov_b32 v39, 0x3f803f80
    s_and_b32 s60, s8, 1
    s_lshl_b32 s61, s60, 1
    s_lshr_b32 s62, s8, 1
    s_add_u32 s61, s61, s62
    v_lshrrev_b32 v5, 2, v3
    v_lshlrev_b32 v6, 7, v5
    v_lshl_add_u32 v6, v4, 10, v6
    v_and_b32 v7, 3, v1
    v_lshl_add_u32 v6, v7, 3, v6
    v_lshrrev_b32 v5, 1, v5
    v_and_b32 v7, 1, v4
    v_lshl_or_b32 v5, v7, 1, v5
    v_xor_b32 v7, s61, v5
    v_lshl_add_u32 v88, v7, 5, v6
    v_xor_b32 v89, 32, v88
    v_lshrrev_b32 v5, 1, v3
    v_xor_b32 v5, v5, v4
    v_lshlrev_b32 v5, 4, v5
    v_lshl_add_u32 v5, v3, 7, v5
    s_lshl_b32 s56, s8, 11
    s_add_u32 s56, s56, 57344
    v_add_u32 v90, s56, v5
    v_xor_b32 v91, 64, v90
    v_xor_b32 v92, 0x800, v90
    v_xor_b32 v93, 0x840, v90
    s_lshr_b32 s65, s53, 2
    s_cmp_eq_u32 s65, 0
    s_cselect_b32 s66, 0, 0x7ff00000
    v_lshl_add_u32 v95, v4, 4, s66
    s_cmp_lt_u32 s65, 14
    s_cselect_b32 s66, 0, 0x7ff00000
    v_add_u32 v94, s66, v2
    s_min_u32 s65, s65, 13
    s_lshl_b32 s65, s65, 12
    v_add_u32 v98, s65, v88
    s_mul_i32 s67, s54, 57344
    s_add_u32 s67, s67, s65
    s_lshl_b32 s65, s61, 10
    s_add_u32 s67, s67, s65
    s_add_u32 s38, s67, 3674112
    s_lshl_b32 s56, s54, 1
    s_add_u32 s56, s56, s60
    s_cmp_eq_u32 s56, 15
    s_cbranch_scc1 q1_v
    s_waitcnt vmcnt(16)
    s_barrier
    ds_read_b128 v[48:51], v90 offset:0
    ds_read_b128 v[52:55], v92 offset:0
    ds_read_b64_tr_b16 v[40:41], v88 offset:0
    ds_read_b64_tr_b16 v[42:43], v88 offset:512
    ds_read_b64_tr_b16 v[44:45], v89 offset:0
    ds_read_b64_tr_b16 v[46:47], v89 offset:512
    ds_read_b128 v[64:67], v91 offset:0
    ds_read_b128 v[68:71], v93 offset:0
    ds_read_b64_tr_b16 v[56:57], v88 offset:4096
    ds_read_b64_tr_b16 v[58:59], v88 offset:4608
    ds_read_b64_tr_b16 v[60:61], v89 offset:4096
    ds_read_b64_tr_b16 v[62:63], v89 offset:4608
    s_waitcnt vmcnt(12)
    s_barrier
    s_waitcnt lgkmcnt(11)
    v_mfma_f32_16x16x32_bf16 v[24:27], v[36:39], v[48:51], 0
    ds_read_b128 v[80:83], v90 offset:8192
    v_mfma_f32_16x16x32_bf16 v[28:31], v[48:51], v[48:51], 0
    ds_read_b128 v[84:87], v92 offset:8192
    s_waitcnt lgkmcnt(10)
    v_mfma_f32_16x16x32_bf16 v[8:11], v[40:43], v[48:51], 0
    ds_read_b64_tr_b16 v[72:73], v88 offset:8192
    s_mov_b32 m0, s55
    s_add_u32 s55, s55, 8192
    buffer_load_dwordx4 v246, s[12:15], s50 offen lds
    v_mfma_f32_16x16x32_bf16 v[16:19], v[40:43], v[52:55], 0
    ds_read_b64_tr_b16 v[74:75], v88 offset:8704
    s_waitcnt lgkmcnt(10)
    v_mfma_f32_16x16x32_bf16 v[12:15], v[44:47], v[48:51], 0
    ds_read_b64_tr_b16 v[76:77], v89 offset:8192
    s_add_u32 m0, m0, 1024
    s_nop 0
    buffer_load_dwordx4 v247, s[12:15], s50 offen lds
    v_mfma_f32_16x16x32_bf16 v[20:23], v[44:47], v[52:55], 0
    ds_read_b64_tr_b16 v[78:79], v89 offset:8704
    v_mfma_f32_16x16x32_bf16 v[32:35], v[40:43], v[36:39], 0
    s_waitcnt lgkmcnt(11)
    v_mfma_f32_16x16x32_bf16 v[24:27], v[36:39], v[64:67], v[24:27]
    ds_read_b128 v[48:51], v91 offset:8192
    v_mfma_f32_16x16x32_bf16 v[28:31], v[64:67], v[64:67], v[28:31]
    ds_read_b128 v[52:55], v93 offset:8192
    s_waitcnt lgkmcnt(10)
    v_mfma_f32_16x16x32_bf16 v[8:11], v[56:59], v[64:67], v[8:11]
    ds_read_b64_tr_b16 v[40:41], v88 offset:12288
    s_mov_b32 m0, s58
    s_add_u32 s50, s50, 128
    global_load_lds_dwordx4 v[240:241], off
    v_mfma_f32_16x16x32_bf16 v[16:19], v[56:59], v[68:71], v[16:19]
    ds_read_b64_tr_b16 v[42:43], v88 offset:12800
    s_add_u32 m0, m0, 1024
    s_add_u32 s58, s58, 8192
    global_load_lds_dwordx4 v[242:243], off
    s_waitcnt lgkmcnt(10)
    v_mfma_f32_16x16x32_bf16 v[12:15], v[60:63], v[64:67], v[12:15]
    ds_read_b64_tr_b16 v[44:45], v89 offset:12288
    v_add_co_u32 v240, vcc, s57, v240
    s_nop 1
    v_addc_co_u32 v241, vcc, 0, v241, vcc
    v_mfma_f32_16x16x32_bf16 v[20:23], v[60:63], v[68:71], v[20:23]
    ds_read_b64_tr_b16 v[46:47], v89 offset:12800
    v_add_co_u32 v242, vcc, s57, v242
    s_nop 1
    v_addc_co_u32 v243, vcc, 0, v243, vcc
    v_mfma_f32_16x16x32_bf16 v[32:35], v[56:59], v[36:39], v[32:35]
    s_waitcnt vmcnt(12)
    s_barrier
    s_waitcnt lgkmcnt(11)
    v_mfma_f32_16x16x32_bf16 v[24:27], v[36:39], v[80:83], v[24:27]
    ds_read_b128 v[64:67], v90 offset:16384
    v_mfma_f32_16x16x32_bf16 v[28:31], v[80:83], v[80:83], v[28:31]
    ds_read_b128 v[68:71], v92 offset:16384
    s_waitcnt lgkmcnt(10)
    v_mfma_f32_16x16x32_bf16 v[8:11], v[72:75], v[80:83], v[8:11]
    ds_read_b64_tr_b16 v[56:57], v88 offset:16384
    s_mov_b32 m0, s55
    s_add_u32 s55, s55, 8192
    buffer_load_dwordx4 v246, s[12:15], s50 offen lds
    v_mfma_f32_16x16x32_bf16 v[16:19], v[72:75], v[84:87], v[16:19]
    ds_read_b64_tr_b16 v[58:59], v88 offset:16896
    s_waitcnt lgkmcnt(10)
    v_mfma_f32_16x16x32_bf16 v[12:15], v[76:79], v[80:83], v[12:15]
    ds_read_b64_tr_b16 v[60:61], v89 offset:16384
    s_add_u32 m0, m0, 1024
    s_nop 0
    buffer_load_dwordx4 v247, s[12:15], s50 offen lds
    v_mfma_f32_16x16x32_bf16 v[20:23], v[76:79], v[84:87], v[20:23]
    ds_read_b64_tr_b16 v[62:63], v89 offset:16896
    v_mfma_f32_16x16x32_bf16 v[32:35], v[72:75], v[36:39], v[32:35]
    s_waitcnt lgkmcnt(11)
    v_mfma_f32_16x16x32_bf16 v[24:27], v[36:39], v[48:51], v[24:27]
    ds_read_b128 v[80:83], v91 offset:16384
    v_mfma_f32_16x16x32_bf16 v[28:31], v[48:51], v[48:51], v[28:31]
    ds_read_b128 v[84:87], v93 offset:16384
    s_waitcnt lgkmcnt(10)
    v_mfma_f32_16x16x32_bf16 v[8:11], v[40:43], v[48:51], v[8:11]
    ds_read_b64_tr_b16 v[72:73], v88 offset:20480
    s_mov_b32 m0, s58
    s_add_u32 s50, s50, 128
    global_load_lds_dwordx4 v[240:241], off
    v_mfma_f32_16x16x32_bf16 v[16:19], v[40:43], v[52:55], v[16:19]
    ds_read_b64_tr_b16 v[74:75], v88 offset:20992
    s_add_u32 m0, m0, 1024
    s_add_u32 s58, s58, 8192
    global_load_lds_dwordx4 v[242:243], off
    s_waitcnt lgkmcnt(10)
    v_mfma_f32_16x16x32_bf16 v[12:15], v[44:47], v[48:51], v[12:15]
    ds_read_b64_tr_b16 v[76:77], v89 offset:20480
    v_add_co_u32 v240, vcc, s57, v240
    s_nop 1
    v_addc_co_u32 v241, vcc, 0, v241, vcc
    v_mfma_f32_16x16x32_bf16 v[20:23], v[44:47], v[52:55], v[20:23]
    ds_read_b64_tr_b16 v[78:79], v89 offset:20992
    v_add_co_u32 v242, vcc, s57, v242
    s_nop 1
    v_addc_co_u32 v243, vcc, 0, v243, vcc
    v_mfma_f32_16x16x32_bf16 v[32:35], v[40:43], v[36:39], v[32:35]
    s_waitcnt vmcnt(12)
    s_barrier
    s_waitcnt lgkmcnt(11)
    v_mfma_f32_16x16x32_bf16 v[24:27], v[36:39], v[64:67], v[24:27]
    ds_read_b128 v[48:51], v90 offset:24576
    v_mfma_f32_16x16x32_bf16 v[28:31], v[64:67], v[64:67], v[28:31]
    ds_read_b128 v[52:55], v92 offset:24576
    s_waitcnt lgkmcnt(10)
    v_mfma_f32_16x16x32_bf16 v[8:11], v[56:59], v[64:67], v[8:11]
    ds_read_b64_tr_b16 v[40:41], v88 offset:24576
    s_mov_b32 m0, s55
    s_add_u32 s55, s55, 8192
    buffer_load_dwordx4 v246, s[12:15], s50 offen lds
    v_mfma_f32_16x16x32_bf16 v[16:19], v[56:59], v[68:71], v[16:19]
    ds_read_b64_tr_b16 v[42:43], v88 offset:25088
    s_waitcnt lgkmcnt(10)
    v_mfma_f32_16x16x32_bf16 v[12:15], v[60:63], v[64:67], v[12:15]
    ds_read_b64_tr_b16 v[44:45], v89 offset:24576
    s_add_u32 m0, m0, 1024
    s_nop 0
    buffer_load_dwordx4 v247, s[12:15], s50 offen lds
    v_mfma_f32_16x16x32_bf16 v[20:23], v[60:63], v[68:71], v[20:23]
    ds_read_b64_tr_b16 v[46:47], v89 offset:25088
    v_mfma_f32_16x16x32_bf16 v[32:35], v[56:59], v[36:39], v[32:35]
    s_waitcnt lgkmcnt(11)
    v_mfma_f32_16x16x32_bf16 v[24:27], v[36:39], v[80:83], v[24:27]
    ds_read_b128 v[64:67], v91 offset:24576
    v_mfma_f32_16x16x32_bf16 v[28:31], v[80:83], v[80:83], v[28:31]
    ds_read_b128 v[68:71], v93 offset:24576
    s_waitcnt lgkmcnt(10)
    v_mfma_f32_16x16x32_bf16 v[8:11], v[72:75], v[80:83], v[8:11]
    ds_read_b64_tr_b16 v[56:57], v88 offset:28672
    s_mov_b32 m0, s58
    s_add_u32 s50, s50, 128
    global_load_lds_dwordx4 v[240:241], off
    v_mfma_f32_16x16x32_bf16 v[16:19], v[72:75], v[84:87], v[16:19]
    ds_read_b64_tr_b16 v[58:59], v88 offset:29184
    s_add_u32 m0, m0, 1024
    s_add_u32 s58, s58, 8192
    global_load_lds_dwordx4 v[242:243], off
    s_waitcnt lgkmcnt(10)
    v_mfma_f32_16x16x32_bf16 v[12:15], v[76:79], v[80:83], v[12:15]
    ds_read_b64_tr_b16 v[60:61], v89 offset:28672
    v_add_co_u32 v240, vcc, s57, v240
    s_nop 1
    v_addc_co_u32 v241, vcc, 0, v241, vcc
    v_mfma_f32_16x16x32_bf16 v[20:23], v[76:79], v[84:87], v[20:23]
    ds_read_b64_tr_b16 v[62:63], v89 offset:29184
    v_add_co_u32 v242, vcc, s57, v242
    s_nop 1
    v_addc_co_u32 v243, vcc, 0, v243, vcc
    v_mfma_f32_16x16x32_bf16 v[32:35], v[72:75], v[36:39], v[32:35]
    s_waitcnt vmcnt(12)
    v_lshrrev_b32 v160, 2, v1
    v_lshlrev_b32 v161, 7, v160
    v_and_b32 v162, 3, v1
    v_lshl_add_u32 v161, v162, 3, v161
    s_lshl_b32 s56, s8, 12
    s_add_u32 s56, s56, 114688
    v_add_u32 v161, s56, v161
    v_bfe_u32 v160, v160, 1, 2
    v_xor_b32 v162, 0, v160
    v_lshl_add_u32 v162, v162, 5, v161
    ds_read_b64_tr_b16 v[128:129], v162
    ds_read_b64_tr_b16 v[130:131], v162 offset:2048
    v_xor_b32 v162, 1, v160
    v_lshl_add_u32 v162, v162, 5, v161
    ds_read_b64_tr_b16 v[132:133], v162
    ds_read_b64_tr_b16 v[134:135], v162 offset:2048
    v_xor_b32 v162, 2, v160
    v_lshl_add_u32 v162, v162, 5, v161
    ds_read_b64_tr_b16 v[136:137], v162
    ds_read_b64_tr_b16 v[138:139], v162 offset:2048
    v_xor_b32 v162, 3, v160
    v_lshl_add_u32 v162, v162, 5, v161
    ds_read_b64_tr_b16 v[140:141], v162
    ds_read_b64_tr_b16 v[142:143], v162 offset:2048
    s_lshl_b32 s56, s49, 2
    s_add_u32 s56, s56, 0
    s_mul_i32 s90, s56, 147
    s_lshr_b32 s90, s90, 10
    s_mul_i32 s91, s90, 7
    s_sub_u32 s56, s56, s91
    s_lshl_b32 s91, s36, 2
    s_add_u32 s91, s91, s56
    s_cmp_ge_u32 s91, 50
    s_cselect_b32 s37, -8, 48
    s_add_u32 s91, s91, s37
    s_mul_i32 s37, s36, -3
    s_add_u32 s37, s37, s56
    s_add_u32 s37, s37, 35
    s_cmp_ge_u32 s56, 4
    s_cselect_b32 s56, s37, s91
    s_mul_i32 s90, s90, 98
    s_add_u32 s56, s56, s90
    s_lshl_b32 s56, s56, 10
    s_cmp_eq_u32 s47, 2
    s_cselect_b32 s56, s56, 0
    s_add_u32 s32, s56, s48
    s_lshl_b32 s56, s49, 2
    s_add_u32 s56, s56, 1
    s_mul_i32 s90, s56, 147
    s_lshr_b32 s90, s90, 10
    s_mul_i32 s91, s90, 7
    s_sub_u32 s56, s56, s91
    s_lshl_b32 s91, s36, 2
    s_add_u32 s91, s91, s56
    s_cmp_ge_u32 s91, 50
    s_cselect_b32 s37, -8, 48
    s_add_u32 s91, s91, s37
    s_mul_i32 s37, s36, -3
    s_add_u32 s37, s37, s56
    s_add_u32 s37, s37, 35
    s_cmp_ge_u32 s56, 4
    s_cselect_b32 s56, s37, s91
    s_mul_i32 s90, s90, 98
    s_add_u32 s56, s56, s90
    s_lshl_b32 s56, s56, 10
    s_cmp_eq_u32 s47, 2
    s_cselect_b32 s56, s56, 1024
    s_add_u32 s33, s56, s48
    s_lshl_b32 s56, s49, 2
    s_add_u32 s56, s56, 2
    s_mul_i32 s90, s56, 147
    s_lshr_b32 s90, s90, 10
    s_mul_i32 s91, s90, 7
    s_sub_u32 s56, s56, s91
    s_lshl_b32 s91, s36, 2
    s_add_u32 s91, s91, s56
    s_cmp_ge_u32 s91, 50
    s_cselect_b32 s37, -8, 48
    s_add_u32 s91, s91, s37
    s_mul_i32 s37, s36, -3
    s_add_u32 s37, s37, s56
    s_add_u32 s37, s37, 35
    s_cmp_ge_u32 s56, 4
    s_cselect_b32 s56, s37, s91
    s_mul_i32 s90, s90, 98
    s_add_u32 s56, s56, s90
    s_lshl_b32 s56, s56, 10
    s_cmp_eq_u32 s47, 2
    s_cselect_b32 s56, s56, 2048
    s_add_u32 s34, s56, s48
    s_lshl_b32 s56, s49, 2
    s_add_u32 s56, s56, 3
    s_mul_i32 s90, s56, 147
    s_lshr_b32 s90, s90, 10
    s_mul_i32 s91, s90, 7
    s_sub_u32 s56, s56, s91
    s_lshl_b32 s91, s36, 2
    s_add_u32 s91, s91, s56
    s_cmp_ge_u32 s91, 50
    s_cselect_b32 s37, -8, 48
    s_add_u32 s91, s91, s37
    s_mul_i32 s37, s36, -3
    s_add_u32 s37, s37, s56
    s_add_u32 s37, s37, 35
    s_cmp_ge_u32 s56, 4
    s_cselect_b32 s56, s37, s91
    s_mul_i32 s90, s90, 98
    s_add_u32 s56, s56, s90
    s_lshl_b32 s56, s56, 10
    s_cmp_eq_u32 s47, 2
    s_cselect_b32 s56, s56, 3072
    s_add_u32 s35, s56, s48
    s_cmp_lg_u32 s47, 1
    s_cbranch_scc1 q1_nzt
    s_mov_b32 exec_lo, 0
    s_mov_b32 exec_hi, 0xffff0000
    s_waitcnt lgkmcnt(6)
    v_mov_b32 v130, 0
    v_mov_b32 v131, 0
    s_waitcnt lgkmcnt(4)
    v_mov_b32 v134, 0
    v_mov_b32 v135, 0
    s_waitcnt lgkmcnt(2)
    v_mov_b32 v138, 0
    v_mov_b32 v139, 0
    s_waitcnt lgkmcnt(0)
    v_mov_b32 v142, 0
    v_mov_b32 v143, 0
    s_mov_b64 exec, -1
q1_nzt:
    s_cmp_eq_u32 s47, 0
    s_cselect_b32 s42, 0x7ff00000, 0
    v_add_u32 v160, s42, v2
    s_waitcnt lgkmcnt(6)
    buffer_store_dwordx4 v[128:131], v160, s[4:7], s32 offen sc1
    s_waitcnt lgkmcnt(4)
    buffer_store_dwordx4 v[132:135], v160, s[4:7], s33 offen sc1
    s_waitcnt lgkmcnt(2)
    buffer_store_dwordx4 v[136:139], v160, s[4:7], s34 offen sc1
    s_waitcnt lgkmcnt(0)
    buffer_store_dwordx4 v[140:143], v160, s[4:7], s35 offen sc1
    v_mfma_f32_16x16x32_bf16 v[168:171], v[128:131], v[36:39], 0
    v_mfma_f32_16x16x32_bf16 v[172:175], v[132:135], v[36:39], 0
    v_mfma_f32_16x16x32_bf16 v[176:179], v[136:139], v[36:39], 0
    v_mfma_f32_16x16x32_bf16 v[180:183], v[140:143], v[36:39], 0
    s_mul_i32 s56, s36, 7168
    s_lshl_b32 s90, s49, 8
    s_add_u32 s56, s56, s90
    s_add_u32 s56, s56, 4141056
    s_cmp_eq_u32 s47, 2
    s_cselect_b32 s56, s56, 0x7ff00000
    v_lshl_add_u32 v162, v4, 4, s56
    v_lshl_add_u32 v162, v3, 6, v162
    v_cmp_eq_u32 vcc, 1, v3
    s_nop 1
    v_cndmask_b32 v168, v168, v172, vcc
    v_cndmask_b32 v169, v169, v173, vcc
    v_cndmask_b32 v170, v170, v174, vcc
    v_cndmask_b32 v171, v171, v175, vcc
    v_cmp_eq_u32 vcc, 2, v3
    s_nop 1
    v_cndmask_b32 v168, v168, v176, vcc
    v_cndmask_b32 v169, v169, v177, vcc
    v_cndmask_b32 v170, v170, v178, vcc
    v_cndmask_b32 v171, v171, v179, vcc
    v_cmp_eq_u32 vcc, 3, v3
    s_nop 1
    v_cndmask_b32 v168, v168, v180, vcc
    v_cndmask_b32 v169, v169, v181, vcc
    v_cndmask_b32 v170, v170, v182, vcc
    v_cndmask_b32 v171, v171, v183, vcc
    s_mov_b32 exec_lo, 0x000f000f
    s_mov_b32 exec_hi, 0x000f000f
    buffer_store_dwordx4 v[168:171], v162, s[4:7], 0 offen sc1
    s_mov_b64 exec, -1
    s_sub_u32 s56, s2, 246
    s_lshl_b32 s56, s56, 2
    s_add_u32 s56, s56, s8
    s_lshl_b32 s56, s56, 10
    s_add_u32 s56, s56, 4255744
    s_cmp_lt_u32 s2, 246
    s_cselect_b32 s56, 0x7ff00000, s56
    v_add_u32 v161, s56, v2
    v_mov_b32 v144, 0
    v_mov_b32 v145, 0
    v_mov_b32 v146, 0
    v_mov_b32 v147, 0
    buffer_store_dwordx4 v[144:147], v161, s[4:7], 0 offen sc1
    s_waitcnt vmcnt(14)
    s_barrier
    v_mfma_f32_16x16x32_bf16 v[24:27], v[36:39], v[48:51], v[24:27]
    ds_read_b128 v[80:83], v90 offset:32768
    v_mfma_f32_16x16x32_bf16 v[28:31], v[48:51], v[48:51], v[28:31]
    ds_read_b128 v[84:87], v92 offset:32768
    v_mfma_f32_16x16x32_bf16 v[8:11], v[40:43], v[48:51], v[8:11]
    ds_read_b64_tr_b16 v[72:73], v88 offset:32768
    s_lshr_b32 s64, s53, 2
    s_mul_i32 s64, s64, 229376
    v_mfma_f32_16x16x32_bf16 v[16:19], v[40:43], v[52:55], v[16:19]
    ds_read_b64_tr_b16 v[74:75], v88 offset:33280
    s_add_u32 s64, s64, s51
    v_mfma_f32_16x16x32_bf16 v[12:15], v[44:47], v[48:51], v[12:15]
    ds_read_b64_tr_b16 v[76:77], v89 offset:32768
    s_bfe_u32 s65, s53, 0x10001
    s_lshl_b32 s65, s65, 15
    v_mfma_f32_16x16x32_bf16 v[20:23], v[44:47], v[52:55], v[20:23]
    ds_read_b64_tr_b16 v[78:79], v89 offset:33280
    s_add_u32 s64, s64, s65
    v_mfma_f32_16x16x32_bf16 v[32:35], v[40:43], v[36:39], v[32:35]
    s_lshr_b32 s65, s53, 1
    s_lshr_b32 s56, s2, 3
    s_lshl_b32 s56, s56, 2
    s_add_u32 s56, s56, s8
    s_lshl_b32 s56, s56, 10
    s_min_u32 s56, s56, x_code_end-x_kernel-1024
    s_getpc_b64 s[88:89]
q1_pct:
    s_add_u32 s88, s88, x_kernel-q1_pct
    s_addc_u32 s89, s89, 0
    v_add_u32 v250, s56, v2
    global_load_dwordx4 v[148:151], v250, s[88:89]
q1_cpt:
    v_mfma_f32_16x16x32_bf16 v[24:27], v[36:39], v[64:67], v[24:27]
    ds_read_b128 v[48:51], v91 offset:32768
    v_mfma_f32_16x16x32_bf16 v[28:31], v[64:67], v[64:67], v[28:31]
    ds_read_b128 v[52:55], v93 offset:32768
    v_mfma_f32_16x16x32_bf16 v[8:11], v[56:59], v[64:67], v[8:11]
    ds_read_b64_tr_b16 v[40:41], v88 offset:36864
    s_lshl_b32 s65, s65, 12
    s_add_u32 s65, s65, s52
    v_mfma_f32_16x16x32_bf16 v[16:19], v[56:59], v[68:71], v[16:19]
    ds_read_b64_tr_b16 v[42:43], v88 offset:37376
    s_mov_b32 s63, 0x3e8b97f6
    s_cmp_eq_u32 s54, 7
    s_cselect_b32 s64, s65, s64
    s_cselect_b32 s63, 1.0, s63
    s_cselect_b64 s[24:25], -1, 0
    v_mfma_f32_16x16x32_bf16 v[12:15], v[60:63], v[64:67], v[12:15]
    ds_read_b64_tr_b16 v[44:45], v89 offset:36864
    s_and_b32 s65, s53, 1
    v_mfma_f32_16x16x32_bf16 v[20:23], v[60:63], v[68:71], v[20:23]
    ds_read_b64_tr_b16 v[46:47], v89 offset:37376
    s_lshl_b32 s65, s65, 8
    s_xor_b32 s66, s65, 256
    v_mfma_f32_16x16x32_bf16 v[32:35], v[56:59], v[36:39], v[32:35]
    s_add_u32 s66, s66, s64
    s_waitcnt vmcnt(11)
    s_barrier
    s_waitcnt lgkmcnt(11)
    v_mfma_f32_16x16x32_bf16 v[24:27], v[36:39], v[80:83], v[24:27]
    ds_read_b128 v[64:67], v90 offset:40960
    v_mfma_f32_16x16x32_bf16 v[28:31], v[80:83], v[80:83], v[28:31]
    ds_read_b128 v[68:71], v92 offset:40960
    s_waitcnt lgkmcnt(10)
    v_mfma_f32_16x16x32_bf16 v[8:11], v[72:75], v[80:83], v[8:11]
    ds_read_b64_tr_b16 v[56:57], v88 offset:40960
    s_add_u32 s64, s65, s64
    s_xor_b32 s26, s61, 0
    v_mfma_f32_16x16x32_bf16 v[16:19], v[72:75], v[84:87], v[16:19]
    ds_read_b64_tr_b16 v[58:59], v88 offset:41472
    s_lshl_b32 s27, s54, 2
    s_waitcnt lgkmcnt(10)
    v_mfma_f32_16x16x32_bf16 v[12:15], v[76:79], v[80:83], v[12:15]
    ds_read_b64_tr_b16 v[60:61], v89 offset:40960
    s_add_u32 s27, s27, s26
    s_lshl_b32 s27, s27, 2
    v_mfma_f32_16x16x32_bf16 v[20:23], v[76:79], v[84:87], v[20:23]
    ds_read_b64_tr_b16 v[62:63], v89 offset:41472
    v_add_u32 v5, s27, v4
    v_mfma_f32_16x16x32_bf16 v[32:35], v[72:75], v[36:39], v[32:35]
    v_mul_u32_u24 v6, 147, v5
    s_waitcnt lgkmcnt(11)
    v_mfma_f32_16x16x32_bf16 v[24:27], v[36:39], v[48:51], v[24:27]
    ds_read_b128 v[80:83], v91 offset:40960
    v_mfma_f32_16x16x32_bf16 v[28:31], v[48:51], v[48:51], v[28:31]
    ds_read_b128 v[84:87], v93 offset:40960
    s_waitcnt lgkmcnt(10)
    v_mfma_f32_16x16x32_bf16 v[8:11], v[40:43], v[48:51], v[8:11]
    ds_read_b64_tr_b16 v[72:73], v88 offset:45056
    v_lshrrev_b32 v6, 10, v6
    v_mul_u32_u24 v7, 7, v6
    v_mfma_f32_16x16x32_bf16 v[16:19], v[40:43], v[52:55], v[16:19]
    ds_read_b64_tr_b16 v[74:75], v88 offset:45568
    v_sub_u32 v5, v5, v7
    v_lshrrev_b32 v7, 1, v4
    s_waitcnt lgkmcnt(10)
    v_mfma_f32_16x16x32_bf16 v[12:15], v[44:47], v[48:51], v[12:15]
    ds_read_b64_tr_b16 v[76:77], v89 offset:45056
    v_mul_u32_u24 v7, s26, v7
    v_mfma_f32_16x16x32_bf16 v[20:23], v[44:47], v[52:55], v[20:23]
    ds_read_b64_tr_b16 v[78:79], v89 offset:45568
    v_xor_b32 v7, v7, v4
    v_lshl_add_u32 v7, s26, 2, v7
    v_mfma_f32_16x16x32_bf16 v[32:35], v[40:43], v[36:39], v[32:35]
    v_cndmask_b32 v5, v5, v7, s[24:25]
    s_waitcnt vmcnt(7)
    s_barrier
    s_waitcnt lgkmcnt(11)
    v_mfma_f32_16x16x32_bf16 v[24:27], v[36:39], v[64:67], v[24:27]
    ds_read_b128 v[48:51], v90 offset:49152
    v_mfma_f32_16x16x32_bf16 v[28:31], v[64:67], v[64:67], v[28:31]
    ds_read_b128 v[52:55], v92 offset:49152
    s_waitcnt lgkmcnt(10)
    v_mfma_f32_16x16x32_bf16 v[8:11], v[56:59], v[64:67], v[8:11]
    ds_read_b64_tr_b16 v[40:41], v88 offset:49152
    v_cndmask_b32 v6, v6, 0, s[24:25]
    v_lshlrev_b32 v6, 11, v6
    v_mfma_f32_16x16x32_bf16 v[16:19], v[56:59], v[68:71], v[16:19]
    ds_read_b64_tr_b16 v[42:43], v88 offset:49664
    v_lshl_add_u32 v6, v3, 4, v6
    v_lshrrev_b32 v7, 1, v5
    s_waitcnt lgkmcnt(10)
    v_mfma_f32_16x16x32_bf16 v[12:15], v[60:63], v[64:67], v[12:15]
    ds_read_b64_tr_b16 v[44:45], v89 offset:49152
    v_lshl_add_u32 v6, v7, 9, v6
    v_mfma_f32_16x16x32_bf16 v[20:23], v[60:63], v[68:71], v[20:23]
    ds_read_b64_tr_b16 v[46:47], v89 offset:49664
    v_cmp_eq_u32 s[28:29], 7, v5
    v_and_b32 v5, 1, v5
    v_mfma_f32_16x16x32_bf16 v[32:35], v[56:59], v[36:39], v[32:35]
    v_lshl_add_u32 v96, v5, 3, v6
    s_waitcnt lgkmcnt(11)
    v_mfma_f32_16x16x32_bf16 v[24:27], v[36:39], v[80:83], v[24:27]
    ds_read_b128 v[64:67], v91 offset:49152
    v_mfma_f32_16x16x32_bf16 v[28:31], v[80:83], v[80:83], v[28:31]
    ds_read_b128 v[68:71], v93 offset:49152
    s_waitcnt lgkmcnt(10)
    v_mfma_f32_16x16x32_bf16 v[8:11], v[72:75], v[80:83], v[8:11]
    ds_read_b64_tr_b16 v[56:57], v88 offset:53248
    s_xor_b32 s26, s61, 1
    s_lshl_b32 s27, s54, 2
    v_mfma_f32_16x16x32_bf16 v[16:19], v[72:75], v[84:87], v[16:19]
    ds_read_b64_tr_b16 v[58:59], v88 offset:53760
    s_add_u32 s27, s27, s26
    s_waitcnt lgkmcnt(10)
    v_mfma_f32_16x16x32_bf16 v[12:15], v[76:79], v[80:83], v[12:15]
    ds_read_b64_tr_b16 v[60:61], v89 offset:53248
    s_lshl_b32 s27, s27, 2
    v_add_u32 v5, s27, v4
    v_mfma_f32_16x16x32_bf16 v[20:23], v[76:79], v[84:87], v[20:23]
    ds_read_b64_tr_b16 v[62:63], v89 offset:53760
    v_mul_u32_u24 v6, 147, v5
    v_mfma_f32_16x16x32_bf16 v[32:35], v[72:75], v[36:39], v[32:35]
    v_lshrrev_b32 v6, 10, v6
    s_waitcnt lgkmcnt(11)
    v_mfma_f32_16x16x32_bf16 v[24:27], v[36:39], v[48:51], v[24:27]
    ds_read_b64_tr_b16 v[164:165], v98
    v_mfma_f32_16x16x32_bf16 v[28:31], v[48:51], v[48:51], v[28:31]
    ds_read_b64_tr_b16 v[166:167], v98 offset:512
    s_waitcnt lgkmcnt(10)
    v_mfma_f32_16x16x32_bf16 v[8:11], v[40:43], v[48:51], v[8:11]
    v_mul_u32_u24 v7, 7, v6
    v_sub_u32 v5, v5, v7
    v_mfma_f32_16x16x32_bf16 v[16:19], v[40:43], v[52:55], v[16:19]
    v_lshrrev_b32 v7, 1, v4
    v_mul_u32_u24 v7, s26, v7
    s_waitcnt lgkmcnt(8)
    v_mfma_f32_16x16x32_bf16 v[12:15], v[44:47], v[48:51], v[12:15]
    v_xor_b32 v7, v7, v4
    v_mfma_f32_16x16x32_bf16 v[20:23], v[44:47], v[52:55], v[20:23]
    v_lshl_add_u32 v7, s26, 2, v7
    v_cndmask_b32 v5, v5, v7, s[24:25]
    v_mfma_f32_16x16x32_bf16 v[32:35], v[40:43], v[36:39], v[32:35]
    v_cndmask_b32 v6, v6, 0, s[24:25]
    s_waitcnt lgkmcnt(7)
    v_mfma_f32_16x16x32_bf16 v[24:27], v[36:39], v[64:67], v[24:27]
    s_waitcnt lgkmcnt(0)
    buffer_store_dwordx4 v[164:167], v94, s[4:7], s38 offen sc1
    v_mfma_f32_16x16x32_bf16 v[28:31], v[64:67], v[64:67], v[28:31]
    v_mfma_f32_16x16x32_bf16 v[8:11], v[56:59], v[64:67], v[8:11]
    v_lshlrev_b32 v6, 11, v6
    v_lshl_add_u32 v6, v3, 4, v6
    v_mfma_f32_16x16x32_bf16 v[16:19], v[56:59], v[68:71], v[16:19]
    v_lshrrev_b32 v7, 1, v5
    v_lshl_add_u32 v6, v7, 9, v6
    v_mfma_f32_16x16x32_bf16 v[12:15], v[60:63], v[64:67], v[12:15]
    v_cmp_eq_u32 s[30:31], 7, v5
    v_mfma_f32_16x16x32_bf16 v[20:23], v[60:63], v[68:71], v[20:23]
    v_and_b32 v5, 1, v5
    v_lshl_add_u32 v97, v5, 3, v6
    v_mfma_f32_16x16x32_bf16 v[32:35], v[56:59], v[36:39], v[32:35]
    v_mov_b32 v126, 0x3f80
    s_lshl_b32 s56, s61, 6
    s_add_u32 s56, s56, 131072
    v_lshl_add_u32 v5, v4, 4, s56
    s_nop 3
    ds_write_b128 v5, v[32:35]
    s_lshl_b32 s65, s54, 8
    s_lshl_b32 s59, s61, 6
    s_add_u32 s65, s65, s59
    s_add_u32 s65, s65, 4136960
    buffer_store_dwordx4 v[32:35], v95, s[4:7], s65 offen sc1
    v_and_b32 v6, 3, v1
    v_cmp_eq_u32 vcc, 1, v6
    s_nop 1
    v_cndmask_b32 v124, v28, v29, vcc
    v_cmp_eq_u32 vcc, 2, v6
    s_nop 1
    v_cndmask_b32 v124, v124, v30, vcc
    v_cmp_eq_u32 vcc, 3, v6
    s_nop 1
    v_cndmask_b32 v124, v124, v31, vcc
    v_mul_f32 v108, 0x3b124925, v24
    v_mul_f32 v125, 0x3b124925, v124
    v_fma_f32 v125, -v108, v108, v125
    v_max_f32 v125, 0, v125
    v_add_f32 v125, 0x3727c5ac, v125
    v_rsq_f32 v109, v125
    s_lshl_b32 s56, s8, 7
    s_add_u32 s56, s56, 131328
    v_lshl_add_u32 v6, v3, 2, s56
    s_mov_b32 exec_lo, 0x00f0000f
    s_mov_b32 exec_hi, 0xf0000f00
    ds_write_b32 v6, v108
    ds_write_b32 v6, v109 offset:64
    s_mov_b64 exec, -1
    v_xor_b32 v7, 64, v5
    s_waitcnt lgkmcnt(0)
    s_barrier
    ds_read_b128 v[104:107], v7
    v_xor_b32 v7, 128, v6
    ds_read2_b32 v[108:109], v6 offset0:0 offset1:16
    ds_read2_b32 v[110:111], v7 offset0:0 offset1:16
    s_waitcnt lgkmcnt(1)
    v_mul_f32 v109, s63, v109
    s_waitcnt lgkmcnt(0)
    v_mul_f32 v111, s63, v111
    v_fma_f32 v8, -v108, v32, v8
    v_fma_f32 v9, -v108, v33, v9
    v_fma_f32 v10, -v108, v34, v10
    v_fma_f32 v11, -v108, v35, v11
    v_mul_f32 v8, v8, v109
    v_mul_f32 v9, v9, v109
    v_mul_f32 v10, v10, v109
    v_mul_f32 v11, v11, v109
    v_cvt_pk_bf16_f32 v8, v8, v9
    v_cvt_pk_bf16_f32 v9, v10, v11
    v_cndmask_b32 v8, v8, v36, s[28:29]
    v_cndmask_b32 v9, v9, v126, s[28:29]
    buffer_store_dwordx2 v[8:9], v96, s[4:7], s64 offen sc1
    v_fma_f32 v16, -v110, v32, v16
    v_fma_f32 v17, -v110, v33, v17
    v_fma_f32 v18, -v110, v34, v18
    v_fma_f32 v19, -v110, v35, v19
    v_mul_f32 v16, v16, v111
    v_mul_f32 v17, v17, v111
    v_mul_f32 v18, v18, v111
    v_mul_f32 v19, v19, v111
    v_cvt_pk_bf16_f32 v16, v16, v17
    v_cvt_pk_bf16_f32 v17, v18, v19
    v_cndmask_b32 v16, v16, v36, s[28:29]
    v_cndmask_b32 v17, v17, v126, s[28:29]
    buffer_store_dwordx2 v[16:17], v96, s[4:7], s66 offen sc1
    v_fma_f32 v12, -v108, v104, v12
    v_fma_f32 v13, -v108, v105, v13
    v_fma_f32 v14, -v108, v106, v14
    v_fma_f32 v15, -v108, v107, v15
    v_mul_f32 v12, v12, v109
    v_mul_f32 v13, v13, v109
    v_mul_f32 v14, v14, v109
    v_mul_f32 v15, v15, v109
    v_cvt_pk_bf16_f32 v12, v12, v13
    v_cvt_pk_bf16_f32 v13, v14, v15
    v_cndmask_b32 v12, v12, v36, s[30:31]
    v_cndmask_b32 v13, v13, v126, s[30:31]
    buffer_store_dwordx2 v[12:13], v97, s[4:7], s64 offen sc1
    v_fma_f32 v20, -v110, v104, v20
    v_fma_f32 v21, -v110, v105, v21
    v_fma_f32 v22, -v110, v106, v22
    v_fma_f32 v23, -v110, v107, v23
    v_mul_f32 v20, v20, v111
    v_mul_f32 v21, v21, v111
    v_mul_f32 v22, v22, v111
    v_mul_f32 v23, v23, v111
    v_cvt_pk_bf16_f32 v20, v20, v21
    v_cvt_pk_bf16_f32 v21, v22, v23
    v_cndmask_b32 v20, v20, v36, s[30:31]
    v_cndmask_b32 v21, v21, v126, s[30:31]
    buffer_store_dwordx2 v[20:21], v97, s[4:7], s66 offen sc1
    s_branch q1_fin
q1_v:
    s_waitcnt vmcnt(16)
    s_barrier
    ds_read_b128 v[48:51], v90 offset:0
    ds_read_b128 v[52:55], v92 offset:0
    ds_read_b64_tr_b16 v[40:41], v88 offset:0
    ds_read_b64_tr_b16 v[42:43], v88 offset:512
    ds_read_b64_tr_b16 v[44:45], v89 offset:0
    ds_read_b64_tr_b16 v[46:47], v89 offset:512
    ds_read_b128 v[64:67], v91 offset:0
    ds_read_b128 v[68:71], v93 offset:0
    ds_read_b64_tr_b16 v[56:57], v88 offset:4096
    ds_read_b64_tr_b16 v[58:59], v88 offset:4608
    ds_read_b64_tr_b16 v[60:61], v89 offset:4096
    ds_read_b64_tr_b16 v[62:63], v89 offset:4608
    s_waitcnt vmcnt(12)
    s_barrier
    s_waitcnt lgkmcnt(11)
    v_mfma_f32_16x16x32_bf16 v[24:27], v[36:39], v[48:51], 0
    ds_read_b128 v[80:83], v90 offset:8192
    v_mfma_f32_16x16x32_bf16 v[28:31], v[48:51], v[48:51], 0
    ds_read_b128 v[84:87], v92 offset:8192
    s_waitcnt lgkmcnt(10)
    v_mfma_f32_16x16x32_bf16 v[8:11], v[48:51], v[40:43], 0
    ds_read_b64_tr_b16 v[72:73], v88 offset:8192
    s_mov_b32 m0, s55
    s_add_u32 s55, s55, 8192
    buffer_load_dwordx4 v246, s[12:15], s50 offen lds
    v_mfma_f32_16x16x32_bf16 v[16:19], v[52:55], v[40:43], 0
    ds_read_b64_tr_b16 v[74:75], v88 offset:8704
    s_waitcnt lgkmcnt(10)
    v_mfma_f32_16x16x32_bf16 v[12:15], v[48:51], v[44:47], 0
    ds_read_b64_tr_b16 v[76:77], v89 offset:8192
    s_add_u32 m0, m0, 1024
    s_nop 0
    buffer_load_dwordx4 v247, s[12:15], s50 offen lds
    v_mfma_f32_16x16x32_bf16 v[20:23], v[52:55], v[44:47], 0
    ds_read_b64_tr_b16 v[78:79], v89 offset:8704
    v_mfma_f32_16x16x32_bf16 v[32:35], v[40:43], v[36:39], 0
    s_waitcnt lgkmcnt(11)
    v_mfma_f32_16x16x32_bf16 v[24:27], v[36:39], v[64:67], v[24:27]
    ds_read_b128 v[48:51], v91 offset:8192
    v_mfma_f32_16x16x32_bf16 v[28:31], v[64:67], v[64:67], v[28:31]
    ds_read_b128 v[52:55], v93 offset:8192
    s_waitcnt lgkmcnt(10)
    v_mfma_f32_16x16x32_bf16 v[8:11], v[64:67], v[56:59], v[8:11]
    ds_read_b64_tr_b16 v[40:41], v88 offset:12288
    s_mov_b32 m0, s58
    s_add_u32 s50, s50, 128
    global_load_lds_dwordx4 v[240:241], off
    v_mfma_f32_16x16x32_bf16 v[16:19], v[68:71], v[56:59], v[16:19]
    ds_read_b64_tr_b16 v[42:43], v88 offset:12800
    s_add_u32 m0, m0, 1024
    s_add_u32 s58, s58, 8192
    global_load_lds_dwordx4 v[242:243], off
    s_waitcnt lgkmcnt(10)
    v_mfma_f32_16x16x32_bf16 v[12:15], v[64:67], v[60:63], v[12:15]
    ds_read_b64_tr_b16 v[44:45], v89 offset:12288
    v_add_co_u32 v240, vcc, s57, v240
    s_nop 1
    v_addc_co_u32 v241, vcc, 0, v241, vcc
    v_mfma_f32_16x16x32_bf16 v[20:23], v[68:71], v[60:63], v[20:23]
    ds_read_b64_tr_b16 v[46:47], v89 offset:12800
    v_add_co_u32 v242, vcc, s57, v242
    s_nop 1
    v_addc_co_u32 v243, vcc, 0, v243, vcc
    v_mfma_f32_16x16x32_bf16 v[32:35], v[56:59], v[36:39], v[32:35]
    s_waitcnt vmcnt(12)
    s_barrier
    s_waitcnt lgkmcnt(11)
    v_mfma_f32_16x16x32_bf16 v[24:27], v[36:39], v[80:83], v[24:27]
    ds_read_b128 v[64:67], v90 offset:16384
    v_mfma_f32_16x16x32_bf16 v[28:31], v[80:83], v[80:83], v[28:31]
    ds_read_b128 v[68:71], v92 offset:16384
    s_waitcnt lgkmcnt(10)
    v_mfma_f32_16x16x32_bf16 v[8:11], v[80:83], v[72:75], v[8:11]
    ds_read_b64_tr_b16 v[56:57], v88 offset:16384
    s_mov_b32 m0, s55
    s_add_u32 s55, s55, 8192
    buffer_load_dwordx4 v246, s[12:15], s50 offen lds
    v_mfma_f32_16x16x32_bf16 v[16:19], v[84:87], v[72:75], v[16:19]
    ds_read_b64_tr_b16 v[58:59], v88 offset:16896
    s_waitcnt lgkmcnt(10)
    v_mfma_f32_16x16x32_bf16 v[12:15], v[80:83], v[76:79], v[12:15]
    ds_read_b64_tr_b16 v[60:61], v89 offset:16384
    s_add_u32 m0, m0, 1024
    s_nop 0
    buffer_load_dwordx4 v247, s[12:15], s50 offen lds
    v_mfma_f32_16x16x32_bf16 v[20:23], v[84:87], v[76:79], v[20:23]
    ds_read_b64_tr_b16 v[62:63], v89 offset:16896
    v_mfma_f32_16x16x32_bf16 v[32:35], v[72:75], v[36:39], v[32:35]
    s_waitcnt lgkmcnt(11)
    v_mfma_f32_16x16x32_bf16 v[24:27], v[36:39], v[48:51], v[24:27]
    ds_read_b128 v[80:83], v91 offset:16384
    v_mfma_f32_16x16x32_bf16 v[28:31], v[48:51], v[48:51], v[28:31]
    ds_read_b128 v[84:87], v93 offset:16384
    s_waitcnt lgkmcnt(10)
    v_mfma_f32_16x16x32_bf16 v[8:11], v[48:51], v[40:43], v[8:11]
    ds_read_b64_tr_b16 v[72:73], v88 offset:20480
    s_mov_b32 m0, s58
    s_add_u32 s50, s50, 128
    global_load_lds_dwordx4 v[240:241], off
    v_mfma_f32_16x16x32_bf16 v[16:19], v[52:55], v[40:43], v[16:19]
    ds_read_b64_tr_b16 v[74:75], v88 offset:20992
    s_add_u32 m0, m0, 1024
    s_add_u32 s58, s58, 8192
    global_load_lds_dwordx4 v[242:243], off
    s_waitcnt lgkmcnt(10)
    v_mfma_f32_16x16x32_bf16 v[12:15], v[48:51], v[44:47], v[12:15]
    ds_read_b64_tr_b16 v[76:77], v89 offset:20480
    v_add_co_u32 v240, vcc, s57, v240
    s_nop 1
    v_addc_co_u32 v241, vcc, 0, v241, vcc
    v_mfma_f32_16x16x32_bf16 v[20:23], v[52:55], v[44:47], v[20:23]
    ds_read_b64_tr_b16 v[78:79], v89 offset:20992
    v_add_co_u32 v242, vcc, s57, v242
    s_nop 1
    v_addc_co_u32 v243, vcc, 0, v243, vcc
    v_mfma_f32_16x16x32_bf16 v[32:35], v[40:43], v[36:39], v[32:35]
    s_waitcnt vmcnt(12)
    s_barrier
    s_waitcnt lgkmcnt(11)
    v_mfma_f32_16x16x32_bf16 v[24:27], v[36:39], v[64:67], v[24:27]
    ds_read_b128 v[48:51], v90 offset:24576
    v_mfma_f32_16x16x32_bf16 v[28:31], v[64:67], v[64:67], v[28:31]
    ds_read_b128 v[52:55], v92 offset:24576
    s_waitcnt lgkmcnt(10)
    v_mfma_f32_16x16x32_bf16 v[8:11], v[64:67], v[56:59], v[8:11]
    ds_read_b64_tr_b16 v[40:41], v88 offset:24576
    s_mov_b32 m0, s55
    s_add_u32 s55, s55, 8192
    buffer_load_dwordx4 v246, s[12:15], s50 offen lds
    v_mfma_f32_16x16x32_bf16 v[16:19], v[68:71], v[56:59], v[16:19]
    ds_read_b64_tr_b16 v[42:43], v88 offset:25088
    s_waitcnt lgkmcnt(10)
    v_mfma_f32_16x16x32_bf16 v[12:15], v[64:67], v[60:63], v[12:15]
    ds_read_b64_tr_b16 v[44:45], v89 offset:24576
    s_add_u32 m0, m0, 1024
    s_nop 0
    buffer_load_dwordx4 v247, s[12:15], s50 offen lds
    v_mfma_f32_16x16x32_bf16 v[20:23], v[68:71], v[60:63], v[20:23]
    ds_read_b64_tr_b16 v[46:47], v89 offset:25088
    v_mfma_f32_16x16x32_bf16 v[32:35], v[56:59], v[36:39], v[32:35]
    s_waitcnt lgkmcnt(11)
    v_mfma_f32_16x16x32_bf16 v[24:27], v[36:39], v[80:83], v[24:27]
    ds_read_b128 v[64:67], v91 offset:24576
    v_mfma_f32_16x16x32_bf16 v[28:31], v[80:83], v[80:83], v[28:31]
    ds_read_b128 v[68:71], v93 offset:24576
    s_waitcnt lgkmcnt(10)
    v_mfma_f32_16x16x32_bf16 v[8:11], v[80:83], v[72:75], v[8:11]
    ds_read_b64_tr_b16 v[56:57], v88 offset:28672
    s_mov_b32 m0, s58
    s_add_u32 s50, s50, 128
    global_load_lds_dwordx4 v[240:241], off
    v_mfma_f32_16x16x32_bf16 v[16:19], v[84:87], v[72:75], v[16:19]
    ds_read_b64_tr_b16 v[58:59], v88 offset:29184
    s_add_u32 m0, m0, 1024
    s_add_u32 s58, s58, 8192
    global_load_lds_dwordx4 v[242:243], off
    s_waitcnt lgkmcnt(10)
    v_mfma_f32_16x16x32_bf16 v[12:15], v[80:83], v[76:79], v[12:15]
    ds_read_b64_tr_b16 v[60:61], v89 offset:28672
    v_add_co_u32 v240, vcc, s57, v240
    s_nop 1
    v_addc_co_u32 v241, vcc, 0, v241, vcc
    v_mfma_f32_16x16x32_bf16 v[20:23], v[84:87], v[76:79], v[20:23]
    ds_read_b64_tr_b16 v[62:63], v89 offset:29184
    v_add_co_u32 v242, vcc, s57, v242
    s_nop 1
    v_addc_co_u32 v243, vcc, 0, v243, vcc
    v_mfma_f32_16x16x32_bf16 v[32:35], v[72:75], v[36:39], v[32:35]
    s_waitcnt vmcnt(12)
    v_lshrrev_b32 v160, 2, v1
    v_lshlrev_b32 v161, 7, v160
    v_and_b32 v162, 3, v1
    v_lshl_add_u32 v161, v162, 3, v161
    s_lshl_b32 s56, s8, 12
    s_add_u32 s56, s56, 114688
    v_add_u32 v161, s56, v161
    v_bfe_u32 v160, v160, 1, 2
    v_xor_b32 v162, 0, v160
    v_lshl_add_u32 v162, v162, 5, v161
    ds_read_b64_tr_b16 v[128:129], v162
    ds_read_b64_tr_b16 v[130:131], v162 offset:2048
    v_xor_b32 v162, 1, v160
    v_lshl_add_u32 v162, v162, 5, v161
    ds_read_b64_tr_b16 v[132:133], v162
    ds_read_b64_tr_b16 v[134:135], v162 offset:2048
    v_xor_b32 v162, 2, v160
    v_lshl_add_u32 v162, v162, 5, v161
    ds_read_b64_tr_b16 v[136:137], v162
    ds_read_b64_tr_b16 v[138:139], v162 offset:2048
    v_xor_b32 v162, 3, v160
    v_lshl_add_u32 v162, v162, 5, v161
    ds_read_b64_tr_b16 v[140:141], v162
    ds_read_b64_tr_b16 v[142:143], v162 offset:2048
    s_lshl_b32 s56, s49, 2
    s_add_u32 s56, s56, 0
    s_mul_i32 s90, s56, 147
    s_lshr_b32 s90, s90, 10
    s_mul_i32 s91, s90, 7
    s_sub_u32 s56, s56, s91
    s_lshl_b32 s91, s36, 2
    s_add_u32 s91, s91, s56
    s_cmp_ge_u32 s91, 50
    s_cselect_b32 s37, -8, 48
    s_add_u32 s91, s91, s37
    s_mul_i32 s37, s36, -3
    s_add_u32 s37, s37, s56
    s_add_u32 s37, s37, 35
    s_cmp_ge_u32 s56, 4
    s_cselect_b32 s56, s37, s91
    s_mul_i32 s90, s90, 98
    s_add_u32 s56, s56, s90
    s_lshl_b32 s56, s56, 10
    s_cmp_eq_u32 s47, 2
    s_cselect_b32 s56, s56, 0
    s_add_u32 s32, s56, s48
    s_lshl_b32 s56, s49, 2
    s_add_u32 s56, s56, 1
    s_mul_i32 s90, s56, 147
    s_lshr_b32 s90, s90, 10
    s_mul_i32 s91, s90, 7
    s_sub_u32 s56, s56, s91
    s_lshl_b32 s91, s36, 2
    s_add_u32 s91, s91, s56
    s_cmp_ge_u32 s91, 50
    s_cselect_b32 s37, -8, 48
    s_add_u32 s91, s91, s37
    s_mul_i32 s37, s36, -3
    s_add_u32 s37, s37, s56
    s_add_u32 s37, s37, 35
    s_cmp_ge_u32 s56, 4
    s_cselect_b32 s56, s37, s91
    s_mul_i32 s90, s90, 98
    s_add_u32 s56, s56, s90
    s_lshl_b32 s56, s56, 10
    s_cmp_eq_u32 s47, 2
    s_cselect_b32 s56, s56, 1024
    s_add_u32 s33, s56, s48
    s_lshl_b32 s56, s49, 2
    s_add_u32 s56, s56, 2
    s_mul_i32 s90, s56, 147
    s_lshr_b32 s90, s90, 10
    s_mul_i32 s91, s90, 7
    s_sub_u32 s56, s56, s91
    s_lshl_b32 s91, s36, 2
    s_add_u32 s91, s91, s56
    s_cmp_ge_u32 s91, 50
    s_cselect_b32 s37, -8, 48
    s_add_u32 s91, s91, s37
    s_mul_i32 s37, s36, -3
    s_add_u32 s37, s37, s56
    s_add_u32 s37, s37, 35
    s_cmp_ge_u32 s56, 4
    s_cselect_b32 s56, s37, s91
    s_mul_i32 s90, s90, 98
    s_add_u32 s56, s56, s90
    s_lshl_b32 s56, s56, 10
    s_cmp_eq_u32 s47, 2
    s_cselect_b32 s56, s56, 2048
    s_add_u32 s34, s56, s48
    s_lshl_b32 s56, s49, 2
    s_add_u32 s56, s56, 3
    s_mul_i32 s90, s56, 147
    s_lshr_b32 s90, s90, 10
    s_mul_i32 s91, s90, 7
    s_sub_u32 s56, s56, s91
    s_lshl_b32 s91, s36, 2
    s_add_u32 s91, s91, s56
    s_cmp_ge_u32 s91, 50
    s_cselect_b32 s37, -8, 48
    s_add_u32 s91, s91, s37
    s_mul_i32 s37, s36, -3
    s_add_u32 s37, s37, s56
    s_add_u32 s37, s37, 35
    s_cmp_ge_u32 s56, 4
    s_cselect_b32 s56, s37, s91
    s_mul_i32 s90, s90, 98
    s_add_u32 s56, s56, s90
    s_lshl_b32 s56, s56, 10
    s_cmp_eq_u32 s47, 2
    s_cselect_b32 s56, s56, 3072
    s_add_u32 s35, s56, s48
    s_cmp_lg_u32 s47, 1
    s_cbranch_scc1 q1_nzv
    s_mov_b32 exec_lo, 0
    s_mov_b32 exec_hi, 0xffff0000
    s_waitcnt lgkmcnt(6)
    v_mov_b32 v130, 0
    v_mov_b32 v131, 0
    s_waitcnt lgkmcnt(4)
    v_mov_b32 v134, 0
    v_mov_b32 v135, 0
    s_waitcnt lgkmcnt(2)
    v_mov_b32 v138, 0
    v_mov_b32 v139, 0
    s_waitcnt lgkmcnt(0)
    v_mov_b32 v142, 0
    v_mov_b32 v143, 0
    s_mov_b64 exec, -1
q1_nzv:
    s_cmp_eq_u32 s47, 0
    s_cselect_b32 s42, 0x7ff00000, 0
    v_add_u32 v160, s42, v2
    s_waitcnt lgkmcnt(6)
    buffer_store_dwordx4 v[128:131], v160, s[4:7], s32 offen sc1
    s_waitcnt lgkmcnt(4)
    buffer_store_dwordx4 v[132:135], v160, s[4:7], s33 offen sc1
    s_waitcnt lgkmcnt(2)
    buffer_store_dwordx4 v[136:139], v160, s[4:7], s34 offen sc1
    s_waitcnt lgkmcnt(0)
    buffer_store_dwordx4 v[140:143], v160, s[4:7], s35 offen sc1
    v_mfma_f32_16x16x32_bf16 v[168:171], v[128:131], v[36:39], 0
    v_mfma_f32_16x16x32_bf16 v[172:175], v[132:135], v[36:39], 0
    v_mfma_f32_16x16x32_bf16 v[176:179], v[136:139], v[36:39], 0
    v_mfma_f32_16x16x32_bf16 v[180:183], v[140:143], v[36:39], 0
    s_mul_i32 s56, s36, 7168
    s_lshl_b32 s90, s49, 8
    s_add_u32 s56, s56, s90
    s_add_u32 s56, s56, 4141056
    s_cmp_eq_u32 s47, 2
    s_cselect_b32 s56, s56, 0x7ff00000
    v_lshl_add_u32 v162, v4, 4, s56
    v_lshl_add_u32 v162, v3, 6, v162
    v_cmp_eq_u32 vcc, 1, v3
    s_nop 1
    v_cndmask_b32 v168, v168, v172, vcc
    v_cndmask_b32 v169, v169, v173, vcc
    v_cndmask_b32 v170, v170, v174, vcc
    v_cndmask_b32 v171, v171, v175, vcc
    v_cmp_eq_u32 vcc, 2, v3
    s_nop 1
    v_cndmask_b32 v168, v168, v176, vcc
    v_cndmask_b32 v169, v169, v177, vcc
    v_cndmask_b32 v170, v170, v178, vcc
    v_cndmask_b32 v171, v171, v179, vcc
    v_cmp_eq_u32 vcc, 3, v3
    s_nop 1
    v_cndmask_b32 v168, v168, v180, vcc
    v_cndmask_b32 v169, v169, v181, vcc
    v_cndmask_b32 v170, v170, v182, vcc
    v_cndmask_b32 v171, v171, v183, vcc
    s_mov_b32 exec_lo, 0x000f000f
    s_mov_b32 exec_hi, 0x000f000f
    buffer_store_dwordx4 v[168:171], v162, s[4:7], 0 offen sc1
    s_mov_b64 exec, -1
    s_sub_u32 s56, s2, 246
    s_lshl_b32 s56, s56, 2
    s_add_u32 s56, s56, s8
    s_lshl_b32 s56, s56, 10
    s_add_u32 s56, s56, 4255744
    s_cmp_lt_u32 s2, 246
    s_cselect_b32 s56, 0x7ff00000, s56
    v_add_u32 v161, s56, v2
    v_mov_b32 v144, 0
    v_mov_b32 v145, 0
    v_mov_b32 v146, 0
    v_mov_b32 v147, 0
    buffer_store_dwordx4 v[144:147], v161, s[4:7], 0 offen sc1
    s_waitcnt vmcnt(14)
    s_barrier
    v_mfma_f32_16x16x32_bf16 v[24:27], v[36:39], v[48:51], v[24:27]
    ds_read_b128 v[80:83], v90 offset:32768
    v_mfma_f32_16x16x32_bf16 v[28:31], v[48:51], v[48:51], v[28:31]
    ds_read_b128 v[84:87], v92 offset:32768
    v_mfma_f32_16x16x32_bf16 v[8:11], v[48:51], v[40:43], v[8:11]
    ds_read_b64_tr_b16 v[72:73], v88 offset:32768
    s_lshr_b32 s64, s53, 1
    v_mfma_f32_16x16x32_bf16 v[16:19], v[52:55], v[40:43], v[16:19]
    ds_read_b64_tr_b16 v[74:75], v88 offset:33280
    s_lshl_b32 s64, s64, 12
    v_mfma_f32_16x16x32_bf16 v[12:15], v[48:51], v[44:47], v[12:15]
    ds_read_b64_tr_b16 v[76:77], v89 offset:32768
    v_mfma_f32_16x16x32_bf16 v[20:23], v[52:55], v[44:47], v[20:23]
    ds_read_b64_tr_b16 v[78:79], v89 offset:33280
    s_add_u32 s64, s64, s52
    v_mfma_f32_16x16x32_bf16 v[32:35], v[40:43], v[36:39], v[32:35]
    s_lshr_b32 s56, s2, 3
    s_lshl_b32 s56, s56, 2
    s_add_u32 s56, s56, s8
    s_lshl_b32 s56, s56, 10
    s_min_u32 s56, s56, x_code_end-x_kernel-1024
    s_getpc_b64 s[88:89]
q1_pcv:
    s_add_u32 s88, s88, x_kernel-q1_pcv
    s_addc_u32 s89, s89, 0
    v_add_u32 v250, s56, v2
    global_load_dwordx4 v[148:151], v250, s[88:89]
q1_cpv:
    v_mfma_f32_16x16x32_bf16 v[24:27], v[36:39], v[64:67], v[24:27]
    ds_read_b128 v[48:51], v91 offset:32768
    v_mfma_f32_16x16x32_bf16 v[28:31], v[64:67], v[64:67], v[28:31]
    ds_read_b128 v[52:55], v93 offset:32768
    v_mfma_f32_16x16x32_bf16 v[8:11], v[64:67], v[56:59], v[8:11]
    ds_read_b64_tr_b16 v[40:41], v88 offset:36864
    s_add_u32 s64, s64, 2048
    v_mfma_f32_16x16x32_bf16 v[16:19], v[68:71], v[56:59], v[16:19]
    ds_read_b64_tr_b16 v[42:43], v88 offset:37376
    s_and_b32 s65, s53, 1
    v_mfma_f32_16x16x32_bf16 v[12:15], v[64:67], v[60:63], v[12:15]
    ds_read_b64_tr_b16 v[44:45], v89 offset:36864
    s_lshl_b32 s65, s65, 10
    v_mfma_f32_16x16x32_bf16 v[20:23], v[68:71], v[60:63], v[20:23]
    ds_read_b64_tr_b16 v[46:47], v89 offset:37376
    s_xor_b32 s66, s65, 1024
    v_mfma_f32_16x16x32_bf16 v[32:35], v[56:59], v[36:39], v[32:35]
    s_waitcnt vmcnt(11)
    s_barrier
    s_waitcnt lgkmcnt(11)
    v_mfma_f32_16x16x32_bf16 v[24:27], v[36:39], v[80:83], v[24:27]
    ds_read_b128 v[64:67], v90 offset:40960
    v_mfma_f32_16x16x32_bf16 v[28:31], v[80:83], v[80:83], v[28:31]
    ds_read_b128 v[68:71], v92 offset:40960
    s_waitcnt lgkmcnt(10)
    v_mfma_f32_16x16x32_bf16 v[8:11], v[80:83], v[72:75], v[8:11]
    ds_read_b64_tr_b16 v[56:57], v88 offset:40960
    s_add_u32 s66, s66, s64
    v_mfma_f32_16x16x32_bf16 v[16:19], v[84:87], v[72:75], v[16:19]
    ds_read_b64_tr_b16 v[58:59], v88 offset:41472
    s_add_u32 s64, s65, s64
    s_waitcnt lgkmcnt(10)
    v_mfma_f32_16x16x32_bf16 v[12:15], v[80:83], v[76:79], v[12:15]
    ds_read_b64_tr_b16 v[60:61], v89 offset:40960
    v_mfma_f32_16x16x32_bf16 v[20:23], v[84:87], v[76:79], v[20:23]
    ds_read_b64_tr_b16 v[62:63], v89 offset:41472
    v_and_b32 v7, 1, v4
    v_mfma_f32_16x16x32_bf16 v[32:35], v[72:75], v[36:39], v[32:35]
    s_waitcnt lgkmcnt(11)
    v_mfma_f32_16x16x32_bf16 v[24:27], v[36:39], v[48:51], v[24:27]
    ds_read_b128 v[80:83], v91 offset:40960
    v_mfma_f32_16x16x32_bf16 v[28:31], v[48:51], v[48:51], v[28:31]
    ds_read_b128 v[84:87], v93 offset:40960
    s_waitcnt lgkmcnt(10)
    v_mfma_f32_16x16x32_bf16 v[8:11], v[48:51], v[40:43], v[8:11]
    ds_read_b64_tr_b16 v[72:73], v88 offset:45056
    v_lshlrev_b32 v5, 9, v7
    v_mfma_f32_16x16x32_bf16 v[16:19], v[52:55], v[40:43], v[16:19]
    ds_read_b64_tr_b16 v[74:75], v88 offset:45568
    v_lshrrev_b32 v6, 1, v4
    s_waitcnt lgkmcnt(10)
    v_mfma_f32_16x16x32_bf16 v[12:15], v[48:51], v[44:47], v[12:15]
    ds_read_b64_tr_b16 v[76:77], v89 offset:45056
    v_lshl_add_u32 v5, v6, 3, v5
    v_mfma_f32_16x16x32_bf16 v[20:23], v[52:55], v[44:47], v[20:23]
    ds_read_b64_tr_b16 v[78:79], v89 offset:45568
    v_lshl_add_u32 v124, v3, 4, v5
    v_mfma_f32_16x16x32_bf16 v[32:35], v[40:43], v[36:39], v[32:35]
    s_waitcnt vmcnt(7)
    s_barrier
    s_waitcnt lgkmcnt(11)
    v_mfma_f32_16x16x32_bf16 v[24:27], v[36:39], v[64:67], v[24:27]
    ds_read_b128 v[48:51], v90 offset:49152
    v_mfma_f32_16x16x32_bf16 v[28:31], v[64:67], v[64:67], v[28:31]
    ds_read_b128 v[52:55], v92 offset:49152
    s_waitcnt lgkmcnt(10)
    v_mfma_f32_16x16x32_bf16 v[8:11], v[64:67], v[56:59], v[8:11]
    ds_read_b64_tr_b16 v[40:41], v88 offset:49152
    v_lshrrev_b32 v6, 3, v3
    v_mfma_f32_16x16x32_bf16 v[16:19], v[68:71], v[56:59], v[16:19]
    ds_read_b64_tr_b16 v[42:43], v88 offset:49664
    v_lshlrev_b32 v6, 2, v6
    s_waitcnt lgkmcnt(10)
    v_mfma_f32_16x16x32_bf16 v[12:15], v[64:67], v[60:63], v[12:15]
    ds_read_b64_tr_b16 v[44:45], v89 offset:49152
    v_mfma_f32_16x16x32_bf16 v[20:23], v[68:71], v[60:63], v[20:23]
    ds_read_b64_tr_b16 v[46:47], v89 offset:49664
    v_xor_b32 v6, v6, v3
    v_mfma_f32_16x16x32_bf16 v[32:35], v[56:59], v[36:39], v[32:35]
    s_waitcnt lgkmcnt(11)
    v_mfma_f32_16x16x32_bf16 v[24:27], v[36:39], v[80:83], v[24:27]
    ds_read_b128 v[64:67], v91 offset:49152
    v_mfma_f32_16x16x32_bf16 v[28:31], v[80:83], v[80:83], v[28:31]
    ds_read_b128 v[68:71], v93 offset:49152
    s_waitcnt lgkmcnt(10)
    v_mfma_f32_16x16x32_bf16 v[8:11], v[80:83], v[72:75], v[8:11]
    ds_read_b64_tr_b16 v[56:57], v88 offset:53248
    v_lshl_add_u32 v5, v6, 4, v5
    v_mfma_f32_16x16x32_bf16 v[16:19], v[84:87], v[72:75], v[16:19]
    ds_read_b64_tr_b16 v[58:59], v88 offset:53760
    v_add_u32 v125, 256, v5
    s_waitcnt lgkmcnt(10)
    v_mfma_f32_16x16x32_bf16 v[12:15], v[80:83], v[76:79], v[12:15]
    ds_read_b64_tr_b16 v[60:61], v89 offset:53248
    s_cmp_eq_u32 s62, 0
    s_cselect_b64 s[24:25], -1, 0
    v_mfma_f32_16x16x32_bf16 v[20:23], v[84:87], v[76:79], v[20:23]
    ds_read_b64_tr_b16 v[62:63], v89 offset:53760
    v_cndmask_b32 v96, v125, v124, s[24:25]
    v_mfma_f32_16x16x32_bf16 v[32:35], v[72:75], v[36:39], v[32:35]
    s_waitcnt lgkmcnt(11)
    v_mfma_f32_16x16x32_bf16 v[24:27], v[36:39], v[48:51], v[24:27]
    ds_read_b64_tr_b16 v[164:165], v98
    v_mfma_f32_16x16x32_bf16 v[28:31], v[48:51], v[48:51], v[28:31]
    ds_read_b64_tr_b16 v[166:167], v98 offset:512
    s_waitcnt lgkmcnt(10)
    v_mfma_f32_16x16x32_bf16 v[8:11], v[48:51], v[40:43], v[8:11]
    v_cndmask_b32 v97, v124, v125, s[24:25]
    v_mfma_f32_16x16x32_bf16 v[16:19], v[52:55], v[40:43], v[16:19]
    s_mov_b32 s26, 0x0f000f00
    s_waitcnt lgkmcnt(8)
    v_mfma_f32_16x16x32_bf16 v[12:15], v[48:51], v[44:47], v[12:15]
    v_mfma_f32_16x16x32_bf16 v[20:23], v[52:55], v[44:47], v[20:23]
    s_mov_b32 s27, 0x0f000f00
    v_mfma_f32_16x16x32_bf16 v[32:35], v[40:43], v[36:39], v[32:35]
    s_waitcnt lgkmcnt(7)
    v_mfma_f32_16x16x32_bf16 v[24:27], v[36:39], v[64:67], v[24:27]
    s_waitcnt lgkmcnt(0)
    buffer_store_dwordx4 v[164:167], v94, s[4:7], s38 offen sc1
    v_mfma_f32_16x16x32_bf16 v[28:31], v[64:67], v[64:67], v[28:31]
    v_mfma_f32_16x16x32_bf16 v[8:11], v[64:67], v[56:59], v[8:11]
    s_andn2_b64 s[28:29], s[26:27], s[24:25]
    v_mfma_f32_16x16x32_bf16 v[16:19], v[68:71], v[56:59], v[16:19]
    s_and_b64 s[30:31], s[26:27], s[24:25]
    v_mfma_f32_16x16x32_bf16 v[12:15], v[64:67], v[60:63], v[12:15]
    v_cmp_eq_u32 s[26:27], 8, v3
    v_mfma_f32_16x16x32_bf16 v[20:23], v[68:71], v[60:63], v[20:23]
    s_nop 0
    v_cndmask_b32 v126, 0, v36, s[26:27]
    v_mfma_f32_16x16x32_bf16 v[32:35], v[56:59], v[36:39], v[32:35]
    s_lshl_b32 s56, s61, 6
    s_add_u32 s56, s56, 131072
    v_lshl_add_u32 v5, v4, 4, s56
    s_nop 4
    ds_write_b128 v5, v[32:35]
    s_lshl_b32 s65, s54, 8
    s_lshl_b32 s59, s61, 6
    s_add_u32 s65, s65, s59
    s_add_u32 s65, s65, 4136960
    buffer_store_dwordx4 v[32:35], v95, s[4:7], s65 offen sc1
    v_and_b32 v6, 3, v1
    v_cmp_eq_u32 vcc, 1, v6
    s_nop 1
    v_cndmask_b32 v124, v28, v29, vcc
    v_cmp_eq_u32 vcc, 2, v6
    s_nop 1
    v_cndmask_b32 v124, v124, v30, vcc
    v_cmp_eq_u32 vcc, 3, v6
    s_nop 1
    v_cndmask_b32 v124, v124, v31, vcc
    v_mul_f32 v108, 0x3b124925, v24
    v_mul_f32 v125, 0x3b124925, v124
    v_fma_f32 v125, -v108, v108, v125
    v_max_f32 v125, 0, v125
    v_add_f32 v125, 0x3727c5ac, v125
    v_rsq_f32 v109, v125
    s_lshl_b32 s56, s8, 7
    s_add_u32 s56, s56, 131328
    v_lshl_add_u32 v6, v3, 2, s56
    s_mov_b32 exec_lo, 0x00f0000f
    s_mov_b32 exec_hi, 0xf0000f00
    ds_write_b32 v6, v108
    ds_write_b32 v6, v109 offset:64
    s_mov_b64 exec, -1
    v_xor_b32 v7, 64, v5
    s_waitcnt lgkmcnt(0)
    s_barrier
    s_lshl_b32 s59, s61, 6
    s_add_u32 s59, s59, 131072
    v_lshl_add_u32 v5, v3, 2, s59
    v_xor_b32 v7, 64, v5
    ds_read_b32 v100, v5
    ds_read_b32 v101, v7
    v_lshl_add_u32 v6, v4, 4, s56
    v_xor_b32 v7, 128, v6
    ds_read_b128 v[108:111], v6
    ds_read_b128 v[112:115], v6 offset:64
    ds_read_b128 v[116:119], v7
    ds_read_b128 v[120:123], v7 offset:64
    s_waitcnt lgkmcnt(3)
    v_fma_f32 v8, -v108, v100, v8
    v_fma_f32 v9, -v109, v100, v9
    v_fma_f32 v10, -v110, v100, v10
    v_fma_f32 v11, -v111, v100, v11
    s_waitcnt lgkmcnt(2)
    v_mul_f32 v8, v8, v112
    v_mul_f32 v9, v9, v113
    v_mul_f32 v10, v10, v114
    v_mul_f32 v11, v11, v115
    v_cvt_pk_bf16_f32 v8, v8, v9
    v_cvt_pk_bf16_f32 v9, v10, v11
    v_cndmask_b32 v8, v8, v126, s[28:29]
    v_cndmask_b32 v9, v9, v126, s[28:29]
    buffer_store_dwordx2 v[8:9], v96, s[4:7], s64 offen sc1
    v_fma_f32 v12, -v108, v101, v12
    v_fma_f32 v13, -v109, v101, v13
    v_fma_f32 v14, -v110, v101, v14
    v_fma_f32 v15, -v111, v101, v15
    v_mul_f32 v12, v12, v112
    v_mul_f32 v13, v13, v113
    v_mul_f32 v14, v14, v114
    v_mul_f32 v15, v15, v115
    v_cvt_pk_bf16_f32 v12, v12, v13
    v_cvt_pk_bf16_f32 v13, v14, v15
    v_cndmask_b32 v12, v12, v126, s[30:31]
    v_cndmask_b32 v13, v13, v126, s[30:31]
    buffer_store_dwordx2 v[12:13], v97, s[4:7], s64 offen sc1
    s_waitcnt lgkmcnt(1)
    v_fma_f32 v16, -v116, v100, v16
    v_fma_f32 v17, -v117, v100, v17
    v_fma_f32 v18, -v118, v100, v18
    v_fma_f32 v19, -v119, v100, v19
    s_waitcnt lgkmcnt(0)
    v_mul_f32 v16, v16, v120
    v_mul_f32 v17, v17, v121
    v_mul_f32 v18, v18, v122
    v_mul_f32 v19, v19, v123
    v_cvt_pk_bf16_f32 v16, v16, v17
    v_cvt_pk_bf16_f32 v17, v18, v19
    v_cndmask_b32 v16, v16, v126, s[28:29]
    v_cndmask_b32 v17, v17, v126, s[28:29]
    buffer_store_dwordx2 v[16:17], v96, s[4:7], s66 offen sc1
    v_fma_f32 v20, -v116, v101, v20
    v_fma_f32 v21, -v117, v101, v21
    v_fma_f32 v22, -v118, v101, v22
    v_fma_f32 v23, -v119, v101, v23
    v_mul_f32 v20, v20, v120
    v_mul_f32 v21, v21, v121
    v_mul_f32 v22, v22, v122
    v_mul_f32 v23, v23, v123
    v_cvt_pk_bf16_f32 v20, v20, v21
    v_cvt_pk_bf16_f32 v21, v22, v23
    v_cndmask_b32 v20, v20, v126, s[30:31]
    v_cndmask_b32 v21, v21, v126, s[30:31]
    buffer_store_dwordx2 v[20:21], v97, s[4:7], s66 offen sc1
q1_fin:
    s_endpgm
q1_end:
    s_endpgm
.p2align 8
.globl x_kernel
.type x_kernel,@function
x_kernel:
    s_load_dwordx2 s[92:93], s[0:1], 96
    s_load_dwordx2 s[88:89], s[0:1], 0
    s_load_dwordx2 s[90:91], s[0:1], 80
    s_load_dwordx2 s[84:85], s[0:1], 56
    s_load_dwordx2 s[86:87], s[0:1], 72
    s_cmp_ge_u32 s2, 256
    s_cbranch_scc1 x_end
    s_mov_b32 s11, 0
    s_mov_b32 s44, 6524928
    s_mov_b32 s45, 4296704
    s_mov_b32 s46, 6524928
    s_mov_b32 s47, 4558848
    s_mov_b32 s48, 6393856
    s_mov_b32 s49, 6524928
    s_mov_b32 s50, 4255744
    v_lshrrev_b32 v1, 6, v0
    s_nop 0
    v_readfirstlane_b32 s8, v1
    v_and_b32 v1, 63, v0
    v_lshlrev_b32 v2, 4, v1
    v_and_b32 v3, 15, v1
    v_lshrrev_b32 v4, 4, v1
    s_and_b32 s9, s2, 7
    s_lshl_b32 s9, s9, 1
    s_lshr_b32 s10, s2, 7
    s_add_u32 s9, s9, s10
    s_bfe_u32 s10, s2, 0x40003
    s_cmp_ge_u32 s10, 7
    s_cselect_b32 s18, 1, 0
    s_mul_i32 s19, s18, 7
    s_sub_u32 s19, s10, s19
    s_cmp_ge_u32 s19, 7
    s_cselect_b32 s19, 0, s19
    s_lshl_b32 s55, s9, 3
    s_lshl_b32 s56, s18, 2
    s_add_u32 s55, s55, s56
    s_mul_i32 s56, s9, 458752
    s_lshl_b32 s57, s10, 11
    s_add_u32 s56, s56, s57
    s_add_u32 s56, s56, s44
    s_add_u32 s57, s8, 0
    s_bfe_u32 s58, s57, 0x10001
    s_mul_i32 s58, s58, 229376
    s_and_b32 s57, s57, 1
    s_lshl_b32 s57, s57, 15
    s_add_u32 s57, s57, s58
    s_add_u32 s32, s57, s56
    s_add_u32 s57, s8, 1
    s_bfe_u32 s58, s57, 0x10001
    s_mul_i32 s58, s58, 229376
    s_and_b32 s57, s57, 1
    s_lshl_b32 s57, s57, 15
    s_add_u32 s57, s57, s58
    s_add_u32 s33, s57, s56
    s_add_u32 s57, s8, 2
    s_bfe_u32 s58, s57, 0x10001
    s_mul_i32 s58, s58, 229376
    s_and_b32 s57, s57, 1
    s_lshl_b32 s57, s57, 15
    s_add_u32 s57, s57, s58
    s_add_u32 s34, s57, s56
    s_add_u32 s57, s8, 3
    s_bfe_u32 s58, s57, 0x10001
    s_mul_i32 s58, s58, 229376
    s_and_b32 s57, s57, 1
    s_lshl_b32 s57, s57, 15
    s_add_u32 s57, s57, s58
    s_add_u32 s35, s57, s56
    s_lshl_b32 s36, s8, 16
    s_add_u32 s36, s36, s45
    s_add_u32 s36, s36, 4096
    s_waitcnt lgkmcnt(0)
    s_mov_b32 s4, s92
    s_and_b32 s5, s93, 0xffff
    s_mov_b32 s6, 14127104
    s_mov_b32 s7, 0x20000
    buffer_load_dwordx4 v[152:155], v2, s[4:7], s45 offen sc1
    buffer_load_dwordx4 v[156:159], v2, s[4:7], s45 offen offset:1024 sc1
    buffer_load_dwordx4 v[16:19], v2, s[4:7], s33 offen sc1
    buffer_load_dwordx4 v[20:23], v2, s[4:7], s33 offen offset:1024 sc1
    buffer_load_dwordx4 v[24:27], v2, s[4:7], s34 offen sc1
    buffer_load_dwordx4 v[28:31], v2, s[4:7], s34 offen offset:1024 sc1
    buffer_load_dwordx4 v[32:35], v2, s[4:7], s35 offen sc1
    buffer_load_dwordx4 v[36:39], v2, s[4:7], s35 offen offset:1024 sc1
    buffer_load_dwordx4 v[8:11], v2, s[4:7], s32 offen sc1
    buffer_load_dwordx4 v[12:15], v2, s[4:7], s32 offen offset:1024 sc1
    s_add_u32 s70, s92, s36
    s_addc_u32 s71, s93, 0
    s_mov_b32 s12, s88
    s_and_b32 s13, s89, 0xffff
    s_mov_b32 s14, 1835008
    s_mov_b32 s15, 0x20000
    s_mov_b32 s20, s90
    s_and_b32 s21, s91, 0xffff
    s_mov_b32 s22, 1835008
    s_mov_b32 s23, 0x20000
    s_mov_b32 s24, s84
    s_and_b32 s25, s85, 0xffff
    s_mov_b32 s26, 3584
    s_mov_b32 s27, 0x20000
    s_mov_b32 s28, s86
    s_and_b32 s29, s87, 0xffff
    s_mov_b32 s30, 896
    s_mov_b32 s31, 0x20000
    s_getreg_b32 s82, hwreg(HW_REG_XCC_ID)
    s_and_b32 s82, s82, 15
    s_mul_i32 s83, s82, s82
    s_lshl_b32 s83, s83, 16
    s_lshl_b32 s82, s82, 8
    s_or_b32 s82, s82, s83
    s_or_b32 s82, s82, 1
    s_lshl_b32 s83, s9, 7
    s_add_u32 s83, s83, s50
    s_add_u32 s83, s83, 2048
    v_mov_b32 v252, s83
    v_mov_b32 v253, s82
    s_lshl_b32 s82, s82, 4
    s_cmp_lg_u32 s8, 0
    s_cbranch_scc1 cen_skip
    s_mov_b64 exec, 1
    buffer_atomic_add v253, v252, s[4:7], 0 offen sc1
    s_mov_b64 exec, -1
cen_skip:
    v_mul_u32_u24 v6, 896, v3
    v_lshl_add_u32 v6, v4, 3, v6
    s_add_u32 s68, s55, s8
    s_mul_i32 s68, s68, 14336
    s_lshl_b32 s69, s19, 7
    s_add_u32 s68, s68, s69
    v_add_u32 v6, s68, v6
    s_mov_b32 s60, 0xffff0000
    s_mov_b32 s61, 0x07060302
    s_mov_b32 s62, 0
    s_mov_b32 s63, -1
    s_mul_i32 s56, s19, 229376
    s_mul_i32 s57, s8, 57344
    s_add_u32 s56, s56, s57
    s_add_u32 s56, s56, 2072576
    s_and_b32 s58, s10, 1
    s_mul_i32 s58, s58, 229376
    s_add_u32 s58, s58, s57
    s_add_u32 s58, s58, 3678208
    s_cmp_ge_u32 s10, 14
    s_cselect_b32 s56, s58, s56
    s_add_u32 s84, s92, s56
    s_addc_u32 s85, s93, 0
    s_lshl_b32 s56, s19, 16
    s_add_u32 s56, s56, 0
    s_mul_i32 s59, s8, 15360
    s_add_u32 s57, s56, s59
    s_add_u32 s72, s92, s57
    s_addc_u32 s73, s93, 0
    s_add_u32 m0, s59, 102400
    s_add_u32 s56, s56, 61440
    s_add_u32 s74, s92, s56
    s_addc_u32 s75, s93, 0
    s_mul_i32 s56, s10, 100352
    s_add_u32 s56, s56, 458752
    s_mul_i32 s59, s8, 13312
    s_min_u32 s59, s59, 37888
    s_add_u32 s59, s59, 49152
    s_mul_i32 s57, s10, 448
    s_mul_i32 s58, s8, 28672
    s_add_u32 s57, s57, s58
    s_add_u32 s57, s57, 4141056
    v_lshrrev_b32 v5, 5, v1
    v_mul_u32_u24 v5, 7168, v5
    v_and_b32 v250, 31, v1
    v_lshl_add_u32 v250, v250, 4, v5
    v_add_u32 v250, s57, v250
    s_cmp_eq_u32 s8, 3
    s_cselect_b32 s57, 0x7ff00000, 0
    s_add_u32 s57, s57, 14336
    v_add_u32 v251, s57, v250
    s_add_u32 s57, s56, s59
    s_add_u32 s78, s92, s57
    s_addc_u32 s79, s93, 0
    s_mov_b32 s42, s56
    s_mul_i32 s39, s8, 5120
    s_add_u32 s39, s39, 28672
    s_add_u32 s57, s39, s56
    s_add_u32 s80, s92, s57
    s_addc_u32 s81, s93, 0
    v_min_u32 v244, 39, v1
    v_lshlrev_b32 v244, 7, v244
    v_bfe_u32 v7, v1, 4, 1
    v_lshlrev_b32 v7, 10, v7
    v_lshl_add_u32 v7, v3, 4, v7
    v_lshrrev_b32 v5, 5, v1
    v_lshl_add_u32 v7, v5, 8, v7
    s_sub_u32 s56, s32, s44
    s_add_u32 s56, s56, s46
    v_add_u32 v7, s56, v7
    s_add_u32 s56, s8, 0
    s_and_b32 s56, s56, 3
    s_mul_i32 s56, s56, 12288
    v_add_u32 v240, s56, v2
    s_add_u32 s56, s8, 1
    s_and_b32 s56, s56, 3
    s_mul_i32 s56, s56, 12288
    v_add_u32 v241, s56, v2
    s_add_u32 s56, s8, 2
    s_and_b32 s56, s56, 3
    s_mul_i32 s56, s56, 12288
    v_add_u32 v242, s56, v2
    s_add_u32 s56, s8, 3
    s_and_b32 s56, s56, 3
    s_mul_i32 s56, s56, 12288
    v_add_u32 v243, s56, v2
    s_lshl_b32 s56, s10, 2
    s_add_u32 s56, s56, s8
    s_lshl_b32 s57, s9, 1
    s_lshr_b32 s58, s56, 5
    s_add_u32 s57, s57, s58
    s_mul_i32 s57, s57, 229376
    s_and_b32 s58, s56, 31
    s_lshl_b32 s58, s58, 11
    s_add_u32 s57, s57, s58
    s_add_u32 s57, s57, s49
    v_lshl_add_u32 v248, v3, 7, s57
    v_add_u32 v247, 0x10000, v248
    s_min_u32 s56, s56, 55
    s_lshl_b32 s57, s56, 11
    s_mul_i32 s58, s9, 114688
    s_add_u32 s57, s57, s58
    s_add_u32 s57, s57, s47
    v_lshl_add_u32 v249, v3, 7, s57
    s_mul_i32 s57, s10, 224
    v_lshl_add_u32 v5, v1, 3, s57
    s_mov_b64 exec, s[62:63]
    s_waitcnt vmcnt(6)
    v_mov_b32 v22, 0
    v_mov_b32 v23, 0
    s_mov_b64 exec, -1
    v_mfma_f32_32x32x16_bf16 v[56:71], v[152:155], v[16:19], 0
    global_load_dwordx4 a[176:179], v2, s[70:71] offset:-4096 sc1
    v_mfma_f32_32x32x16_bf16 v[56:71], v[156:159], v[20:23], v[56:71]
    global_load_dwordx4 a[180:183], v2, s[70:71] offset:-3072 sc1
    s_mov_b64 exec, s[62:63]
    s_waitcnt vmcnt(6)
    v_mov_b32 v30, 0
    v_mov_b32 v31, 0
    s_mov_b64 exec, -1
    v_mfma_f32_32x32x16_bf16 v[72:87], v[152:155], v[24:27], 0
    global_load_dwordx4 a[184:187], v2, s[70:71] offset:-2048 sc1
    v_mfma_f32_32x32x16_bf16 v[72:87], v[156:159], v[28:31], v[72:87]
    global_load_dwordx4 a[188:191], v2, s[70:71] offset:-1024 sc1
    s_mov_b64 exec, s[62:63]
    s_waitcnt vmcnt(6)
    v_mov_b32 v38, 0
    v_mov_b32 v39, 0
    s_mov_b64 exec, -1
    v_mfma_f32_32x32x16_bf16 v[88:103], v[152:155], v[32:35], 0
    global_load_dwordx4 a[192:195], v2, s[70:71] offset:0 sc1
    v_mfma_f32_32x32x16_bf16 v[88:103], v[156:159], v[36:39], v[88:103]
    global_load_dwordx4 a[196:199], v2, s[70:71] offset:1024 sc1
    v_max3_f32 v228, v56, v57, v58
    v_max3_f32 v229, v59, v60, v61
    v_max3_f32 v228, v228, v62, v63
    v_max3_f32 v229, v229, v64, v65
    s_mov_b64 exec, s[62:63]
    s_waitcnt vmcnt(6)
    v_mov_b32 v14, 0
    v_mov_b32 v15, 0
    s_mov_b64 exec, -1
    v_mfma_f32_32x32x16_bf16 v[40:55], v[152:155], v[8:11], 0
    global_load_dwordx4 a[200:203], v2, s[70:71] offset:2048 sc1
    v_max3_f32 v228, v228, v66, v67
    v_max3_f32 v229, v229, v68, v69
    v_max3_f32 v228, v228, v70, v71
    v_min_f32 v228, -v228, -v229
    v_mfma_f32_32x32x16_bf16 v[40:55], v[156:159], v[12:15], v[40:55]
    global_load_dwordx4 a[204:207], v2, s[70:71] offset:3072 sc1
    s_add_u32 s70, s70, 8192
    s_addc_u32 s71, s71, 0
    v_max3_f32 v232, v72, v73, v74
    v_max3_f32 v233, v75, v76, v77
    v_max3_f32 v232, v232, v78, v79
    v_max3_f32 v233, v233, v80, v81
    v_max3_f32 v232, v232, v82, v83
    v_max3_f32 v233, v233, v84, v85
    v_max3_f32 v232, v232, v86, v87
    v_min_f32 v232, -v232, -v233
    v_max3_f32 v236, v88, v89, v90
    v_max3_f32 v237, v91, v92, v93
    v_max3_f32 v236, v236, v94, v95
    v_max3_f32 v237, v237, v96, v97
    v_max3_f32 v236, v236, v98, v99
    v_max3_f32 v237, v237, v100, v101
    v_max3_f32 v236, v236, v102, v103
    v_min_f32 v236, -v236, -v237
    v_max3_f32 v224, v40, v41, v42
    v_max3_f32 v225, v43, v44, v45
    v_max3_f32 v224, v224, v46, v47
    v_max3_f32 v225, v225, v48, v49
    v_max3_f32 v224, v224, v50, v51
    v_max3_f32 v225, v225, v52, v53
    v_max3_f32 v224, v224, v54, v55
    v_min_f32 v224, -v224, -v225
    s_mov_b64 exec, s[62:63]
    v_lshrrev_b32 v22, 16, v228
    v_lshrrev_b32 v30, 16, v232
    v_lshrrev_b32 v38, 16, v236
    v_lshrrev_b32 v14, 16, v224
    s_mov_b64 exec, -1
    s_waitcnt vmcnt(7)
    v_mfma_f32_32x32x16_bf16 v[104:119], a[176:179], v[16:19], 0
    s_waitcnt vmcnt(6)
    v_mfma_f32_32x32x16_bf16 v[104:119], a[180:183], v[20:23], v[104:119]
    v_mfma_f32_32x32x16_bf16 v[120:135], a[176:179], v[24:27], 0
    s_waitcnt vmcnt(4)
    s_nop 9
    v_exp_f32 v104, v104
    v_exp_f32 v105, v105
    v_exp_f32 v106, v106
    v_exp_f32 v107, v107
    v_mfma_f32_32x32x16_bf16 v[120:135], a[180:183], v[28:31], v[120:135]
    global_load_dwordx4 a[208:211], v2, s[70:71] offset:-4096 sc1
    v_exp_f32 v108, v108
    v_exp_f32 v109, v109
    v_exp_f32 v110, v110
    v_exp_f32 v111, v111
    v_cvt_pk_bf16_f32 v136, v104, v105
    v_cvt_pk_bf16_f32 v137, v106, v107
    v_exp_f32 v112, v112
    v_exp_f32 v113, v113
    v_exp_f32 v114, v114
    v_exp_f32 v115, v115
    v_cvt_pk_bf16_f32 v138, v108, v109
    v_cvt_pk_bf16_f32 v139, v110, v111
    global_load_dwordx4 a[212:215], v2, s[70:71] offset:-3072 sc1
    v_exp_f32 v116, v116
    v_exp_f32 v117, v117
    v_exp_f32 v118, v118
    v_exp_f32 v119, v119
    v_cvt_pk_bf16_f32 v140, v112, v113
    v_cvt_pk_bf16_f32 v141, v114, v115
    v_cvt_pk_bf16_f32 v142, v116, v117
    v_cvt_pk_bf16_f32 v143, v118, v119
    v_mfma_f32_32x32x16_bf16 v[104:119], a[176:179], v[32:35], 0
    v_exp_f32 v120, v120
    v_exp_f32 v121, v121
    v_exp_f32 v122, v122
    v_exp_f32 v123, v123
    v_mfma_f32_32x32x16_bf16 v[104:119], a[180:183], v[36:39], v[104:119]
    global_load_dwordx4 a[216:219], v2, s[70:71] offset:-2048 sc1
    v_exp_f32 v124, v124
    v_exp_f32 v125, v125
    v_exp_f32 v126, v126
    v_exp_f32 v127, v127
    v_cvt_pk_bf16_f32 v144, v120, v121
    v_cvt_pk_bf16_f32 v145, v122, v123
    v_mfma_f32_32x32x16_bf16 v[56:71], a[184:187], v[136:139], 0
    v_exp_f32 v128, v128
    v_exp_f32 v129, v129
    v_exp_f32 v130, v130
    v_exp_f32 v131, v131
    v_cvt_pk_bf16_f32 v146, v124, v125
    v_cvt_pk_bf16_f32 v147, v126, v127
    v_mfma_f32_32x32x16_bf16 v[56:71], a[188:191], v[140:143], v[56:71]
    global_load_dwordx4 a[220:223], v2, s[70:71] offset:-1024 sc1
    v_exp_f32 v132, v132
    v_exp_f32 v133, v133
    v_exp_f32 v134, v134
    v_exp_f32 v135, v135
    v_cvt_pk_bf16_f32 v148, v128, v129
    v_cvt_pk_bf16_f32 v149, v130, v131
    v_cvt_pk_bf16_f32 v150, v132, v133
    v_cvt_pk_bf16_f32 v151, v134, v135
    v_mfma_f32_32x32x16_bf16 v[120:135], a[176:179], v[8:11], 0
    s_waitcnt vmcnt(6)
    v_exp_f32 v104, v104
    v_exp_f32 v105, v105
    v_exp_f32 v106, v106
    v_exp_f32 v107, v107
    v_mfma_f32_32x32x16_bf16 v[120:135], a[180:183], v[12:15], v[120:135]
    global_load_dwordx4 v[160:163], v2, s[70:71] offset:0 sc1
    v_exp_f32 v108, v108
    v_exp_f32 v109, v109
    v_exp_f32 v110, v110
    v_exp_f32 v111, v111
    v_cvt_pk_bf16_f32 v136, v104, v105
    v_cvt_pk_bf16_f32 v137, v106, v107
    v_mfma_f32_32x32x16_bf16 v[72:87], a[184:187], v[144:147], 0
    v_exp_f32 v112, v112
    v_exp_f32 v113, v113
    v_exp_f32 v114, v114
    v_exp_f32 v115, v115
    v_cvt_pk_bf16_f32 v138, v108, v109
    v_cvt_pk_bf16_f32 v139, v110, v111
    v_mfma_f32_32x32x16_bf16 v[72:87], a[188:191], v[148:151], v[72:87]
    global_load_dwordx4 v[164:167], v2, s[70:71] offset:1024 sc1
    v_exp_f32 v116, v116
    v_exp_f32 v117, v117
    v_exp_f32 v118, v118
    v_exp_f32 v119, v119
    v_cvt_pk_bf16_f32 v140, v112, v113
    v_cvt_pk_bf16_f32 v141, v114, v115
    v_cvt_pk_bf16_f32 v142, v116, v117
    v_cvt_pk_bf16_f32 v143, v118, v119
    v_mfma_f32_32x32x16_bf16 v[104:119], a[192:195], v[16:19], 0
    v_exp_f32 v120, v120
    v_exp_f32 v121, v121
    v_exp_f32 v122, v122
    v_exp_f32 v123, v123
    v_mfma_f32_32x32x16_bf16 v[104:119], a[196:199], v[20:23], v[104:119]
    global_load_dwordx4 v[168:171], v2, s[70:71] offset:2048 sc1
    v_exp_f32 v124, v124
    v_exp_f32 v125, v125
    v_exp_f32 v126, v126
    v_exp_f32 v127, v127
    v_cvt_pk_bf16_f32 v144, v120, v121
    v_cvt_pk_bf16_f32 v145, v122, v123
    v_mfma_f32_32x32x16_bf16 v[88:103], a[184:187], v[136:139], 0
    v_exp_f32 v128, v128
    v_exp_f32 v129, v129
    v_exp_f32 v130, v130
    v_exp_f32 v131, v131
    v_cvt_pk_bf16_f32 v146, v124, v125
    v_cvt_pk_bf16_f32 v147, v126, v127
    v_mfma_f32_32x32x16_bf16 v[88:103], a[188:191], v[140:143], v[88:103]
    global_load_dwordx4 v[172:175], v2, s[70:71] offset:3072 sc1
    v_exp_f32 v132, v132
    v_exp_f32 v133, v133
    v_exp_f32 v134, v134
    v_exp_f32 v135, v135
    v_cvt_pk_bf16_f32 v148, v128, v129
    v_cvt_pk_bf16_f32 v149, v130, v131
    v_cvt_pk_bf16_f32 v150, v132, v133
    v_cvt_pk_bf16_f32 v151, v134, v135
    v_mfma_f32_32x32x16_bf16 v[120:135], a[192:195], v[24:27], 0
    s_waitcnt vmcnt(8)
    s_add_u32 s70, s70, 8192
    s_addc_u32 s71, s71, 0
    v_exp_f32 v104, v104
    v_exp_f32 v105, v105
    v_exp_f32 v106, v106
    v_exp_f32 v107, v107
    v_mfma_f32_32x32x16_bf16 v[120:135], a[196:199], v[28:31], v[120:135]
    global_load_dwordx4 v[176:179], v2, s[70:71] offset:-4096 sc1
    v_exp_f32 v108, v108
    v_exp_f32 v109, v109
    v_exp_f32 v110, v110
    v_exp_f32 v111, v111
    v_cvt_pk_bf16_f32 v136, v104, v105
    v_cvt_pk_bf16_f32 v137, v106, v107
    v_mfma_f32_32x32x16_bf16 v[40:55], a[184:187], v[144:147], 0
    global_load_lds_dwordx4 v2, s[72:73] offset:0
    v_exp_f32 v112, v112
    v_exp_f32 v113, v113
    v_exp_f32 v114, v114
    v_exp_f32 v115, v115
    v_cvt_pk_bf16_f32 v138, v108, v109
    v_cvt_pk_bf16_f32 v139, v110, v111
    v_mfma_f32_32x32x16_bf16 v[40:55], a[188:191], v[148:151], v[40:55]
    global_load_dwordx4 v[180:183], v2, s[70:71] offset:-3072 sc1
    v_exp_f32 v116, v116
    v_exp_f32 v117, v117
    v_exp_f32 v118, v118
    v_exp_f32 v119, v119
    v_cvt_pk_bf16_f32 v140, v112, v113
    v_cvt_pk_bf16_f32 v141, v114, v115
    v_cvt_pk_bf16_f32 v142, v116, v117
    v_cvt_pk_bf16_f32 v143, v118, v119
    v_mfma_f32_32x32x16_bf16 v[104:119], a[192:195], v[32:35], 0
    v_exp_f32 v120, v120
    v_exp_f32 v121, v121
    v_exp_f32 v122, v122
    v_exp_f32 v123, v123
    v_mfma_f32_32x32x16_bf16 v[104:119], a[196:199], v[36:39], v[104:119]
    global_load_dwordx4 v[184:187], v2, s[70:71] offset:-2048 sc1
    v_exp_f32 v124, v124
    v_exp_f32 v125, v125
    v_exp_f32 v126, v126
    v_exp_f32 v127, v127
    v_cvt_pk_bf16_f32 v144, v120, v121
    v_cvt_pk_bf16_f32 v145, v122, v123
    v_mfma_f32_32x32x16_bf16 v[56:71], a[200:203], v[136:139], v[56:71]
    global_load_lds_dwordx4 v2, s[72:73] offset:1024
    v_exp_f32 v128, v128
    v_exp_f32 v129, v129
    v_exp_f32 v130, v130
    v_exp_f32 v131, v131
    v_cvt_pk_bf16_f32 v146, v124, v125
    v_cvt_pk_bf16_f32 v147, v126, v127
    v_mfma_f32_32x32x16_bf16 v[56:71], a[204:207], v[140:143], v[56:71]
    global_load_dwordx4 v[188:191], v2, s[70:71] offset:-1024 sc1
    v_exp_f32 v132, v132
    v_exp_f32 v133, v133
    v_exp_f32 v134, v134
    v_exp_f32 v135, v135
    v_cvt_pk_bf16_f32 v148, v128, v129
    v_cvt_pk_bf16_f32 v149, v130, v131
    v_cvt_pk_bf16_f32 v150, v132, v133
    v_cvt_pk_bf16_f32 v151, v134, v135
    v_mfma_f32_32x32x16_bf16 v[120:135], a[192:195], v[8:11], 0
    s_waitcnt vmcnt(12)
    v_exp_f32 v104, v104
    v_exp_f32 v105, v105
    v_exp_f32 v106, v106
    v_exp_f32 v107, v107
    v_mfma_f32_32x32x16_bf16 v[120:135], a[196:199], v[12:15], v[120:135]
    global_load_dwordx4 v[192:195], v2, s[70:71] offset:0 sc1
    v_exp_f32 v108, v108
    v_exp_f32 v109, v109
    v_exp_f32 v110, v110
    v_exp_f32 v111, v111
    v_cvt_pk_bf16_f32 v136, v104, v105
    v_cvt_pk_bf16_f32 v137, v106, v107
    v_mfma_f32_32x32x16_bf16 v[72:87], a[200:203], v[144:147], v[72:87]
    global_load_lds_dwordx4 v2, s[72:73] offset:2048
    v_exp_f32 v112, v112
    v_exp_f32 v113, v113
    v_exp_f32 v114, v114
    v_exp_f32 v115, v115
    v_cvt_pk_bf16_f32 v138, v108, v109
    v_cvt_pk_bf16_f32 v139, v110, v111
    v_mfma_f32_32x32x16_bf16 v[72:87], a[204:207], v[148:151], v[72:87]
    global_load_dwordx4 v[196:199], v2, s[70:71] offset:1024 sc1
    v_exp_f32 v116, v116
    v_exp_f32 v117, v117
    v_exp_f32 v118, v118
    v_exp_f32 v119, v119
    v_cvt_pk_bf16_f32 v140, v112, v113
    v_cvt_pk_bf16_f32 v141, v114, v115
    v_cvt_pk_bf16_f32 v142, v116, v117
    v_cvt_pk_bf16_f32 v143, v118, v119
    v_mfma_f32_32x32x16_bf16 v[104:119], a[208:211], v[16:19], 0
    v_exp_f32 v120, v120
    v_exp_f32 v121, v121
    v_exp_f32 v122, v122
    v_exp_f32 v123, v123
    v_mfma_f32_32x32x16_bf16 v[104:119], a[212:215], v[20:23], v[104:119]
    global_load_dwordx4 v[200:203], v2, s[70:71] offset:2048 sc1
    v_exp_f32 v124, v124
    v_exp_f32 v125, v125
    v_exp_f32 v126, v126
    v_exp_f32 v127, v127
    v_cvt_pk_bf16_f32 v144, v120, v121
    v_cvt_pk_bf16_f32 v145, v122, v123
    v_mfma_f32_32x32x16_bf16 v[88:103], a[200:203], v[136:139], v[88:103]
    global_load_lds_dwordx4 v2, s[72:73] offset:3072
    v_exp_f32 v128, v128
    v_exp_f32 v129, v129
    v_exp_f32 v130, v130
    v_exp_f32 v131, v131
    v_cvt_pk_bf16_f32 v146, v124, v125
    v_cvt_pk_bf16_f32 v147, v126, v127
    v_mfma_f32_32x32x16_bf16 v[88:103], a[204:207], v[140:143], v[88:103]
    global_load_dwordx4 v[204:207], v2, s[70:71] offset:3072 sc1
    v_exp_f32 v132, v132
    v_exp_f32 v133, v133
    v_exp_f32 v134, v134
    v_exp_f32 v135, v135
    v_cvt_pk_bf16_f32 v148, v128, v129
    v_cvt_pk_bf16_f32 v149, v130, v131
    v_cvt_pk_bf16_f32 v150, v132, v133
    v_cvt_pk_bf16_f32 v151, v134, v135
    v_mfma_f32_32x32x16_bf16 v[120:135], a[208:211], v[24:27], 0
    s_waitcnt vmcnt(16)
    s_add_u32 s70, s70, 8192
    s_addc_u32 s71, s71, 0
    v_exp_f32 v104, v104
    v_exp_f32 v105, v105
    v_exp_f32 v106, v106
    v_exp_f32 v107, v107
    v_mfma_f32_32x32x16_bf16 v[120:135], a[212:215], v[28:31], v[120:135]
    global_load_dwordx4 v[208:211], v2, s[70:71] offset:-4096 sc1
    v_exp_f32 v108, v108
    v_exp_f32 v109, v109
    v_exp_f32 v110, v110
    v_exp_f32 v111, v111
    v_cvt_pk_bf16_f32 v136, v104, v105
    v_cvt_pk_bf16_f32 v137, v106, v107
    v_mfma_f32_32x32x16_bf16 v[40:55], a[200:203], v[144:147], v[40:55]
    s_add_u32 m0, m0, 4096
    s_add_u32 s72, s72, 4096
    s_addc_u32 s73, s73, 0
    v_exp_f32 v112, v112
    v_exp_f32 v113, v113
    v_exp_f32 v114, v114
    v_exp_f32 v115, v115
    v_cvt_pk_bf16_f32 v138, v108, v109
    v_cvt_pk_bf16_f32 v139, v110, v111
    v_mfma_f32_32x32x16_bf16 v[40:55], a[204:207], v[148:151], v[40:55]
    global_load_dwordx4 v[212:215], v2, s[70:71] offset:-3072 sc1
    v_exp_f32 v116, v116
    v_exp_f32 v117, v117
    v_exp_f32 v118, v118
    v_exp_f32 v119, v119
    v_cvt_pk_bf16_f32 v140, v112, v113
    v_cvt_pk_bf16_f32 v141, v114, v115
    v_cvt_pk_bf16_f32 v142, v116, v117
    v_cvt_pk_bf16_f32 v143, v118, v119
    v_mfma_f32_32x32x16_bf16 v[104:119], a[208:211], v[32:35], 0
    v_exp_f32 v120, v120
    v_exp_f32 v121, v121
    v_exp_f32 v122, v122
    v_exp_f32 v123, v123
    v_mfma_f32_32x32x16_bf16 v[104:119], a[212:215], v[36:39], v[104:119]
    global_load_dwordx4 v[216:219], v2, s[70:71] offset:-2048 sc1
    v_exp_f32 v124, v124
    v_exp_f32 v125, v125
    v_exp_f32 v126, v126
    v_exp_f32 v127, v127
    v_cvt_pk_bf16_f32 v144, v120, v121
    v_cvt_pk_bf16_f32 v145, v122, v123
    v_mfma_f32_32x32x16_bf16 v[56:71], a[216:219], v[136:139], v[56:71]
    global_load_lds_dwordx4 v2, s[72:73] offset:0
    v_exp_f32 v128, v128
    v_exp_f32 v129, v129
    v_exp_f32 v130, v130
    v_exp_f32 v131, v131
    v_cvt_pk_bf16_f32 v146, v124, v125
    v_cvt_pk_bf16_f32 v147, v126, v127
    v_mfma_f32_32x32x16_bf16 v[56:71], a[220:223], v[140:143], v[56:71]
    global_load_dwordx4 v[220:223], v2, s[70:71] offset:-1024 sc1
    v_exp_f32 v132, v132
    v_exp_f32 v133, v133
    v_exp_f32 v134, v134
    v_exp_f32 v135, v135
    v_cvt_pk_bf16_f32 v148, v128, v129
    v_cvt_pk_bf16_f32 v149, v130, v131
    v_cvt_pk_bf16_f32 v150, v132, v133
    v_cvt_pk_bf16_f32 v151, v134, v135
    v_mfma_f32_32x32x16_bf16 v[120:135], a[208:211], v[8:11], 0
    s_waitcnt vmcnt(19)
    v_exp_f32 v104, v104
    v_exp_f32 v105, v105
    v_exp_f32 v106, v106
    v_exp_f32 v107, v107
    v_mfma_f32_32x32x16_bf16 v[120:135], a[212:215], v[12:15], v[120:135]
    global_load_dwordx4 v[224:227], v2, s[70:71] offset:0 sc1
    v_exp_f32 v108, v108
    v_exp_f32 v109, v109
    v_exp_f32 v110, v110
    v_exp_f32 v111, v111
    v_cvt_pk_bf16_f32 v136, v104, v105
    v_cvt_pk_bf16_f32 v137, v106, v107
    v_mfma_f32_32x32x16_bf16 v[72:87], a[216:219], v[144:147], v[72:87]
    global_load_lds_dwordx4 v2, s[72:73] offset:1024
    v_exp_f32 v112, v112
    v_exp_f32 v113, v113
    v_exp_f32 v114, v114
    v_exp_f32 v115, v115
    v_cvt_pk_bf16_f32 v138, v108, v109
    v_cvt_pk_bf16_f32 v139, v110, v111
    v_mfma_f32_32x32x16_bf16 v[72:87], a[220:223], v[148:151], v[72:87]
    global_load_dwordx4 v[228:231], v2, s[70:71] offset:1024 sc1
    v_exp_f32 v116, v116
    v_exp_f32 v117, v117
    v_exp_f32 v118, v118
    v_exp_f32 v119, v119
    v_cvt_pk_bf16_f32 v140, v112, v113
    v_cvt_pk_bf16_f32 v141, v114, v115
    v_cvt_pk_bf16_f32 v142, v116, v117
    v_cvt_pk_bf16_f32 v143, v118, v119
    v_mfma_f32_32x32x16_bf16 v[104:119], v[160:163], v[16:19], 0
    v_exp_f32 v120, v120
    v_exp_f32 v121, v121
    v_exp_f32 v122, v122
    v_exp_f32 v123, v123
    v_mfma_f32_32x32x16_bf16 v[104:119], v[164:167], v[20:23], v[104:119]
    global_load_dwordx4 v[232:235], v2, s[70:71] offset:2048 sc1
    v_exp_f32 v124, v124
    v_exp_f32 v125, v125
    v_exp_f32 v126, v126
    v_exp_f32 v127, v127
    v_cvt_pk_bf16_f32 v144, v120, v121
    v_cvt_pk_bf16_f32 v145, v122, v123
    v_mfma_f32_32x32x16_bf16 v[88:103], a[216:219], v[136:139], v[88:103]
    global_load_lds_dwordx4 v2, s[72:73] offset:2048
    v_exp_f32 v128, v128
    v_exp_f32 v129, v129
    v_exp_f32 v130, v130
    v_exp_f32 v131, v131
    v_cvt_pk_bf16_f32 v146, v124, v125
    v_cvt_pk_bf16_f32 v147, v126, v127
    v_mfma_f32_32x32x16_bf16 v[88:103], a[220:223], v[140:143], v[88:103]
    global_load_dwordx4 v[236:239], v2, s[70:71] offset:3072 sc1
    v_exp_f32 v132, v132
    v_exp_f32 v133, v133
    v_exp_f32 v134, v134
    v_exp_f32 v135, v135
    v_cvt_pk_bf16_f32 v148, v128, v129
    v_cvt_pk_bf16_f32 v149, v130, v131
    v_cvt_pk_bf16_f32 v150, v132, v133
    v_cvt_pk_bf16_f32 v151, v134, v135
    v_mfma_f32_32x32x16_bf16 v[120:135], v[160:163], v[24:27], 0
    s_waitcnt vmcnt(23)
    s_add_u32 s70, s70, 8192
    s_addc_u32 s71, s71, 0
    v_exp_f32 v104, v104
    v_exp_f32 v105, v105
    v_exp_f32 v106, v106
    v_exp_f32 v107, v107
    v_mfma_f32_32x32x16_bf16 v[120:135], v[164:167], v[28:31], v[120:135]
    global_load_dwordx4 a[176:179], v2, s[70:71] offset:-4096 sc1
    v_exp_f32 v108, v108
    v_exp_f32 v109, v109
    v_exp_f32 v110, v110
    v_exp_f32 v111, v111
    v_cvt_pk_bf16_f32 v136, v104, v105
    v_cvt_pk_bf16_f32 v137, v106, v107
    v_mfma_f32_32x32x16_bf16 v[40:55], a[216:219], v[144:147], v[40:55]
    global_load_lds_dwordx4 v2, s[72:73] offset:3072
    v_exp_f32 v112, v112
    v_exp_f32 v113, v113
    v_exp_f32 v114, v114
    v_exp_f32 v115, v115
    v_cvt_pk_bf16_f32 v138, v108, v109
    v_cvt_pk_bf16_f32 v139, v110, v111
    v_mfma_f32_32x32x16_bf16 v[40:55], a[220:223], v[148:151], v[40:55]
    global_load_dwordx4 a[180:183], v2, s[70:71] offset:-3072 sc1
    v_exp_f32 v116, v116
    v_exp_f32 v117, v117
    v_exp_f32 v118, v118
    v_exp_f32 v119, v119
    v_cvt_pk_bf16_f32 v140, v112, v113
    v_cvt_pk_bf16_f32 v141, v114, v115
    v_cvt_pk_bf16_f32 v142, v116, v117
    v_cvt_pk_bf16_f32 v143, v118, v119
    v_mfma_f32_32x32x16_bf16 v[104:119], v[160:163], v[32:35], 0
    v_exp_f32 v120, v120
    v_exp_f32 v121, v121
    v_exp_f32 v122, v122
    v_exp_f32 v123, v123
    v_mfma_f32_32x32x16_bf16 v[104:119], v[164:167], v[36:39], v[104:119]
    global_load_dwordx4 a[184:187], v2, s[70:71] offset:-2048 sc1
    v_exp_f32 v124, v124
    v_exp_f32 v125, v125
    v_exp_f32 v126, v126
    v_exp_f32 v127, v127
    v_cvt_pk_bf16_f32 v144, v120, v121
    v_cvt_pk_bf16_f32 v145, v122, v123
    v_mfma_f32_32x32x16_bf16 v[56:71], v[168:171], v[136:139], v[56:71]
    s_add_u32 m0, m0, 4096
    s_add_u32 s72, s72, 4096
    s_addc_u32 s73, s73, 0
    v_exp_f32 v128, v128
    v_exp_f32 v129, v129
    v_exp_f32 v130, v130
    v_exp_f32 v131, v131
    v_cvt_pk_bf16_f32 v146, v124, v125
    v_cvt_pk_bf16_f32 v147, v126, v127
    v_mfma_f32_32x32x16_bf16 v[56:71], v[172:175], v[140:143], v[56:71]
    global_load_dwordx4 a[188:191], v2, s[70:71] offset:-1024 sc1
    v_exp_f32 v132, v132
    v_exp_f32 v133, v133
    v_exp_f32 v134, v134
    v_exp_f32 v135, v135
    v_cvt_pk_bf16_f32 v148, v128, v129
    v_cvt_pk_bf16_f32 v149, v130, v131
    v_cvt_pk_bf16_f32 v150, v132, v133
    v_cvt_pk_bf16_f32 v151, v134, v135
    v_mfma_f32_32x32x16_bf16 v[120:135], v[160:163], v[8:11], 0
    s_waitcnt vmcnt(25)
    v_exp_f32 v104, v104
    v_exp_f32 v105, v105
    v_exp_f32 v106, v106
    v_exp_f32 v107, v107
    v_mfma_f32_32x32x16_bf16 v[120:135], v[164:167], v[12:15], v[120:135]
    global_load_dwordx4 a[192:195], v2, s[70:71] offset:0 sc1
    v_exp_f32 v108, v108
    v_exp_f32 v109, v109
    v_exp_f32 v110, v110
    v_exp_f32 v111, v111
    v_cvt_pk_bf16_f32 v136, v104, v105
    v_cvt_pk_bf16_f32 v137, v106, v107
    v_mfma_f32_32x32x16_bf16 v[72:87], v[168:171], v[144:147], v[72:87]
    global_load_lds_dwordx4 v2, s[72:73] offset:0
    v_exp_f32 v112, v112
    v_exp_f32 v113, v113
    v_exp_f32 v114, v114
    v_exp_f32 v115, v115
    v_cvt_pk_bf16_f32 v138, v108, v109
    v_cvt_pk_bf16_f32 v139, v110, v111
    v_mfma_f32_32x32x16_bf16 v[72:87], v[172:175], v[148:151], v[72:87]
    global_load_dwordx4 a[196:199], v2, s[70:71] offset:1024 sc1
    v_exp_f32 v116, v116
    v_exp_f32 v117, v117
    v_exp_f32 v118, v118
    v_exp_f32 v119, v119
    v_cvt_pk_bf16_f32 v140, v112, v113
    v_cvt_pk_bf16_f32 v141, v114, v115
    v_cvt_pk_bf16_f32 v142, v116, v117
    v_cvt_pk_bf16_f32 v143, v118, v119
    v_mfma_f32_32x32x16_bf16 v[104:119], v[176:179], v[16:19], 0
    v_exp_f32 v120, v120
    v_exp_f32 v121, v121
    v_exp_f32 v122, v122
    v_exp_f32 v123, v123
    v_mfma_f32_32x32x16_bf16 v[104:119], v[180:183], v[20:23], v[104:119]
    global_load_dwordx4 a[200:203], v2, s[70:71] offset:2048 sc1
    v_exp_f32 v124, v124
    v_exp_f32 v125, v125
    v_exp_f32 v126, v126
    v_exp_f32 v127, v127
    v_cvt_pk_bf16_f32 v144, v120, v121
    v_cvt_pk_bf16_f32 v145, v122, v123
    v_mfma_f32_32x32x16_bf16 v[88:103], v[168:171], v[136:139], v[88:103]
    global_load_lds_dwordx4 v2, s[72:73] offset:1024
    v_exp_f32 v128, v128
    v_exp_f32 v129, v129
    v_exp_f32 v130, v130
    v_exp_f32 v131, v131
    v_cvt_pk_bf16_f32 v146, v124, v125
    v_cvt_pk_bf16_f32 v147, v126, v127
    v_mfma_f32_32x32x16_bf16 v[88:103], v[172:175], v[140:143], v[88:103]
    global_load_dwordx4 a[204:207], v2, s[70:71] offset:3072 sc1
    v_exp_f32 v132, v132
    v_exp_f32 v133, v133
    v_exp_f32 v134, v134
    v_exp_f32 v135, v135
    v_cvt_pk_bf16_f32 v148, v128, v129
    v_cvt_pk_bf16_f32 v149, v130, v131
    v_cvt_pk_bf16_f32 v150, v132, v133
    v_cvt_pk_bf16_f32 v151, v134, v135
    v_mfma_f32_32x32x16_bf16 v[120:135], v[176:179], v[24:27], 0
    s_waitcnt vmcnt(28)
    s_add_u32 s70, s70, 8192
    s_addc_u32 s71, s71, 0
    v_exp_f32 v104, v104
    v_exp_f32 v105, v105
    v_exp_f32 v106, v106
    v_exp_f32 v107, v107
    v_mfma_f32_32x32x16_bf16 v[120:135], v[180:183], v[28:31], v[120:135]
    global_load_dwordx4 a[208:211], v2, s[70:71] offset:-4096 sc1
    v_exp_f32 v108, v108
    v_exp_f32 v109, v109
    v_exp_f32 v110, v110
    v_exp_f32 v111, v111
    v_cvt_pk_bf16_f32 v136, v104, v105
    v_cvt_pk_bf16_f32 v137, v106, v107
    v_mfma_f32_32x32x16_bf16 v[40:55], v[168:171], v[144:147], v[40:55]
    global_load_lds_dwordx4 v2, s[72:73] offset:2048
    v_exp_f32 v112, v112
    v_exp_f32 v113, v113
    v_exp_f32 v114, v114
    v_exp_f32 v115, v115
    v_cvt_pk_bf16_f32 v138, v108, v109
    v_cvt_pk_bf16_f32 v139, v110, v111
    v_mfma_f32_32x32x16_bf16 v[40:55], v[172:175], v[148:151], v[40:55]
    global_load_dwordx4 a[212:215], v2, s[70:71] offset:-3072 sc1
    v_exp_f32 v116, v116
    v_exp_f32 v117, v117
    v_exp_f32 v118, v118
    v_exp_f32 v119, v119
    v_cvt_pk_bf16_f32 v140, v112, v113
    v_cvt_pk_bf16_f32 v141, v114, v115
    v_cvt_pk_bf16_f32 v142, v116, v117
    v_cvt_pk_bf16_f32 v143, v118, v119
    v_mfma_f32_32x32x16_bf16 v[104:119], v[176:179], v[32:35], 0
    v_exp_f32 v120, v120
    v_exp_f32 v121, v121
    v_exp_f32 v122, v122
    v_exp_f32 v123, v123
    v_mfma_f32_32x32x16_bf16 v[104:119], v[180:183], v[36:39], v[104:119]
    global_load_dwordx4 a[216:219], v2, s[70:71] offset:-2048 sc1
    v_exp_f32 v124, v124
    v_exp_f32 v125, v125
    v_exp_f32 v126, v126
    v_exp_f32 v127, v127
    v_cvt_pk_bf16_f32 v144, v120, v121
    v_cvt_pk_bf16_f32 v145, v122, v123
    v_mfma_f32_32x32x16_bf16 v[56:71], v[184:187], v[136:139], v[56:71]
    global_load_lds_dwordx4 v2, s[72:73] offset:3072
    v_exp_f32 v128, v128
    v_exp_f32 v129, v129
    v_exp_f32 v130, v130
    v_exp_f32 v131, v131
    v_cvt_pk_bf16_f32 v146, v124, v125
    v_cvt_pk_bf16_f32 v147, v126, v127
    v_mfma_f32_32x32x16_bf16 v[56:71], v[188:191], v[140:143], v[56:71]
    global_load_dwordx4 a[220:223], v2, s[70:71] offset:-1024 sc1
    v_exp_f32 v132, v132
    v_exp_f32 v133, v133
    v_exp_f32 v134, v134
    v_exp_f32 v135, v135
    v_cvt_pk_bf16_f32 v148, v128, v129
    v_cvt_pk_bf16_f32 v149, v130, v131
    v_cvt_pk_bf16_f32 v150, v132, v133
    v_cvt_pk_bf16_f32 v151, v134, v135
    v_mfma_f32_32x32x16_bf16 v[120:135], v[176:179], v[8:11], 0
    s_waitcnt vmcnt(31)
    v_exp_f32 v104, v104
    v_exp_f32 v105, v105
    v_exp_f32 v106, v106
    v_exp_f32 v107, v107
    v_mfma_f32_32x32x16_bf16 v[120:135], v[180:183], v[12:15], v[120:135]
    global_load_dwordx4 v[160:163], v2, s[70:71] offset:0 sc1
    v_exp_f32 v108, v108
    v_exp_f32 v109, v109
    v_exp_f32 v110, v110
    v_exp_f32 v111, v111
    v_cvt_pk_bf16_f32 v136, v104, v105
    v_cvt_pk_bf16_f32 v137, v106, v107
    v_mfma_f32_32x32x16_bf16 v[72:87], v[184:187], v[144:147], v[72:87]
    s_add_u32 m0, m0, 4096
    s_add_u32 s72, s72, 4096
    s_addc_u32 s73, s73, 0
    v_exp_f32 v112, v112
    v_exp_f32 v113, v113
    v_exp_f32 v114, v114
    v_exp_f32 v115, v115
    v_cvt_pk_bf16_f32 v138, v108, v109
    v_cvt_pk_bf16_f32 v139, v110, v111
    v_mfma_f32_32x32x16_bf16 v[72:87], v[188:191], v[148:151], v[72:87]
    global_load_dwordx4 v[164:167], v2, s[70:71] offset:1024 sc1
    v_exp_f32 v116, v116
    v_exp_f32 v117, v117
    v_exp_f32 v118, v118
    v_exp_f32 v119, v119
    v_cvt_pk_bf16_f32 v140, v112, v113
    v_cvt_pk_bf16_f32 v141, v114, v115
    v_cvt_pk_bf16_f32 v142, v116, v117
    v_cvt_pk_bf16_f32 v143, v118, v119
    v_mfma_f32_32x32x16_bf16 v[104:119], v[192:195], v[16:19], 0
    v_exp_f32 v120, v120
    v_exp_f32 v121, v121
    v_exp_f32 v122, v122
    v_exp_f32 v123, v123
    v_mfma_f32_32x32x16_bf16 v[104:119], v[196:199], v[20:23], v[104:119]
    global_load_dwordx4 v[168:171], v2, s[70:71] offset:2048 sc1
    v_exp_f32 v124, v124
    v_exp_f32 v125, v125
    v_exp_f32 v126, v126
    v_exp_f32 v127, v127
    v_cvt_pk_bf16_f32 v144, v120, v121
    v_cvt_pk_bf16_f32 v145, v122, v123
    v_mfma_f32_32x32x16_bf16 v[88:103], v[184:187], v[136:139], v[88:103]
    global_load_lds_dwordx4 v2, s[72:73] offset:0
    v_exp_f32 v128, v128
    v_exp_f32 v129, v129
    v_exp_f32 v130, v130
    v_exp_f32 v131, v131
    v_cvt_pk_bf16_f32 v146, v124, v125
    v_cvt_pk_bf16_f32 v147, v126, v127
    v_mfma_f32_32x32x16_bf16 v[88:103], v[188:191], v[140:143], v[88:103]
    global_load_dwordx4 v[172:175], v2, s[70:71] offset:3072 sc1
    v_exp_f32 v132, v132
    v_exp_f32 v133, v133
    v_exp_f32 v134, v134
    v_exp_f32 v135, v135
    v_cvt_pk_bf16_f32 v148, v128, v129
    v_cvt_pk_bf16_f32 v149, v130, v131
    v_cvt_pk_bf16_f32 v150, v132, v133
    v_cvt_pk_bf16_f32 v151, v134, v135
    v_mfma_f32_32x32x16_bf16 v[120:135], v[192:195], v[24:27], 0
    s_waitcnt vmcnt(33)
    s_add_u32 s70, s70, 8192
    s_addc_u32 s71, s71, 0
    v_exp_f32 v104, v104
    v_exp_f32 v105, v105
    v_exp_f32 v106, v106
    v_exp_f32 v107, v107
    v_mfma_f32_32x32x16_bf16 v[120:135], v[196:199], v[28:31], v[120:135]
    global_load_lds_dwordx4 v2, s[72:73] offset:1024
    v_exp_f32 v108, v108
    v_exp_f32 v109, v109
    v_exp_f32 v110, v110
    v_exp_f32 v111, v111
    v_cvt_pk_bf16_f32 v136, v104, v105
    v_cvt_pk_bf16_f32 v137, v106, v107
    v_mfma_f32_32x32x16_bf16 v[40:55], v[184:187], v[144:147], v[40:55]
    global_load_lds_dwordx4 v2, s[72:73] offset:2048
    v_exp_f32 v112, v112
    v_exp_f32 v113, v113
    v_exp_f32 v114, v114
    v_exp_f32 v115, v115
    v_cvt_pk_bf16_f32 v138, v108, v109
    v_cvt_pk_bf16_f32 v139, v110, v111
    v_mfma_f32_32x32x16_bf16 v[40:55], v[188:191], v[148:151], v[40:55]
    global_load_dwordx4 v[176:179], v2, s[70:71] offset:-4096 sc1
    v_exp_f32 v116, v116
    v_exp_f32 v117, v117
    v_exp_f32 v118, v118
    v_exp_f32 v119, v119
    v_cvt_pk_bf16_f32 v140, v112, v113
    v_cvt_pk_bf16_f32 v141, v114, v115
    v_cvt_pk_bf16_f32 v142, v116, v117
    v_cvt_pk_bf16_f32 v143, v118, v119
    v_mfma_f32_32x32x16_bf16 v[104:119], v[192:195], v[32:35], 0
    v_exp_f32 v120, v120
    v_exp_f32 v121, v121
    v_exp_f32 v122, v122
    v_exp_f32 v123, v123
    v_mfma_f32_32x32x16_bf16 v[104:119], v[196:199], v[36:39], v[104:119]
    global_load_dwordx4 a[224:227], v2, s[74:75] offset:0
    v_exp_f32 v124, v124
    v_exp_f32 v125, v125
    v_exp_f32 v126, v126
    v_exp_f32 v127, v127
    v_cvt_pk_bf16_f32 v144, v120, v121
    v_cvt_pk_bf16_f32 v145, v122, v123
    v_mfma_f32_32x32x16_bf16 v[56:71], v[200:203], v[136:139], v[56:71]
    global_load_dwordx4 a[228:231], v2, s[74:75] offset:1024
    v_exp_f32 v128, v128
    v_exp_f32 v129, v129
    v_exp_f32 v130, v130
    v_exp_f32 v131, v131
    v_cvt_pk_bf16_f32 v146, v124, v125
    v_cvt_pk_bf16_f32 v147, v126, v127
    v_mfma_f32_32x32x16_bf16 v[56:71], v[204:207], v[140:143], v[56:71]
    global_load_dwordx4 v[180:183], v2, s[70:71] offset:-3072 sc1
    v_exp_f32 v132, v132
    v_exp_f32 v133, v133
    v_exp_f32 v134, v134
    v_exp_f32 v135, v135
    v_cvt_pk_bf16_f32 v148, v128, v129
    v_cvt_pk_bf16_f32 v149, v130, v131
    v_cvt_pk_bf16_f32 v150, v132, v133
    v_cvt_pk_bf16_f32 v151, v134, v135
    v_mfma_f32_32x32x16_bf16 v[120:135], v[192:195], v[8:11], 0
    s_waitcnt vmcnt(37)
    v_exp_f32 v104, v104
    v_exp_f32 v105, v105
    v_exp_f32 v106, v106
    v_exp_f32 v107, v107
    v_mfma_f32_32x32x16_bf16 v[120:135], v[196:199], v[12:15], v[120:135]
    global_load_dwordx4 a[232:235], v2, s[74:75] offset:2048
    v_exp_f32 v108, v108
    v_exp_f32 v109, v109
    v_exp_f32 v110, v110
    v_exp_f32 v111, v111
    v_cvt_pk_bf16_f32 v136, v104, v105
    v_cvt_pk_bf16_f32 v137, v106, v107
    v_mfma_f32_32x32x16_bf16 v[72:87], v[200:203], v[144:147], v[72:87]
    global_load_dwordx4 a[236:239], v2, s[74:75] offset:3072
    v_exp_f32 v112, v112
    v_exp_f32 v113, v113
    v_exp_f32 v114, v114
    v_exp_f32 v115, v115
    v_cvt_pk_bf16_f32 v138, v108, v109
    v_cvt_pk_bf16_f32 v139, v110, v111
    v_mfma_f32_32x32x16_bf16 v[72:87], v[204:207], v[148:151], v[72:87]
    global_load_dwordx4 v[184:187], v2, s[70:71] offset:-2048 sc1
    v_exp_f32 v116, v116
    v_exp_f32 v117, v117
    v_exp_f32 v118, v118
    v_exp_f32 v119, v119
    v_cvt_pk_bf16_f32 v140, v112, v113
    v_cvt_pk_bf16_f32 v141, v114, v115
    v_cvt_pk_bf16_f32 v142, v116, v117
    v_cvt_pk_bf16_f32 v143, v118, v119
    v_mfma_f32_32x32x16_bf16 v[104:119], v[208:211], v[16:19], 0
    v_exp_f32 v120, v120
    v_exp_f32 v121, v121
    v_exp_f32 v122, v122
    v_exp_f32 v123, v123
    v_mfma_f32_32x32x16_bf16 v[104:119], v[212:215], v[20:23], v[104:119]
    buffer_load_dwordx2 a[240:241], v6, s[12:15], 0 offen offset:0
    v_exp_f32 v124, v124
    v_exp_f32 v125, v125
    v_exp_f32 v126, v126
    v_exp_f32 v127, v127
    v_cvt_pk_bf16_f32 v144, v120, v121
    v_cvt_pk_bf16_f32 v145, v122, v123
    v_mfma_f32_32x32x16_bf16 v[88:103], v[200:203], v[136:139], v[88:103]
    buffer_load_dwordx2 a[242:243], v6, s[12:15], 0 offen offset:32
    v_exp_f32 v128, v128
    v_exp_f32 v129, v129
    v_exp_f32 v130, v130
    v_exp_f32 v131, v131
    v_cvt_pk_bf16_f32 v146, v124, v125
    v_cvt_pk_bf16_f32 v147, v126, v127
    v_mfma_f32_32x32x16_bf16 v[88:103], v[204:207], v[140:143], v[88:103]
    global_load_dwordx4 v[188:191], v2, s[70:71] offset:-1024 sc1
    v_exp_f32 v132, v132
    v_exp_f32 v133, v133
    v_exp_f32 v134, v134
    v_exp_f32 v135, v135
    v_cvt_pk_bf16_f32 v148, v128, v129
    v_cvt_pk_bf16_f32 v149, v130, v131
    v_cvt_pk_bf16_f32 v150, v132, v133
    v_cvt_pk_bf16_f32 v151, v134, v135
    v_mfma_f32_32x32x16_bf16 v[120:135], v[208:211], v[24:27], 0
    s_waitcnt vmcnt(40)
    v_exp_f32 v104, v104
    v_exp_f32 v105, v105
    v_exp_f32 v106, v106
    v_exp_f32 v107, v107
    v_mfma_f32_32x32x16_bf16 v[120:135], v[212:215], v[28:31], v[120:135]
    buffer_load_dwordx2 a[244:245], v6, s[12:15], 0 offen offset:64
    v_exp_f32 v108, v108
    v_exp_f32 v109, v109
    v_exp_f32 v110, v110
    v_exp_f32 v111, v111
    v_cvt_pk_bf16_f32 v136, v104, v105
    v_cvt_pk_bf16_f32 v137, v106, v107
    v_mfma_f32_32x32x16_bf16 v[40:55], v[200:203], v[144:147], v[40:55]
    v_exp_f32 v112, v112
    v_exp_f32 v113, v113
    v_exp_f32 v114, v114
    v_exp_f32 v115, v115
    v_cvt_pk_bf16_f32 v138, v108, v109
    v_cvt_pk_bf16_f32 v139, v110, v111
    v_mfma_f32_32x32x16_bf16 v[40:55], v[204:207], v[148:151], v[40:55]
    global_load_dwordx4 v[192:195], v2, s[70:71] offset:0 sc1
    v_exp_f32 v116, v116
    v_exp_f32 v117, v117
    v_exp_f32 v118, v118
    v_exp_f32 v119, v119
    v_cvt_pk_bf16_f32 v140, v112, v113
    v_cvt_pk_bf16_f32 v141, v114, v115
    v_cvt_pk_bf16_f32 v142, v116, v117
    v_cvt_pk_bf16_f32 v143, v118, v119
    v_mfma_f32_32x32x16_bf16 v[104:119], v[208:211], v[32:35], 0
    v_exp_f32 v120, v120
    v_exp_f32 v121, v121
    v_exp_f32 v122, v122
    v_exp_f32 v123, v123
    v_mfma_f32_32x32x16_bf16 v[104:119], v[212:215], v[36:39], v[104:119]
    buffer_load_dwordx2 a[246:247], v6, s[12:15], 0 offen offset:96
    v_exp_f32 v124, v124
    v_exp_f32 v125, v125
    v_exp_f32 v126, v126
    v_exp_f32 v127, v127
    v_cvt_pk_bf16_f32 v144, v120, v121
    v_cvt_pk_bf16_f32 v145, v122, v123
    v_mfma_f32_32x32x16_bf16 v[56:71], v[216:219], v[136:139], v[56:71]
    s_mov_b32 m0, s59
    v_exp_f32 v128, v128
    v_exp_f32 v129, v129
    v_exp_f32 v130, v130
    v_exp_f32 v131, v131
    v_cvt_pk_bf16_f32 v146, v124, v125
    v_cvt_pk_bf16_f32 v147, v126, v127
    v_mfma_f32_32x32x16_bf16 v[56:71], v[220:223], v[140:143], v[56:71]
    global_load_dwordx4 v[196:199], v2, s[70:71] offset:1024 sc1
    v_exp_f32 v132, v132
    v_exp_f32 v133, v133
    v_exp_f32 v134, v134
    v_exp_f32 v135, v135
    v_cvt_pk_bf16_f32 v148, v128, v129
    v_cvt_pk_bf16_f32 v149, v130, v131
    v_cvt_pk_bf16_f32 v150, v132, v133
    v_cvt_pk_bf16_f32 v151, v134, v135
    v_mfma_f32_32x32x16_bf16 v[120:135], v[208:211], v[8:11], 0
    s_waitcnt vmcnt(41)
    v_exp_f32 v104, v104
    v_exp_f32 v105, v105
    v_exp_f32 v106, v106
    v_exp_f32 v107, v107
    v_mfma_f32_32x32x16_bf16 v[120:135], v[212:215], v[12:15], v[120:135]
    global_load_lds_dwordx4 v2, s[78:79] offset:0
    v_exp_f32 v108, v108
    v_exp_f32 v109, v109
    v_exp_f32 v110, v110
    v_exp_f32 v111, v111
    v_cvt_pk_bf16_f32 v136, v104, v105
    v_cvt_pk_bf16_f32 v137, v106, v107
    v_mfma_f32_32x32x16_bf16 v[72:87], v[216:219], v[144:147], v[72:87]
    global_load_lds_dwordx4 v2, s[78:79] offset:1024
    v_exp_f32 v112, v112
    v_exp_f32 v113, v113
    v_exp_f32 v114, v114
    v_exp_f32 v115, v115
    v_cvt_pk_bf16_f32 v138, v108, v109
    v_cvt_pk_bf16_f32 v139, v110, v111
    v_mfma_f32_32x32x16_bf16 v[72:87], v[220:223], v[148:151], v[72:87]
    global_load_dwordx4 v[200:203], v2, s[70:71] offset:2048 sc1
    v_exp_f32 v116, v116
    v_exp_f32 v117, v117
    v_exp_f32 v118, v118
    v_exp_f32 v119, v119
    v_cvt_pk_bf16_f32 v140, v112, v113
    v_cvt_pk_bf16_f32 v141, v114, v115
    v_cvt_pk_bf16_f32 v142, v116, v117
    v_cvt_pk_bf16_f32 v143, v118, v119
    v_mfma_f32_32x32x16_bf16 v[104:119], v[224:227], v[16:19], 0
    v_exp_f32 v120, v120
    v_exp_f32 v121, v121
    v_exp_f32 v122, v122
    v_exp_f32 v123, v123
    v_mfma_f32_32x32x16_bf16 v[104:119], v[228:231], v[20:23], v[104:119]
    global_load_lds_dwordx4 v2, s[78:79] offset:2048
    v_exp_f32 v124, v124
    v_exp_f32 v125, v125
    v_exp_f32 v126, v126
    v_exp_f32 v127, v127
    v_cvt_pk_bf16_f32 v144, v120, v121
    v_cvt_pk_bf16_f32 v145, v122, v123
    v_mfma_f32_32x32x16_bf16 v[88:103], v[216:219], v[136:139], v[88:103]
    global_load_lds_dwordx4 v2, s[78:79] offset:3072
    v_exp_f32 v128, v128
    v_exp_f32 v129, v129
    v_exp_f32 v130, v130
    v_exp_f32 v131, v131
    v_cvt_pk_bf16_f32 v146, v124, v125
    v_cvt_pk_bf16_f32 v147, v126, v127
    v_mfma_f32_32x32x16_bf16 v[88:103], v[220:223], v[140:143], v[88:103]
    global_load_dwordx4 v[204:207], v2, s[70:71] offset:3072 sc1
    v_exp_f32 v132, v132
    v_exp_f32 v133, v133
    v_exp_f32 v134, v134
    v_exp_f32 v135, v135
    v_cvt_pk_bf16_f32 v148, v128, v129
    v_cvt_pk_bf16_f32 v149, v130, v131
    v_cvt_pk_bf16_f32 v150, v132, v133
    v_cvt_pk_bf16_f32 v151, v134, v135
    v_mfma_f32_32x32x16_bf16 v[120:135], v[224:227], v[24:27], 0
    s_waitcnt vmcnt(44)
    s_add_u32 s70, s70, 8192
    s_addc_u32 s71, s71, 0
    v_exp_f32 v104, v104
    v_exp_f32 v105, v105
    v_exp_f32 v106, v106
    v_exp_f32 v107, v107
    v_mfma_f32_32x32x16_bf16 v[120:135], v[228:231], v[28:31], v[120:135]
    s_add_u32 m0, m0, 4096
    s_add_u32 s78, s78, 4096
    s_addc_u32 s79, s79, 0
    v_exp_f32 v108, v108
    v_exp_f32 v109, v109
    v_exp_f32 v110, v110
    v_exp_f32 v111, v111
    v_cvt_pk_bf16_f32 v136, v104, v105
    v_cvt_pk_bf16_f32 v137, v106, v107
    v_mfma_f32_32x32x16_bf16 v[40:55], v[216:219], v[144:147], v[40:55]
    global_load_lds_dwordx4 v2, s[78:79] offset:0
    v_exp_f32 v112, v112
    v_exp_f32 v113, v113
    v_exp_f32 v114, v114
    v_exp_f32 v115, v115
    v_cvt_pk_bf16_f32 v138, v108, v109
    v_cvt_pk_bf16_f32 v139, v110, v111
    v_mfma_f32_32x32x16_bf16 v[40:55], v[220:223], v[148:151], v[40:55]
    global_load_dwordx4 v[208:211], v2, s[70:71] offset:-4096 sc1
    v_exp_f32 v116, v116
    v_exp_f32 v117, v117
    v_exp_f32 v118, v118
    v_exp_f32 v119, v119
    v_cvt_pk_bf16_f32 v140, v112, v113
    v_cvt_pk_bf16_f32 v141, v114, v115
    v_cvt_pk_bf16_f32 v142, v116, v117
    v_cvt_pk_bf16_f32 v143, v118, v119
    v_mfma_f32_32x32x16_bf16 v[104:119], v[224:227], v[32:35], 0
    v_exp_f32 v120, v120
    v_exp_f32 v121, v121
    v_exp_f32 v122, v122
    v_exp_f32 v123, v123
    v_mfma_f32_32x32x16_bf16 v[104:119], v[228:231], v[36:39], v[104:119]
    global_load_lds_dwordx4 v2, s[78:79] offset:1024
    v_exp_f32 v124, v124
    v_exp_f32 v125, v125
    v_exp_f32 v126, v126
    v_exp_f32 v127, v127
    v_cvt_pk_bf16_f32 v144, v120, v121
    v_cvt_pk_bf16_f32 v145, v122, v123
    v_mfma_f32_32x32x16_bf16 v[56:71], v[232:235], v[136:139], v[56:71]
    global_load_lds_dwordx4 v2, s[78:79] offset:2048
    v_exp_f32 v128, v128
    v_exp_f32 v129, v129
    v_exp_f32 v130, v130
    v_exp_f32 v131, v131
    v_cvt_pk_bf16_f32 v146, v124, v125
    v_cvt_pk_bf16_f32 v147, v126, v127
    v_mfma_f32_32x32x16_bf16 v[56:71], v[236:239], v[140:143], v[56:71]
    global_load_dwordx4 v[212:215], v2, s[70:71] offset:-3072 sc1
    v_exp_f32 v132, v132
    v_exp_f32 v133, v133
    v_exp_f32 v134, v134
    v_exp_f32 v135, v135
    v_cvt_pk_bf16_f32 v148, v128, v129
    v_cvt_pk_bf16_f32 v149, v130, v131
    v_cvt_pk_bf16_f32 v150, v132, v133
    v_cvt_pk_bf16_f32 v151, v134, v135
    v_mfma_f32_32x32x16_bf16 v[120:135], v[224:227], v[8:11], 0
    s_waitcnt vmcnt(46)
    v_exp_f32 v104, v104
    v_exp_f32 v105, v105
    v_exp_f32 v106, v106
    v_exp_f32 v107, v107
    v_mfma_f32_32x32x16_bf16 v[120:135], v[228:231], v[12:15], v[120:135]
    global_load_lds_dwordx4 v2, s[78:79] offset:3072
    v_exp_f32 v108, v108
    v_exp_f32 v109, v109
    v_exp_f32 v110, v110
    v_exp_f32 v111, v111
    v_cvt_pk_bf16_f32 v136, v104, v105
    v_cvt_pk_bf16_f32 v137, v106, v107
    v_mfma_f32_32x32x16_bf16 v[72:87], v[232:235], v[144:147], v[72:87]
    s_add_u32 m0, m0, 4096
    s_add_u32 s78, s78, 4096
    s_addc_u32 s79, s79, 0
    v_exp_f32 v112, v112
    v_exp_f32 v113, v113
    v_exp_f32 v114, v114
    v_exp_f32 v115, v115
    v_cvt_pk_bf16_f32 v138, v108, v109
    v_cvt_pk_bf16_f32 v139, v110, v111
    v_mfma_f32_32x32x16_bf16 v[72:87], v[236:239], v[148:151], v[72:87]
    global_load_dwordx4 v[216:219], v2, s[70:71] offset:-2048 sc1
    v_exp_f32 v116, v116
    v_exp_f32 v117, v117
    v_exp_f32 v118, v118
    v_exp_f32 v119, v119
    v_cvt_pk_bf16_f32 v140, v112, v113
    v_cvt_pk_bf16_f32 v141, v114, v115
    v_cvt_pk_bf16_f32 v142, v116, v117
    v_cvt_pk_bf16_f32 v143, v118, v119
    v_mfma_f32_32x32x16_bf16 v[104:119], a[176:179], v[16:19], 0
    v_exp_f32 v120, v120
    v_exp_f32 v121, v121
    v_exp_f32 v122, v122
    v_exp_f32 v123, v123
    v_mfma_f32_32x32x16_bf16 v[104:119], a[180:183], v[20:23], v[104:119]
    global_load_lds_dwordx4 v2, s[78:79] offset:0
    v_exp_f32 v124, v124
    v_exp_f32 v125, v125
    v_exp_f32 v126, v126
    v_exp_f32 v127, v127
    v_cvt_pk_bf16_f32 v144, v120, v121
    v_cvt_pk_bf16_f32 v145, v122, v123
    v_mfma_f32_32x32x16_bf16 v[88:103], v[232:235], v[136:139], v[88:103]
    global_load_lds_dwordx4 v2, s[78:79] offset:1024
    v_exp_f32 v128, v128
    v_exp_f32 v129, v129
    v_exp_f32 v130, v130
    v_exp_f32 v131, v131
    v_cvt_pk_bf16_f32 v146, v124, v125
    v_cvt_pk_bf16_f32 v147, v126, v127
    v_mfma_f32_32x32x16_bf16 v[88:103], v[236:239], v[140:143], v[88:103]
    global_load_dwordx4 v[220:223], v2, s[70:71] offset:-1024 sc1
    v_exp_f32 v132, v132
    v_exp_f32 v133, v133
    v_exp_f32 v134, v134
    v_exp_f32 v135, v135
    v_cvt_pk_bf16_f32 v148, v128, v129
    v_cvt_pk_bf16_f32 v149, v130, v131
    v_cvt_pk_bf16_f32 v150, v132, v133
    v_cvt_pk_bf16_f32 v151, v134, v135
    v_mfma_f32_32x32x16_bf16 v[120:135], a[176:179], v[24:27], 0
    s_waitcnt vmcnt(49)
    v_exp_f32 v104, v104
    v_exp_f32 v105, v105
    v_exp_f32 v106, v106
    v_exp_f32 v107, v107
    v_mfma_f32_32x32x16_bf16 v[120:135], a[180:183], v[28:31], v[120:135]
    global_load_lds_dwordx4 v2, s[78:79] offset:2048
    v_exp_f32 v108, v108
    v_exp_f32 v109, v109
    v_exp_f32 v110, v110
    v_exp_f32 v111, v111
    v_cvt_pk_bf16_f32 v136, v104, v105
    v_cvt_pk_bf16_f32 v137, v106, v107
    v_mfma_f32_32x32x16_bf16 v[40:55], v[232:235], v[144:147], v[40:55]
    global_load_lds_dwordx4 v2, s[78:79] offset:3072
    v_exp_f32 v112, v112
    v_exp_f32 v113, v113
    v_exp_f32 v114, v114
    v_exp_f32 v115, v115
    v_cvt_pk_bf16_f32 v138, v108, v109
    v_cvt_pk_bf16_f32 v139, v110, v111
    v_mfma_f32_32x32x16_bf16 v[40:55], v[236:239], v[148:151], v[40:55]
    global_load_dwordx4 v[224:227], v2, s[70:71] offset:0 sc1
    v_exp_f32 v116, v116
    v_exp_f32 v117, v117
    v_exp_f32 v118, v118
    v_exp_f32 v119, v119
    v_cvt_pk_bf16_f32 v140, v112, v113
    v_cvt_pk_bf16_f32 v141, v114, v115
    v_cvt_pk_bf16_f32 v142, v116, v117
    v_cvt_pk_bf16_f32 v143, v118, v119
    v_mfma_f32_32x32x16_bf16 v[104:119], a[176:179], v[32:35], 0
    v_exp_f32 v120, v120
    v_exp_f32 v121, v121
    v_exp_f32 v122, v122
    v_exp_f32 v123, v123
    v_mfma_f32_32x32x16_bf16 v[104:119], a[180:183], v[36:39], v[104:119]
    s_add_u32 m0, m0, 4096
    s_add_u32 s78, s78, 4096
    s_addc_u32 s79, s79, 0
    v_exp_f32 v124, v124
    v_exp_f32 v125, v125
    v_exp_f32 v126, v126
    v_exp_f32 v127, v127
    v_cvt_pk_bf16_f32 v144, v120, v121
    v_cvt_pk_bf16_f32 v145, v122, v123
    v_mfma_f32_32x32x16_bf16 v[56:71], a[184:187], v[136:139], v[56:71]
    global_load_lds_dwordx4 v2, s[78:79] offset:0
    v_exp_f32 v128, v128
    v_exp_f32 v129, v129
    v_exp_f32 v130, v130
    v_exp_f32 v131, v131
    v_cvt_pk_bf16_f32 v146, v124, v125
    v_cvt_pk_bf16_f32 v147, v126, v127
    v_mfma_f32_32x32x16_bf16 v[56:71], a[188:191], v[140:143], v[56:71]
    global_load_dwordx4 v[228:231], v2, s[70:71] offset:1024 sc1
    v_exp_f32 v132, v132
    v_exp_f32 v133, v133
    v_exp_f32 v134, v134
    v_exp_f32 v135, v135
    v_cvt_pk_bf16_f32 v148, v128, v129
    v_cvt_pk_bf16_f32 v149, v130, v131
    v_cvt_pk_bf16_f32 v150, v132, v133
    v_cvt_pk_bf16_f32 v151, v134, v135
    v_mfma_f32_32x32x16_bf16 v[120:135], a[176:179], v[8:11], 0
    s_waitcnt vmcnt(51)
    v_exp_f32 v104, v104
    v_exp_f32 v105, v105
    v_exp_f32 v106, v106
    v_exp_f32 v107, v107
    v_mfma_f32_32x32x16_bf16 v[120:135], a[180:183], v[12:15], v[120:135]
    buffer_load_dwordx4 v[152:155], v250, s[4:7], 0 offen
    v_exp_f32 v108, v108
    v_exp_f32 v109, v109
    v_exp_f32 v110, v110
    v_exp_f32 v111, v111
    v_cvt_pk_bf16_f32 v136, v104, v105
    v_cvt_pk_bf16_f32 v137, v106, v107
    v_mfma_f32_32x32x16_bf16 v[72:87], a[184:187], v[144:147], v[72:87]
    buffer_load_dwordx4 v[156:159], v251, s[4:7], 0 offen
    v_exp_f32 v112, v112
    v_exp_f32 v113, v113
    v_exp_f32 v114, v114
    v_exp_f32 v115, v115
    v_cvt_pk_bf16_f32 v138, v108, v109
    v_cvt_pk_bf16_f32 v139, v110, v111
    v_mfma_f32_32x32x16_bf16 v[72:87], a[188:191], v[148:151], v[72:87]
    global_load_dwordx4 v[232:235], v2, s[70:71] offset:2048 sc1
    v_exp_f32 v116, v116
    v_exp_f32 v117, v117
    v_exp_f32 v118, v118
    v_exp_f32 v119, v119
    v_cvt_pk_bf16_f32 v140, v112, v113
    v_cvt_pk_bf16_f32 v141, v114, v115
    v_cvt_pk_bf16_f32 v142, v116, v117
    v_cvt_pk_bf16_f32 v143, v118, v119
    v_mfma_f32_32x32x16_bf16 v[104:119], a[192:195], v[16:19], 0
    v_exp_f32 v120, v120
    v_exp_f32 v121, v121
    v_exp_f32 v122, v122
    v_exp_f32 v123, v123
    v_mfma_f32_32x32x16_bf16 v[104:119], a[196:199], v[20:23], v[104:119]
    buffer_load_dwordx2 a[248:249], v5, s[24:27], 0 offen
    v_exp_f32 v124, v124
    v_exp_f32 v125, v125
    v_exp_f32 v126, v126
    v_exp_f32 v127, v127
    v_cvt_pk_bf16_f32 v144, v120, v121
    v_cvt_pk_bf16_f32 v145, v122, v123
    v_mfma_f32_32x32x16_bf16 v[88:103], a[184:187], v[136:139], v[88:103]
    s_add_u32 s86, s84, 0
    s_addc_u32 s87, s85, 0
    v_exp_f32 v128, v128
    v_exp_f32 v129, v129
    v_exp_f32 v130, v130
    v_exp_f32 v131, v131
    v_cvt_pk_bf16_f32 v146, v124, v125
    v_cvt_pk_bf16_f32 v147, v126, v127
    v_mfma_f32_32x32x16_bf16 v[88:103], a[188:191], v[140:143], v[88:103]
    global_load_dwordx4 v[236:239], v2, s[70:71] offset:3072 sc1
    v_exp_f32 v132, v132
    v_exp_f32 v133, v133
    v_exp_f32 v134, v134
    v_exp_f32 v135, v135
    v_cvt_pk_bf16_f32 v148, v128, v129
    v_cvt_pk_bf16_f32 v149, v130, v131
    v_cvt_pk_bf16_f32 v150, v132, v133
    v_cvt_pk_bf16_f32 v151, v134, v135
    v_mfma_f32_32x32x16_bf16 v[120:135], a[192:195], v[24:27], 0
    s_waitcnt vmcnt(53)
    v_exp_f32 v104, v104
    v_exp_f32 v105, v105
    v_exp_f32 v106, v106
    v_exp_f32 v107, v107
    v_mfma_f32_32x32x16_bf16 v[120:135], a[196:199], v[28:31], v[120:135]
    global_load_dword v246, v247, s[92:93] sc1
    v_exp_f32 v108, v108
    v_exp_f32 v109, v109
    v_exp_f32 v110, v110
    v_exp_f32 v111, v111
    v_cvt_pk_bf16_f32 v136, v104, v105
    v_cvt_pk_bf16_f32 v137, v106, v107
    v_mfma_f32_32x32x16_bf16 v[40:55], a[184:187], v[144:147], v[40:55]
    global_load_dwordx4 a[0:3], v2, s[86:87] offset:-4096
    v_exp_f32 v112, v112
    v_exp_f32 v113, v113
    v_exp_f32 v114, v114
    v_exp_f32 v115, v115
    v_cvt_pk_bf16_f32 v138, v108, v109
    v_cvt_pk_bf16_f32 v139, v110, v111
    v_mfma_f32_32x32x16_bf16 v[40:55], a[188:191], v[148:151], v[40:55]
    v_exp_f32 v116, v116
    v_exp_f32 v117, v117
    v_exp_f32 v118, v118
    v_exp_f32 v119, v119
    v_cvt_pk_bf16_f32 v140, v112, v113
    v_cvt_pk_bf16_f32 v141, v114, v115
    v_cvt_pk_bf16_f32 v142, v116, v117
    v_cvt_pk_bf16_f32 v143, v118, v119
    v_mfma_f32_32x32x16_bf16 v[104:119], a[192:195], v[32:35], 0
    v_exp_f32 v120, v120
    v_exp_f32 v121, v121
    v_exp_f32 v122, v122
    v_exp_f32 v123, v123
    v_mfma_f32_32x32x16_bf16 v[104:119], a[196:199], v[36:39], v[104:119]
    global_load_dwordx4 a[4:7], v2, s[86:87] offset:-3072
    v_exp_f32 v124, v124
    v_exp_f32 v125, v125
    v_exp_f32 v126, v126
    v_exp_f32 v127, v127
    v_cvt_pk_bf16_f32 v144, v120, v121
    v_cvt_pk_bf16_f32 v145, v122, v123
    v_mfma_f32_32x32x16_bf16 v[56:71], a[200:203], v[136:139], v[56:71]
    global_load_dwordx4 a[8:11], v2, s[86:87] offset:-2048
    v_exp_f32 v128, v128
    v_exp_f32 v129, v129
    v_exp_f32 v130, v130
    v_exp_f32 v131, v131
    v_cvt_pk_bf16_f32 v146, v124, v125
    v_cvt_pk_bf16_f32 v147, v126, v127
    v_mfma_f32_32x32x16_bf16 v[56:71], a[204:207], v[140:143], v[56:71]
    global_load_dwordx4 a[12:15], v2, s[86:87] offset:-1024
    v_exp_f32 v132, v132
    v_exp_f32 v133, v133
    v_exp_f32 v134, v134
    v_exp_f32 v135, v135
    v_cvt_pk_bf16_f32 v148, v128, v129
    v_cvt_pk_bf16_f32 v149, v130, v131
    v_cvt_pk_bf16_f32 v150, v132, v133
    v_cvt_pk_bf16_f32 v151, v134, v135
    v_mfma_f32_32x32x16_bf16 v[120:135], a[192:195], v[8:11], 0
    s_waitcnt vmcnt(55)
    v_exp_f32 v104, v104
    v_exp_f32 v105, v105
    v_exp_f32 v106, v106
    v_exp_f32 v107, v107
    v_mfma_f32_32x32x16_bf16 v[120:135], a[196:199], v[12:15], v[120:135]
    s_add_u32 s86, s84, 4096
    s_addc_u32 s87, s85, 0
    v_exp_f32 v108, v108
    v_exp_f32 v109, v109
    v_exp_f32 v110, v110
    v_exp_f32 v111, v111
    v_cvt_pk_bf16_f32 v136, v104, v105
    v_cvt_pk_bf16_f32 v137, v106, v107
    v_mfma_f32_32x32x16_bf16 v[72:87], a[200:203], v[144:147], v[72:87]
    global_load_dwordx4 a[16:19], v2, s[86:87] offset:-4096
    v_exp_f32 v112, v112
    v_exp_f32 v113, v113
    v_exp_f32 v114, v114
    v_exp_f32 v115, v115
    v_cvt_pk_bf16_f32 v138, v108, v109
    v_cvt_pk_bf16_f32 v139, v110, v111
    v_mfma_f32_32x32x16_bf16 v[72:87], a[204:207], v[148:151], v[72:87]
    global_load_dwordx4 a[20:23], v2, s[86:87] offset:-3072
    v_exp_f32 v116, v116
    v_exp_f32 v117, v117
    v_exp_f32 v118, v118
    v_exp_f32 v119, v119
    v_cvt_pk_bf16_f32 v140, v112, v113
    v_cvt_pk_bf16_f32 v141, v114, v115
    v_cvt_pk_bf16_f32 v142, v116, v117
    v_cvt_pk_bf16_f32 v143, v118, v119
    v_mfma_f32_32x32x16_bf16 v[104:119], a[208:211], v[16:19], 0
    v_exp_f32 v120, v120
    v_exp_f32 v121, v121
    v_exp_f32 v122, v122
    v_exp_f32 v123, v123
    v_mfma_f32_32x32x16_bf16 v[104:119], a[212:215], v[20:23], v[104:119]
    global_load_dwordx4 a[24:27], v2, s[86:87] offset:-2048
    v_exp_f32 v124, v124
    v_exp_f32 v125, v125
    v_exp_f32 v126, v126
    v_exp_f32 v127, v127
    v_cvt_pk_bf16_f32 v144, v120, v121
    v_cvt_pk_bf16_f32 v145, v122, v123
    v_mfma_f32_32x32x16_bf16 v[88:103], a[200:203], v[136:139], v[88:103]
    global_load_dwordx4 a[28:31], v2, s[86:87] offset:-1024
    v_exp_f32 v128, v128
    v_exp_f32 v129, v129
    v_exp_f32 v130, v130
    v_exp_f32 v131, v131
    v_cvt_pk_bf16_f32 v146, v124, v125
    v_cvt_pk_bf16_f32 v147, v126, v127
    v_mfma_f32_32x32x16_bf16 v[88:103], a[204:207], v[140:143], v[88:103]
    s_add_u32 s86, s84, 8192
    s_addc_u32 s87, s85, 0
    v_exp_f32 v132, v132
    v_exp_f32 v133, v133
    v_exp_f32 v134, v134
    v_exp_f32 v135, v135
    v_cvt_pk_bf16_f32 v148, v128, v129
    v_cvt_pk_bf16_f32 v149, v130, v131
    v_cvt_pk_bf16_f32 v150, v132, v133
    v_cvt_pk_bf16_f32 v151, v134, v135
    v_mfma_f32_32x32x16_bf16 v[120:135], a[208:211], v[24:27], 0
    s_waitcnt vmcnt(56)
    v_exp_f32 v104, v104
    v_exp_f32 v105, v105
    v_exp_f32 v106, v106
    v_exp_f32 v107, v107
    v_mfma_f32_32x32x16_bf16 v[120:135], a[212:215], v[28:31], v[120:135]
    global_load_dwordx4 a[32:35], v2, s[86:87] offset:-4096
    v_exp_f32 v108, v108
    v_exp_f32 v109, v109
    v_exp_f32 v110, v110
    v_exp_f32 v111, v111
    v_cvt_pk_bf16_f32 v136, v104, v105
    v_cvt_pk_bf16_f32 v137, v106, v107
    v_mfma_f32_32x32x16_bf16 v[40:55], a[200:203], v[144:147], v[40:55]
    global_load_dwordx4 a[36:39], v2, s[86:87] offset:-3072
    v_exp_f32 v112, v112
    v_exp_f32 v113, v113
    v_exp_f32 v114, v114
    v_exp_f32 v115, v115
    v_cvt_pk_bf16_f32 v138, v108, v109
    v_cvt_pk_bf16_f32 v139, v110, v111
    v_mfma_f32_32x32x16_bf16 v[40:55], a[204:207], v[148:151], v[40:55]
    global_load_dwordx4 a[40:43], v2, s[86:87] offset:-2048
    v_exp_f32 v116, v116
    v_exp_f32 v117, v117
    v_exp_f32 v118, v118
    v_exp_f32 v119, v119
    v_cvt_pk_bf16_f32 v140, v112, v113
    v_cvt_pk_bf16_f32 v141, v114, v115
    v_cvt_pk_bf16_f32 v142, v116, v117
    v_cvt_pk_bf16_f32 v143, v118, v119
    v_mfma_f32_32x32x16_bf16 v[104:119], a[208:211], v[32:35], 0
    v_exp_f32 v120, v120
    v_exp_f32 v121, v121
    v_exp_f32 v122, v122
    v_exp_f32 v123, v123
    v_mfma_f32_32x32x16_bf16 v[104:119], a[212:215], v[36:39], v[104:119]
    global_load_dwordx4 a[44:47], v2, s[86:87] offset:-1024
    v_exp_f32 v124, v124
    v_exp_f32 v125, v125
    v_exp_f32 v126, v126
    v_exp_f32 v127, v127
    v_cvt_pk_bf16_f32 v144, v120, v121
    v_cvt_pk_bf16_f32 v145, v122, v123
    v_mfma_f32_32x32x16_bf16 v[56:71], a[216:219], v[136:139], v[56:71]
    s_add_u32 s86, s84, 12288
    s_addc_u32 s87, s85, 0
    v_exp_f32 v128, v128
    v_exp_f32 v129, v129
    v_exp_f32 v130, v130
    v_exp_f32 v131, v131
    v_cvt_pk_bf16_f32 v146, v124, v125
    v_cvt_pk_bf16_f32 v147, v126, v127
    v_mfma_f32_32x32x16_bf16 v[56:71], a[220:223], v[140:143], v[56:71]
    global_load_dwordx4 a[48:51], v2, s[86:87] offset:-4096
    v_exp_f32 v132, v132
    v_exp_f32 v133, v133
    v_exp_f32 v134, v134
    v_exp_f32 v135, v135
    v_cvt_pk_bf16_f32 v148, v128, v129
    v_cvt_pk_bf16_f32 v149, v130, v131
    v_cvt_pk_bf16_f32 v150, v132, v133
    v_cvt_pk_bf16_f32 v151, v134, v135
    v_mfma_f32_32x32x16_bf16 v[120:135], a[208:211], v[8:11], 0
    s_waitcnt vmcnt(59)
    v_exp_f32 v104, v104
    v_exp_f32 v105, v105
    v_exp_f32 v106, v106
    v_exp_f32 v107, v107
    v_mfma_f32_32x32x16_bf16 v[120:135], a[212:215], v[12:15], v[120:135]
    global_load_dwordx4 a[52:55], v2, s[86:87] offset:-3072
    v_exp_f32 v108, v108
    v_exp_f32 v109, v109
    v_exp_f32 v110, v110
    v_exp_f32 v111, v111
    v_cvt_pk_bf16_f32 v136, v104, v105
    v_cvt_pk_bf16_f32 v137, v106, v107
    v_mfma_f32_32x32x16_bf16 v[72:87], a[216:219], v[144:147], v[72:87]
    global_load_dwordx4 a[56:59], v2, s[86:87] offset:-2048
    v_exp_f32 v112, v112
    v_exp_f32 v113, v113
    v_exp_f32 v114, v114
    v_exp_f32 v115, v115
    v_cvt_pk_bf16_f32 v138, v108, v109
    v_cvt_pk_bf16_f32 v139, v110, v111
    v_mfma_f32_32x32x16_bf16 v[72:87], a[220:223], v[148:151], v[72:87]
    global_load_dwordx4 a[60:63], v2, s[86:87] offset:-1024
    v_exp_f32 v116, v116
    v_exp_f32 v117, v117
    v_exp_f32 v118, v118
    v_exp_f32 v119, v119
    v_cvt_pk_bf16_f32 v140, v112, v113
    v_cvt_pk_bf16_f32 v141, v114, v115
    v_cvt_pk_bf16_f32 v142, v116, v117
    v_cvt_pk_bf16_f32 v143, v118, v119
    v_mfma_f32_32x32x16_bf16 v[104:119], v[160:163], v[16:19], 0
    v_exp_f32 v120, v120
    v_exp_f32 v121, v121
    v_exp_f32 v122, v122
    v_exp_f32 v123, v123
    v_mfma_f32_32x32x16_bf16 v[104:119], v[164:167], v[20:23], v[104:119]
    s_add_u32 s86, s84, 16384
    s_addc_u32 s87, s85, 0
    v_exp_f32 v124, v124
    v_exp_f32 v125, v125
    v_exp_f32 v126, v126
    v_exp_f32 v127, v127
    v_cvt_pk_bf16_f32 v144, v120, v121
    v_cvt_pk_bf16_f32 v145, v122, v123
    v_mfma_f32_32x32x16_bf16 v[88:103], a[216:219], v[136:139], v[88:103]
    global_load_dwordx4 a[64:67], v2, s[86:87] offset:-4096
    v_exp_f32 v128, v128
    v_exp_f32 v129, v129
    v_exp_f32 v130, v130
    v_exp_f32 v131, v131
    v_cvt_pk_bf16_f32 v146, v124, v125
    v_cvt_pk_bf16_f32 v147, v126, v127
    v_mfma_f32_32x32x16_bf16 v[88:103], a[220:223], v[140:143], v[88:103]
    global_load_dwordx4 a[68:71], v2, s[86:87] offset:-3072
    v_exp_f32 v132, v132
    v_exp_f32 v133, v133
    v_exp_f32 v134, v134
    v_exp_f32 v135, v135
    v_cvt_pk_bf16_f32 v148, v128, v129
    v_cvt_pk_bf16_f32 v149, v130, v131
    v_cvt_pk_bf16_f32 v150, v132, v133
    v_cvt_pk_bf16_f32 v151, v134, v135
    v_mfma_f32_32x32x16_bf16 v[120:135], v[160:163], v[24:27], 0
    s_waitcnt vmcnt(61)
    v_exp_f32 v104, v104
    v_exp_f32 v105, v105
    v_exp_f32 v106, v106
    v_exp_f32 v107, v107
    v_mfma_f32_32x32x16_bf16 v[120:135], v[164:167], v[28:31], v[120:135]
    global_load_dwordx4 a[72:75], v2, s[86:87] offset:-2048
    v_exp_f32 v108, v108
    v_exp_f32 v109, v109
    v_exp_f32 v110, v110
    v_exp_f32 v111, v111
    v_cvt_pk_bf16_f32 v136, v104, v105
    v_cvt_pk_bf16_f32 v137, v106, v107
    v_mfma_f32_32x32x16_bf16 v[40:55], a[216:219], v[144:147], v[40:55]
    global_load_dword v246, v249, s[92:93] sc1
    v_exp_f32 v112, v112
    v_exp_f32 v113, v113
    v_exp_f32 v114, v114
    v_exp_f32 v115, v115
    v_cvt_pk_bf16_f32 v138, v108, v109
    v_cvt_pk_bf16_f32 v139, v110, v111
    v_mfma_f32_32x32x16_bf16 v[40:55], a[220:223], v[148:151], v[40:55]
    global_load_dwordx4 a[76:79], v2, s[86:87] offset:-1024
    v_exp_f32 v116, v116
    v_exp_f32 v117, v117
    v_exp_f32 v118, v118
    v_exp_f32 v119, v119
    v_cvt_pk_bf16_f32 v140, v112, v113
    v_cvt_pk_bf16_f32 v141, v114, v115
    v_cvt_pk_bf16_f32 v142, v116, v117
    v_cvt_pk_bf16_f32 v143, v118, v119
    v_mfma_f32_32x32x16_bf16 v[104:119], v[160:163], v[32:35], 0
    v_exp_f32 v120, v120
    v_exp_f32 v121, v121
    v_exp_f32 v122, v122
    v_exp_f32 v123, v123
    v_mfma_f32_32x32x16_bf16 v[104:119], v[164:167], v[36:39], v[104:119]
    v_exp_f32 v124, v124
    v_exp_f32 v125, v125
    v_exp_f32 v126, v126
    v_exp_f32 v127, v127
    v_cvt_pk_bf16_f32 v144, v120, v121
    v_cvt_pk_bf16_f32 v145, v122, v123
    v_mfma_f32_32x32x16_bf16 v[56:71], v[168:171], v[136:139], v[56:71]
    s_add_u32 s86, s84, 20480
    s_addc_u32 s87, s85, 0
    v_exp_f32 v128, v128
    v_exp_f32 v129, v129
    v_exp_f32 v130, v130
    v_exp_f32 v131, v131
    v_cvt_pk_bf16_f32 v146, v124, v125
    v_cvt_pk_bf16_f32 v147, v126, v127
    v_mfma_f32_32x32x16_bf16 v[56:71], v[172:175], v[140:143], v[56:71]
    global_load_dwordx4 a[80:83], v2, s[86:87] offset:-4096
    v_exp_f32 v132, v132
    v_exp_f32 v133, v133
    v_exp_f32 v134, v134
    v_exp_f32 v135, v135
    v_cvt_pk_bf16_f32 v148, v128, v129
    v_cvt_pk_bf16_f32 v149, v130, v131
    v_cvt_pk_bf16_f32 v150, v132, v133
    v_cvt_pk_bf16_f32 v151, v134, v135
    v_mfma_f32_32x32x16_bf16 v[120:135], v[160:163], v[8:11], 0
    s_waitcnt vmcnt(59)
    v_exp_f32 v104, v104
    v_exp_f32 v105, v105
    v_exp_f32 v106, v106
    v_exp_f32 v107, v107
    v_mfma_f32_32x32x16_bf16 v[120:135], v[164:167], v[12:15], v[120:135]
    global_load_dwordx4 a[84:87], v2, s[86:87] offset:-3072
    v_exp_f32 v108, v108
    v_exp_f32 v109, v109
    v_exp_f32 v110, v110
    v_exp_f32 v111, v111
    v_cvt_pk_bf16_f32 v136, v104, v105
    v_cvt_pk_bf16_f32 v137, v106, v107
    v_mfma_f32_32x32x16_bf16 v[72:87], v[168:171], v[144:147], v[72:87]
    global_load_dwordx4 a[88:91], v2, s[86:87] offset:-2048
    v_exp_f32 v112, v112
    v_exp_f32 v113, v113
    v_exp_f32 v114, v114
    v_exp_f32 v115, v115
    v_cvt_pk_bf16_f32 v138, v108, v109
    v_cvt_pk_bf16_f32 v139, v110, v111
    v_mfma_f32_32x32x16_bf16 v[72:87], v[172:175], v[148:151], v[72:87]
    global_load_dwordx4 a[92:95], v2, s[86:87] offset:-1024
    v_exp_f32 v116, v116
    v_exp_f32 v117, v117
    v_exp_f32 v118, v118
    v_exp_f32 v119, v119
    v_cvt_pk_bf16_f32 v140, v112, v113
    v_cvt_pk_bf16_f32 v141, v114, v115
    v_cvt_pk_bf16_f32 v142, v116, v117
    v_cvt_pk_bf16_f32 v143, v118, v119
    v_mfma_f32_32x32x16_bf16 v[104:119], v[176:179], v[16:19], 0
    v_exp_f32 v120, v120
    v_exp_f32 v121, v121
    v_exp_f32 v122, v122
    v_exp_f32 v123, v123
    v_mfma_f32_32x32x16_bf16 v[104:119], v[180:183], v[20:23], v[104:119]
    s_add_u32 s86, s84, 28672
    s_addc_u32 s87, s85, 0
    v_exp_f32 v124, v124
    v_exp_f32 v125, v125
    v_exp_f32 v126, v126
    v_exp_f32 v127, v127
    v_cvt_pk_bf16_f32 v144, v120, v121
    v_cvt_pk_bf16_f32 v145, v122, v123
    v_mfma_f32_32x32x16_bf16 v[88:103], v[168:171], v[136:139], v[88:103]
    global_load_dwordx4 a[96:99], v2, s[86:87] offset:-4096
    v_exp_f32 v128, v128
    v_exp_f32 v129, v129
    v_exp_f32 v130, v130
    v_exp_f32 v131, v131
    v_cvt_pk_bf16_f32 v146, v124, v125
    v_cvt_pk_bf16_f32 v147, v126, v127
    v_mfma_f32_32x32x16_bf16 v[88:103], v[172:175], v[140:143], v[88:103]
    global_load_dwordx4 a[100:103], v2, s[86:87] offset:-3072
    v_exp_f32 v132, v132
    v_exp_f32 v133, v133
    v_exp_f32 v134, v134
    v_exp_f32 v135, v135
    v_cvt_pk_bf16_f32 v148, v128, v129
    v_cvt_pk_bf16_f32 v149, v130, v131
    v_cvt_pk_bf16_f32 v150, v132, v133
    v_cvt_pk_bf16_f32 v151, v134, v135
    v_mfma_f32_32x32x16_bf16 v[120:135], v[176:179], v[24:27], 0
    s_waitcnt vmcnt(58)
    v_exp_f32 v104, v104
    v_exp_f32 v105, v105
    v_exp_f32 v106, v106
    v_exp_f32 v107, v107
    v_mfma_f32_32x32x16_bf16 v[120:135], v[180:183], v[28:31], v[120:135]
    global_load_dwordx4 a[104:107], v2, s[86:87] offset:-2048
    v_exp_f32 v108, v108
    v_exp_f32 v109, v109
    v_exp_f32 v110, v110
    v_exp_f32 v111, v111
    v_cvt_pk_bf16_f32 v136, v104, v105
    v_cvt_pk_bf16_f32 v137, v106, v107
    v_mfma_f32_32x32x16_bf16 v[40:55], v[168:171], v[144:147], v[40:55]
    global_load_dwordx4 a[108:111], v2, s[86:87] offset:-1024
    v_exp_f32 v112, v112
    v_exp_f32 v113, v113
    v_exp_f32 v114, v114
    v_exp_f32 v115, v115
    v_cvt_pk_bf16_f32 v138, v108, v109
    v_cvt_pk_bf16_f32 v139, v110, v111
    v_mfma_f32_32x32x16_bf16 v[40:55], v[172:175], v[148:151], v[40:55]
    s_add_u32 s86, s84, 32768
    s_addc_u32 s87, s85, 0
    v_exp_f32 v116, v116
    v_exp_f32 v117, v117
    v_exp_f32 v118, v118
    v_exp_f32 v119, v119
    v_cvt_pk_bf16_f32 v140, v112, v113
    v_cvt_pk_bf16_f32 v141, v114, v115
    v_cvt_pk_bf16_f32 v142, v116, v117
    v_cvt_pk_bf16_f32 v143, v118, v119
    v_mfma_f32_32x32x16_bf16 v[104:119], v[176:179], v[32:35], 0
    v_exp_f32 v120, v120
    v_exp_f32 v121, v121
    v_exp_f32 v122, v122
    v_exp_f32 v123, v123
    v_mfma_f32_32x32x16_bf16 v[104:119], v[180:183], v[36:39], v[104:119]
    global_load_dwordx4 a[112:115], v2, s[86:87] offset:-4096
    v_exp_f32 v124, v124
    v_exp_f32 v125, v125
    v_exp_f32 v126, v126
    v_exp_f32 v127, v127
    v_cvt_pk_bf16_f32 v144, v120, v121
    v_cvt_pk_bf16_f32 v145, v122, v123
    v_mfma_f32_32x32x16_bf16 v[56:71], v[184:187], v[136:139], v[56:71]
    global_load_dwordx4 a[116:119], v2, s[86:87] offset:-3072
    v_exp_f32 v128, v128
    v_exp_f32 v129, v129
    v_exp_f32 v130, v130
    v_exp_f32 v131, v131
    v_cvt_pk_bf16_f32 v146, v124, v125
    v_cvt_pk_bf16_f32 v147, v126, v127
    v_mfma_f32_32x32x16_bf16 v[56:71], v[188:191], v[140:143], v[56:71]
    global_load_dwordx4 a[120:123], v2, s[86:87] offset:-2048
    v_exp_f32 v132, v132
    v_exp_f32 v133, v133
    v_exp_f32 v134, v134
    v_exp_f32 v135, v135
    v_cvt_pk_bf16_f32 v148, v128, v129
    v_cvt_pk_bf16_f32 v149, v130, v131
    v_cvt_pk_bf16_f32 v150, v132, v133
    v_cvt_pk_bf16_f32 v151, v134, v135
    v_mfma_f32_32x32x16_bf16 v[120:135], v[176:179], v[8:11], 0
    s_waitcnt vmcnt(59)
    v_exp_f32 v104, v104
    v_exp_f32 v105, v105
    v_exp_f32 v106, v106
    v_exp_f32 v107, v107
    v_mfma_f32_32x32x16_bf16 v[120:135], v[180:183], v[12:15], v[120:135]
    global_load_dwordx4 a[124:127], v2, s[86:87] offset:-1024
    v_exp_f32 v108, v108
    v_exp_f32 v109, v109
    v_exp_f32 v110, v110
    v_exp_f32 v111, v111
    v_cvt_pk_bf16_f32 v136, v104, v105
    v_cvt_pk_bf16_f32 v137, v106, v107
    v_mfma_f32_32x32x16_bf16 v[72:87], v[184:187], v[144:147], v[72:87]
    s_add_u32 s86, s84, 36864
    s_addc_u32 s87, s85, 0
    v_exp_f32 v112, v112
    v_exp_f32 v113, v113
    v_exp_f32 v114, v114
    v_exp_f32 v115, v115
    v_cvt_pk_bf16_f32 v138, v108, v109
    v_cvt_pk_bf16_f32 v139, v110, v111
    v_mfma_f32_32x32x16_bf16 v[72:87], v[188:191], v[148:151], v[72:87]
    global_load_dwordx4 a[128:131], v2, s[86:87] offset:-4096
    v_exp_f32 v116, v116
    v_exp_f32 v117, v117
    v_exp_f32 v118, v118
    v_exp_f32 v119, v119
    v_cvt_pk_bf16_f32 v140, v112, v113
    v_cvt_pk_bf16_f32 v141, v114, v115
    v_cvt_pk_bf16_f32 v142, v116, v117
    v_cvt_pk_bf16_f32 v143, v118, v119
    v_mfma_f32_32x32x16_bf16 v[104:119], v[192:195], v[16:19], 0
    v_exp_f32 v120, v120
    v_exp_f32 v121, v121
    v_exp_f32 v122, v122
    v_exp_f32 v123, v123
    v_mfma_f32_32x32x16_bf16 v[104:119], v[196:199], v[20:23], v[104:119]
    global_load_dwordx4 a[132:135], v2, s[86:87] offset:-3072
    v_exp_f32 v124, v124
    v_exp_f32 v125, v125
    v_exp_f32 v126, v126
    v_exp_f32 v127, v127
    v_cvt_pk_bf16_f32 v144, v120, v121
    v_cvt_pk_bf16_f32 v145, v122, v123
    v_mfma_f32_32x32x16_bf16 v[88:103], v[184:187], v[136:139], v[88:103]
    global_load_dwordx4 a[136:139], v2, s[86:87] offset:-2048
    v_exp_f32 v128, v128
    v_exp_f32 v129, v129
    v_exp_f32 v130, v130
    v_exp_f32 v131, v131
    v_cvt_pk_bf16_f32 v146, v124, v125
    v_cvt_pk_bf16_f32 v147, v126, v127
    v_mfma_f32_32x32x16_bf16 v[88:103], v[188:191], v[140:143], v[88:103]
    global_load_dwordx4 a[140:143], v2, s[86:87] offset:-1024
    v_exp_f32 v132, v132
    v_exp_f32 v133, v133
    v_exp_f32 v134, v134
    v_exp_f32 v135, v135
    v_cvt_pk_bf16_f32 v148, v128, v129
    v_cvt_pk_bf16_f32 v149, v130, v131
    v_cvt_pk_bf16_f32 v150, v132, v133
    v_cvt_pk_bf16_f32 v151, v134, v135
    v_mfma_f32_32x32x16_bf16 v[120:135], v[192:195], v[24:27], 0
    s_waitcnt vmcnt(58)
    v_exp_f32 v104, v104
    v_exp_f32 v105, v105
    v_exp_f32 v106, v106
    v_exp_f32 v107, v107
    v_mfma_f32_32x32x16_bf16 v[120:135], v[196:199], v[28:31], v[120:135]
    s_add_u32 s86, s84, 40960
    s_addc_u32 s87, s85, 0
    v_exp_f32 v108, v108
    v_exp_f32 v109, v109
    v_exp_f32 v110, v110
    v_exp_f32 v111, v111
    v_cvt_pk_bf16_f32 v136, v104, v105
    v_cvt_pk_bf16_f32 v137, v106, v107
    v_mfma_f32_32x32x16_bf16 v[40:55], v[184:187], v[144:147], v[40:55]
    global_load_dwordx4 a[144:147], v2, s[86:87] offset:-4096
    v_exp_f32 v112, v112
    v_exp_f32 v113, v113
    v_exp_f32 v114, v114
    v_exp_f32 v115, v115
    v_cvt_pk_bf16_f32 v138, v108, v109
    v_cvt_pk_bf16_f32 v139, v110, v111
    v_mfma_f32_32x32x16_bf16 v[40:55], v[188:191], v[148:151], v[40:55]
    global_load_dwordx4 a[148:151], v2, s[86:87] offset:-3072
    v_exp_f32 v116, v116
    v_exp_f32 v117, v117
    v_exp_f32 v118, v118
    v_exp_f32 v119, v119
    v_cvt_pk_bf16_f32 v140, v112, v113
    v_cvt_pk_bf16_f32 v141, v114, v115
    v_cvt_pk_bf16_f32 v142, v116, v117
    v_cvt_pk_bf16_f32 v143, v118, v119
    v_mfma_f32_32x32x16_bf16 v[104:119], v[192:195], v[32:35], 0
    v_exp_f32 v120, v120
    v_exp_f32 v121, v121
    v_exp_f32 v122, v122
    v_exp_f32 v123, v123
    v_mfma_f32_32x32x16_bf16 v[104:119], v[196:199], v[36:39], v[104:119]
    global_load_dword v246, v248, s[92:93] sc1
    v_exp_f32 v124, v124
    v_exp_f32 v125, v125
    v_exp_f32 v126, v126
    v_exp_f32 v127, v127
    v_cvt_pk_bf16_f32 v144, v120, v121
    v_cvt_pk_bf16_f32 v145, v122, v123
    v_mfma_f32_32x32x16_bf16 v[56:71], v[200:203], v[136:139], v[56:71]
    v_exp_f32 v128, v128
    v_exp_f32 v129, v129
    v_exp_f32 v130, v130
    v_exp_f32 v131, v131
    v_cvt_pk_bf16_f32 v146, v124, v125
    v_cvt_pk_bf16_f32 v147, v126, v127
    v_mfma_f32_32x32x16_bf16 v[56:71], v[204:207], v[140:143], v[56:71]
    global_load_dwordx4 a[152:155], v2, s[86:87] offset:-2048
    v_exp_f32 v132, v132
    v_exp_f32 v133, v133
    v_exp_f32 v134, v134
    v_exp_f32 v135, v135
    v_cvt_pk_bf16_f32 v148, v128, v129
    v_cvt_pk_bf16_f32 v149, v130, v131
    v_cvt_pk_bf16_f32 v150, v132, v133
    v_cvt_pk_bf16_f32 v151, v134, v135
    v_mfma_f32_32x32x16_bf16 v[120:135], v[192:195], v[8:11], 0
    s_waitcnt vmcnt(57)
    v_exp_f32 v104, v104
    v_exp_f32 v105, v105
    v_exp_f32 v106, v106
    v_exp_f32 v107, v107
    v_mfma_f32_32x32x16_bf16 v[120:135], v[196:199], v[12:15], v[120:135]
    global_load_dwordx4 a[156:159], v2, s[86:87] offset:-1024
    v_exp_f32 v108, v108
    v_exp_f32 v109, v109
    v_exp_f32 v110, v110
    v_exp_f32 v111, v111
    v_cvt_pk_bf16_f32 v136, v104, v105
    v_cvt_pk_bf16_f32 v137, v106, v107
    v_mfma_f32_32x32x16_bf16 v[72:87], v[200:203], v[144:147], v[72:87]
    s_add_u32 s86, s84, 45056
    s_addc_u32 s87, s85, 0
    v_exp_f32 v112, v112
    v_exp_f32 v113, v113
    v_exp_f32 v114, v114
    v_exp_f32 v115, v115
    v_cvt_pk_bf16_f32 v138, v108, v109
    v_cvt_pk_bf16_f32 v139, v110, v111
    v_mfma_f32_32x32x16_bf16 v[72:87], v[204:207], v[148:151], v[72:87]
    global_load_dwordx4 a[160:163], v2, s[86:87] offset:-4096
    v_exp_f32 v116, v116
    v_exp_f32 v117, v117
    v_exp_f32 v118, v118
    v_exp_f32 v119, v119
    v_cvt_pk_bf16_f32 v140, v112, v113
    v_cvt_pk_bf16_f32 v141, v114, v115
    v_cvt_pk_bf16_f32 v142, v116, v117
    v_cvt_pk_bf16_f32 v143, v118, v119
    v_mfma_f32_32x32x16_bf16 v[104:119], v[208:211], v[16:19], 0
    v_exp_f32 v120, v120
    v_exp_f32 v121, v121
    v_exp_f32 v122, v122
    v_exp_f32 v123, v123
    v_mfma_f32_32x32x16_bf16 v[104:119], v[212:215], v[20:23], v[104:119]
    global_load_dwordx4 a[164:167], v2, s[86:87] offset:-3072
    v_exp_f32 v124, v124
    v_exp_f32 v125, v125
    v_exp_f32 v126, v126
    v_exp_f32 v127, v127
    v_cvt_pk_bf16_f32 v144, v120, v121
    v_cvt_pk_bf16_f32 v145, v122, v123
    v_mfma_f32_32x32x16_bf16 v[88:103], v[200:203], v[136:139], v[88:103]
    global_load_dwordx4 a[168:171], v2, s[86:87] offset:-2048
    v_exp_f32 v128, v128
    v_exp_f32 v129, v129
    v_exp_f32 v130, v130
    v_exp_f32 v131, v131
    v_cvt_pk_bf16_f32 v146, v124, v125
    v_cvt_pk_bf16_f32 v147, v126, v127
    v_mfma_f32_32x32x16_bf16 v[88:103], v[204:207], v[140:143], v[88:103]
    global_load_dwordx4 a[172:175], v2, s[86:87] offset:-1024
    v_exp_f32 v132, v132
    v_exp_f32 v133, v133
    v_exp_f32 v134, v134
    v_exp_f32 v135, v135
    v_cvt_pk_bf16_f32 v148, v128, v129
    v_cvt_pk_bf16_f32 v149, v130, v131
    v_cvt_pk_bf16_f32 v150, v132, v133
    v_cvt_pk_bf16_f32 v151, v134, v135
    v_mfma_f32_32x32x16_bf16 v[120:135], v[208:211], v[24:27], 0
    s_waitcnt vmcnt(57)
    v_exp_f32 v104, v104
    v_exp_f32 v105, v105
    v_exp_f32 v106, v106
    v_exp_f32 v107, v107
    v_mfma_f32_32x32x16_bf16 v[120:135], v[212:215], v[28:31], v[120:135]
    s_add_u32 s86, s84, 49152
    s_addc_u32 s87, s85, 0
    v_exp_f32 v108, v108
    v_exp_f32 v109, v109
    v_exp_f32 v110, v110
    v_exp_f32 v111, v111
    v_cvt_pk_bf16_f32 v136, v104, v105
    v_cvt_pk_bf16_f32 v137, v106, v107
    v_mfma_f32_32x32x16_bf16 v[40:55], v[200:203], v[144:147], v[40:55]
    global_load_dwordx4 a[176:179], v2, s[86:87] offset:-4096
    v_exp_f32 v112, v112
    v_exp_f32 v113, v113
    v_exp_f32 v114, v114
    v_exp_f32 v115, v115
    v_cvt_pk_bf16_f32 v138, v108, v109
    v_cvt_pk_bf16_f32 v139, v110, v111
    v_mfma_f32_32x32x16_bf16 v[40:55], v[204:207], v[148:151], v[40:55]
    global_load_dwordx4 a[180:183], v2, s[86:87] offset:-3072
    v_exp_f32 v116, v116
    v_exp_f32 v117, v117
    v_exp_f32 v118, v118
    v_exp_f32 v119, v119
    v_cvt_pk_bf16_f32 v140, v112, v113
    v_cvt_pk_bf16_f32 v141, v114, v115
    v_cvt_pk_bf16_f32 v142, v116, v117
    v_cvt_pk_bf16_f32 v143, v118, v119
    v_mfma_f32_32x32x16_bf16 v[104:119], v[208:211], v[32:35], 0
    v_exp_f32 v120, v120
    v_exp_f32 v121, v121
    v_exp_f32 v122, v122
    v_exp_f32 v123, v123
    v_mfma_f32_32x32x16_bf16 v[104:119], v[212:215], v[36:39], v[104:119]
    global_load_dwordx4 a[184:187], v2, s[86:87] offset:-2048
    v_exp_f32 v124, v124
    v_exp_f32 v125, v125
    v_exp_f32 v126, v126
    v_exp_f32 v127, v127
    v_cvt_pk_bf16_f32 v144, v120, v121
    v_cvt_pk_bf16_f32 v145, v122, v123
    v_mfma_f32_32x32x16_bf16 v[56:71], v[216:219], v[136:139], v[56:71]
    global_load_dwordx4 a[188:191], v2, s[86:87] offset:-1024
    v_exp_f32 v128, v128
    v_exp_f32 v129, v129
    v_exp_f32 v130, v130
    v_exp_f32 v131, v131
    v_cvt_pk_bf16_f32 v146, v124, v125
    v_cvt_pk_bf16_f32 v147, v126, v127
    v_mfma_f32_32x32x16_bf16 v[56:71], v[220:223], v[140:143], v[56:71]
    s_add_u32 s86, s84, 24576
    s_addc_u32 s87, s85, 0
    v_exp_f32 v132, v132
    v_exp_f32 v133, v133
    v_exp_f32 v134, v134
    v_exp_f32 v135, v135
    v_cvt_pk_bf16_f32 v148, v128, v129
    v_cvt_pk_bf16_f32 v149, v130, v131
    v_cvt_pk_bf16_f32 v150, v132, v133
    v_cvt_pk_bf16_f32 v151, v134, v135
    v_mfma_f32_32x32x16_bf16 v[120:135], v[208:211], v[8:11], 0
    s_waitcnt vmcnt(56)
    v_exp_f32 v104, v104
    v_exp_f32 v105, v105
    v_exp_f32 v106, v106
    v_exp_f32 v107, v107
    v_mfma_f32_32x32x16_bf16 v[120:135], v[212:215], v[12:15], v[120:135]
    global_load_dwordx4 a[192:195], v2, s[86:87] offset:-4096
    v_exp_f32 v108, v108
    v_exp_f32 v109, v109
    v_exp_f32 v110, v110
    v_exp_f32 v111, v111
    v_cvt_pk_bf16_f32 v136, v104, v105
    v_cvt_pk_bf16_f32 v137, v106, v107
    v_mfma_f32_32x32x16_bf16 v[72:87], v[216:219], v[144:147], v[72:87]
    global_load_dwordx4 a[196:199], v2, s[86:87] offset:-3072
    v_exp_f32 v112, v112
    v_exp_f32 v113, v113
    v_exp_f32 v114, v114
    v_exp_f32 v115, v115
    v_cvt_pk_bf16_f32 v138, v108, v109
    v_cvt_pk_bf16_f32 v139, v110, v111
    v_mfma_f32_32x32x16_bf16 v[72:87], v[220:223], v[148:151], v[72:87]
    global_load_dwordx4 a[200:203], v2, s[86:87] offset:-2048
    v_exp_f32 v116, v116
    v_exp_f32 v117, v117
    v_exp_f32 v118, v118
    v_exp_f32 v119, v119
    v_cvt_pk_bf16_f32 v140, v112, v113
    v_cvt_pk_bf16_f32 v141, v114, v115
    v_cvt_pk_bf16_f32 v142, v116, v117
    v_cvt_pk_bf16_f32 v143, v118, v119
    v_mfma_f32_32x32x16_bf16 v[104:119], v[224:227], v[16:19], 0
    v_exp_f32 v120, v120
    v_exp_f32 v121, v121
    v_exp_f32 v122, v122
    v_exp_f32 v123, v123
    v_mfma_f32_32x32x16_bf16 v[104:119], v[228:231], v[20:23], v[104:119]
    global_load_dwordx4 a[204:207], v2, s[86:87] offset:-1024
    v_exp_f32 v124, v124
    v_exp_f32 v125, v125
    v_exp_f32 v126, v126
    v_exp_f32 v127, v127
    v_cvt_pk_bf16_f32 v144, v120, v121
    v_cvt_pk_bf16_f32 v145, v122, v123
    v_mfma_f32_32x32x16_bf16 v[88:103], v[216:219], v[136:139], v[88:103]
    s_add_u32 s86, s84, 53248
    s_addc_u32 s87, s85, 0
    v_exp_f32 v128, v128
    v_exp_f32 v129, v129
    v_exp_f32 v130, v130
    v_exp_f32 v131, v131
    v_cvt_pk_bf16_f32 v146, v124, v125
    v_cvt_pk_bf16_f32 v147, v126, v127
    v_mfma_f32_32x32x16_bf16 v[88:103], v[220:223], v[140:143], v[88:103]
    global_load_dwordx4 a[208:211], v2, s[86:87] offset:-4096
    v_exp_f32 v132, v132
    v_exp_f32 v133, v133
    v_exp_f32 v134, v134
    v_exp_f32 v135, v135
    v_cvt_pk_bf16_f32 v148, v128, v129
    v_cvt_pk_bf16_f32 v149, v130, v131
    v_cvt_pk_bf16_f32 v150, v132, v133
    v_cvt_pk_bf16_f32 v151, v134, v135
    v_mfma_f32_32x32x16_bf16 v[120:135], v[224:227], v[24:27], 0
    s_waitcnt vmcnt(56)
    v_exp_f32 v104, v104
    v_exp_f32 v105, v105
    v_exp_f32 v106, v106
    v_exp_f32 v107, v107
    v_mfma_f32_32x32x16_bf16 v[120:135], v[228:231], v[28:31], v[120:135]
    global_load_dwordx4 a[212:215], v2, s[86:87] offset:-3072
    v_exp_f32 v108, v108
    v_exp_f32 v109, v109
    v_exp_f32 v110, v110
    v_exp_f32 v111, v111
    v_cvt_pk_bf16_f32 v136, v104, v105
    v_cvt_pk_bf16_f32 v137, v106, v107
    v_mfma_f32_32x32x16_bf16 v[40:55], v[216:219], v[144:147], v[40:55]
    global_load_dwordx4 a[216:219], v2, s[86:87] offset:-2048
    v_exp_f32 v112, v112
    v_exp_f32 v113, v113
    v_exp_f32 v114, v114
    v_exp_f32 v115, v115
    v_cvt_pk_bf16_f32 v138, v108, v109
    v_cvt_pk_bf16_f32 v139, v110, v111
    v_mfma_f32_32x32x16_bf16 v[40:55], v[220:223], v[148:151], v[40:55]
    global_load_dwordx4 a[220:223], v2, s[86:87] offset:-1024
    v_exp_f32 v116, v116
    v_exp_f32 v117, v117
    v_exp_f32 v118, v118
    v_exp_f32 v119, v119
    v_cvt_pk_bf16_f32 v140, v112, v113
    v_cvt_pk_bf16_f32 v141, v114, v115
    v_cvt_pk_bf16_f32 v142, v116, v117
    v_cvt_pk_bf16_f32 v143, v118, v119
    v_mfma_f32_32x32x16_bf16 v[104:119], v[224:227], v[32:35], 0
    v_exp_f32 v120, v120
    v_exp_f32 v121, v121
    v_exp_f32 v122, v122
    v_exp_f32 v123, v123
    v_mfma_f32_32x32x16_bf16 v[104:119], v[228:231], v[36:39], v[104:119]
    buffer_load_dword v253, v252, s[4:7], 0 offen sc1
    v_exp_f32 v124, v124
    v_exp_f32 v125, v125
    v_exp_f32 v126, v126
    v_exp_f32 v127, v127
    v_cvt_pk_bf16_f32 v144, v120, v121
    v_cvt_pk_bf16_f32 v145, v122, v123
    v_mfma_f32_32x32x16_bf16 v[56:71], v[232:235], v[136:139], v[56:71]
    global_load_dword v246, v244, s[80:81] sc1
    v_exp_f32 v128, v128
    v_exp_f32 v129, v129
    v_exp_f32 v130, v130
    v_exp_f32 v131, v131
    v_cvt_pk_bf16_f32 v146, v124, v125
    v_cvt_pk_bf16_f32 v147, v126, v127
    v_mfma_f32_32x32x16_bf16 v[56:71], v[236:239], v[140:143], v[56:71]
    v_exp_f32 v132, v132
    v_exp_f32 v133, v133
    v_exp_f32 v134, v134
    v_exp_f32 v135, v135
    v_cvt_pk_bf16_f32 v148, v128, v129
    v_cvt_pk_bf16_f32 v149, v130, v131
    v_cvt_pk_bf16_f32 v150, v132, v133
    v_cvt_pk_bf16_f32 v151, v134, v135
    v_mfma_f32_32x32x16_bf16 v[120:135], v[224:227], v[8:11], 0
    v_exp_f32 v104, v104
    v_exp_f32 v105, v105
    v_exp_f32 v106, v106
    v_exp_f32 v107, v107
    v_mfma_f32_32x32x16_bf16 v[120:135], v[228:231], v[12:15], v[120:135]
    v_exp_f32 v108, v108
    v_exp_f32 v109, v109
    v_exp_f32 v110, v110
    v_exp_f32 v111, v111
    v_cvt_pk_bf16_f32 v136, v104, v105
    v_cvt_pk_bf16_f32 v137, v106, v107
    v_mfma_f32_32x32x16_bf16 v[72:87], v[232:235], v[144:147], v[72:87]
    ds_write_b128 v241, v[56:59] offset:0
    ds_write_b128 v241, v[60:63] offset:1024
    v_exp_f32 v112, v112
    v_exp_f32 v113, v113
    v_exp_f32 v114, v114
    v_exp_f32 v115, v115
    v_cvt_pk_bf16_f32 v138, v108, v109
    v_cvt_pk_bf16_f32 v139, v110, v111
    v_mfma_f32_32x32x16_bf16 v[72:87], v[236:239], v[148:151], v[72:87]
    ds_write_b128 v241, v[64:67] offset:2048
    ds_write_b128 v241, v[68:71] offset:3072
    v_exp_f32 v116, v116
    v_exp_f32 v117, v117
    v_exp_f32 v118, v118
    v_exp_f32 v119, v119
    v_cvt_pk_bf16_f32 v140, v112, v113
    v_cvt_pk_bf16_f32 v141, v114, v115
    v_cvt_pk_bf16_f32 v142, v116, v117
    v_cvt_pk_bf16_f32 v143, v118, v119
    v_exp_f32 v120, v120
    v_exp_f32 v121, v121
    v_exp_f32 v122, v122
    v_exp_f32 v123, v123
    v_exp_f32 v124, v124
    v_exp_f32 v125, v125
    v_exp_f32 v126, v126
    v_exp_f32 v127, v127
    v_cvt_pk_bf16_f32 v144, v120, v121
    v_cvt_pk_bf16_f32 v145, v122, v123
    v_mfma_f32_32x32x16_bf16 v[88:103], v[232:235], v[136:139], v[88:103]
    ds_write_b128 v242, v[72:75] offset:4096
    ds_write_b128 v242, v[76:79] offset:5120
    v_exp_f32 v128, v128
    v_exp_f32 v129, v129
    v_exp_f32 v130, v130
    v_exp_f32 v131, v131
    v_cvt_pk_bf16_f32 v146, v124, v125
    v_cvt_pk_bf16_f32 v147, v126, v127
    v_mfma_f32_32x32x16_bf16 v[88:103], v[236:239], v[140:143], v[88:103]
    ds_write_b128 v242, v[80:83] offset:6144
    ds_write_b128 v242, v[84:87] offset:7168
    v_exp_f32 v132, v132
    v_exp_f32 v133, v133
    v_exp_f32 v134, v134
    v_exp_f32 v135, v135
    v_cvt_pk_bf16_f32 v148, v128, v129
    v_cvt_pk_bf16_f32 v149, v130, v131
    v_cvt_pk_bf16_f32 v150, v132, v133
    v_cvt_pk_bf16_f32 v151, v134, v135
    v_mfma_f32_32x32x16_bf16 v[40:55], v[232:235], v[144:147], v[40:55]
    s_nop 0
    v_mfma_f32_32x32x16_bf16 v[40:55], v[236:239], v[148:151], v[40:55]
    ds_write_b128 v243, v[88:91] offset:8192
    ds_write_b128 v243, v[92:95] offset:9216
    ds_write_b128 v243, v[96:99] offset:10240
    ds_write_b128 v243, v[100:103] offset:11264
    s_mov_b32 s57, 200000
cen_p:
    s_waitcnt vmcnt(1)
    v_readfirstlane_b32 s56, v253
    s_nop 0
    s_and_b32 s58, s56, 0xff
    s_cmp_ge_u32 s58, 16
    s_cbranch_scc1 cen_q
    s_sub_u32 s57, s57, 1
    s_cmp_eq_u32 s57, 0
    s_cbranch_scc1 cen_q
    buffer_load_dword v253, v252, s[4:7], 0 offen sc1
    s_waitcnt vmcnt(0)
    s_branch cen_p
cen_q:
    s_cmp_eq_u32 s56, s82
    s_cselect_b32 s83, 1, 0
x_common:
    s_waitcnt lgkmcnt(0)
    s_barrier
    s_mov_b32 s64, 0
    ds_read_b128 v[68:71], v240 offset:3072
    ds_read_b128 v[84:87], v240 offset:7168
    ds_read_b128 v[100:103], v240 offset:11264
    ds_read_b128 v[60:63], v240 offset:1024
    ds_read_b128 v[76:79], v240 offset:5120
    ds_read_b128 v[92:95], v240 offset:9216
    ds_read_b128 v[56:59], v240 offset:0
    ds_read_b128 v[72:75], v240 offset:4096
    ds_read_b128 v[88:91], v240 offset:8192
    ds_read_b128 v[64:67], v240 offset:2048
    ds_read_b128 v[80:83], v240 offset:6144
    ds_read_b128 v[96:99], v240 offset:10240
    s_waitcnt lgkmcnt(11)
    v_pk_add_f32 v[52:53], v[52:53], v[68:69]
    v_pk_add_f32 v[54:55], v[54:55], v[70:71]
    s_waitcnt lgkmcnt(10)
    v_pk_add_f32 v[52:53], v[52:53], v[84:85]
    v_pk_add_f32 v[54:55], v[54:55], v[86:87]
    s_waitcnt lgkmcnt(9)
    v_pk_add_f32 v[52:53], v[52:53], v[100:101]
    v_pk_add_f32 v[54:55], v[54:55], v[102:103]
    v_mov_b32 v226, v52
    v_mov_b32 v227, v52
    s_waitcnt lgkmcnt(8)
    v_pk_add_f32 v[44:45], v[44:45], v[60:61]
    v_pk_add_f32 v[46:47], v[46:47], v[62:63]
    s_waitcnt lgkmcnt(7)
    v_pk_add_f32 v[44:45], v[44:45], v[76:77]
    v_pk_add_f32 v[46:47], v[46:47], v[78:79]
    s_waitcnt lgkmcnt(6)
    v_pk_add_f32 v[44:45], v[44:45], v[92:93]
    v_pk_add_f32 v[46:47], v[46:47], v[94:95]
    v_permlane32_swap_b32 v226, v227
    s_waitcnt lgkmcnt(5)
    v_pk_add_f32 v[40:41], v[40:41], v[56:57]
    v_pk_add_f32 v[42:43], v[42:43], v[58:59]
    s_waitcnt lgkmcnt(4)
    v_pk_add_f32 v[40:41], v[40:41], v[72:73]
    v_pk_add_f32 v[42:43], v[42:43], v[74:75]
    s_waitcnt lgkmcnt(3)
    v_pk_add_f32 v[40:41], v[40:41], v[88:89]
    v_pk_add_f32 v[42:43], v[42:43], v[90:91]
    s_waitcnt lgkmcnt(2)
    v_pk_add_f32 v[48:49], v[48:49], v[64:65]
    v_pk_add_f32 v[50:51], v[50:51], v[66:67]
    s_waitcnt lgkmcnt(1)
    v_pk_add_f32 v[48:49], v[48:49], v[80:81]
    v_pk_add_f32 v[50:51], v[50:51], v[82:83]
    s_waitcnt lgkmcnt(0)
    v_pk_add_f32 v[48:49], v[48:49], v[96:97]
    v_pk_add_f32 v[50:51], v[50:51], v[98:99]
attn_fin:
    v_rcp_f32 v224, v227
    v_rcp_f32 v225, v227
    s_nop 2
    v_pk_mul_f32 v[44:45], v[44:45], v[224:225]
    v_pk_mul_f32 v[46:47], v[46:47], v[224:225]
    v_cvt_pk_bf16_f32 v60, v44, v45
    v_cvt_pk_bf16_f32 v61, v46, v47
    v_pk_mul_f32 v[52:53], v[52:53], v[224:225]
    v_pk_mul_f32 v[54:55], v[54:55], v[224:225]
    v_cvt_pk_bf16_f32 v62, v52, v53
    v_cvt_pk_bf16_f32 v63, v54, v55
    buffer_store_dwordx4 v[60:63], v7, s[4:7], 0 offen offset:512
    v_pk_mul_f32 v[40:41], v[40:41], v[224:225]
    v_pk_mul_f32 v[42:43], v[42:43], v[224:225]
    v_cvt_pk_bf16_f32 v56, v40, v41
    v_cvt_pk_bf16_f32 v57, v42, v43
    v_pk_mul_f32 v[48:49], v[48:49], v[224:225]
    v_pk_mul_f32 v[50:51], v[50:51], v[224:225]
    v_cvt_pk_bf16_f32 v58, v48, v49
    v_cvt_pk_bf16_f32 v59, v50, v51
    buffer_store_dwordx4 v[56:59], v7, s[4:7], 0 offen offset:0
    v_add_f32 v224, |v40|, |v41|
    v_add_f32 v225, |v42|, |v43|
    v_add_f32 v224, v224, |v44|
    v_add_f32 v225, v225, |v45|
    v_add_f32 v224, v224, |v46|
    v_add_f32 v225, v225, |v47|
    v_add_f32 v224, v224, |v48|
    v_add_f32 v225, v225, |v49|
    v_add_f32 v224, v224, |v50|
    v_add_f32 v225, v225, |v51|
    v_add_f32 v224, v224, |v52|
    v_add_f32 v225, v225, |v53|
    v_add_f32 v224, v224, |v54|
    v_add_f32 v225, v225, |v55|
    v_add_f32 v224, v224, v225
    v_mov_b32 v225, 0x7f800000
    v_mov_b32 v226, 0x2b800000
    v_cmp_lt_f32 s[56:57], v224, v225
    v_cmp_lt_f32 s[58:59], v226, v227
    v_cmp_gt_f32 vcc, 0x71800000, v227
    s_and_b64 s[56:57], s[56:57], s[58:59]
    s_and_b64 vcc, vcc, s[56:57]
    s_cmp_eq_u64 vcc, -1
    s_cselect_b32 s56, 1, s64
    s_cmp_eq_u32 s56, 0
    s_cbranch_scc1 attn_slow
    v_add_u32 v5, 102400, v2
    ds_read_b128 v[88:91], v5 offset:0
    ds_read_b128 v[92:95], v5 offset:1024
    ds_read_b128 v[96:99], v5 offset:2048
    ds_read_b128 v[100:103], v5 offset:3072
    ds_read_b128 v[104:107], v5 offset:4096
    ds_read_b128 v[108:111], v5 offset:5120
    ds_read_b128 v[112:115], v5 offset:6144
    ds_read_b128 v[116:119], v5 offset:7168
    v_accvgpr_read_b32 v140, a240
    v_accvgpr_read_b32 v141, a241
    v_accvgpr_read_b32 v142, a242
    v_accvgpr_read_b32 v143, a243
    v_accvgpr_read_b32 v144, a244
    v_accvgpr_read_b32 v145, a245
    v_accvgpr_read_b32 v146, a246
    v_accvgpr_read_b32 v147, a247
    v_lshlrev_b32 v72, 16, v140
    v_and_b32 v73, s60, v140
    v_lshlrev_b32 v74, 16, v141
    v_and_b32 v75, s60, v141
    v_lshlrev_b32 v76, 16, v142
    v_and_b32 v77, s60, v142
    v_lshlrev_b32 v78, 16, v143
    v_and_b32 v79, s60, v143
    v_lshlrev_b32 v80, 16, v144
    v_and_b32 v81, s60, v144
    v_lshlrev_b32 v82, 16, v145
    v_and_b32 v83, s60, v145
    v_lshlrev_b32 v84, 16, v146
    v_and_b32 v85, s60, v146
    v_lshlrev_b32 v86, 16, v147
    v_and_b32 v87, s60, v147
    v_mov_b32 v144, 0x3f803f80
    v_mov_b32 v145, 0x3f803f80
    v_mov_b32 v146, 0x3f803f80
    v_mov_b32 v147, 0x3f803f80
    s_lshl_b32 s56, s9, 7
    s_add_u32 s56, s56, 0
    s_add_u32 s56, s56, s50
    s_lshl_b32 s57, s10, 2
    s_add_u32 s57, s56, s57
    v_lshlrev_b32 v252, 2, v1
    v_mov_b32 v253, 1
    s_lshl_b32 s58, s8, 4
    s_add_u32 s58, s58, s10
    s_waitcnt vmcnt(0)
    s_barrier
    s_cmp_ge_u32 s58, 16
    s_cbranch_scc1 sy0_n
    s_mov_b64 exec, 1
    s_cmp_eq_u32 s83, 1
    s_cbranch_scc0 sy0_s
    buffer_store_dword v253, v252, s[4:7], s57 offen
    s_branch sy0_x
sy0_s:
    buffer_wbl2 sc1
    s_waitcnt vmcnt(0)
    buffer_atomic_add v253, v252, s[4:7], s56 offen offset:64 sc1
sy0_x:
    s_mov_b64 exec, -1
sy0_n:
    s_mov_b32 s64, 0xaaaaaaaa
    s_mov_b32 s65, 0xaaaaaaaa
    s_mov_b32 s66, 0xcccccccc
    s_mov_b32 s67, 0xcccccccc
    s_add_u32 s61, s55, s8
    s_mul_i32 s62, s61, 14336
    s_lshl_b32 s58, s19, 11
    s_add_u32 s62, s62, s58
    s_add_u32 s62, s62, s47
    s_lshl_b32 s63, s61, 10
    s_lshl_b32 s59, s19, 7
    s_add_u32 s63, s63, s59
    s_add_u32 s63, s63, s48
    s_lshr_b32 s59, s8, 1
    s_lshl_b32 s59, s59, 15
    s_and_b32 s61, s8, 1
    s_lshl_b32 s61, s61, 10
    s_add_u32 s61, s61, s59
    s_mul_i32 s59, s55, 57344
    s_add_u32 s61, s61, s59
    s_add_u32 s61, s61, s46
    s_add_u32 s61, s61, 4096
    s_lshl_b32 s38, s9, 7
    s_add_u32 s38, s38, 0
    s_add_u32 s38, s38, s50
    v_and_b32 v252, 31, v1
    v_lshl_add_u32 v252, v252, 2, s38
    s_mov_b32 s40, 0x10000
    s_mov_b32 s41, 0
    s_cmp_eq_u32 s83, 1
    s_cselect_b32 s38, 1, 16
    s_cselect_b32 s40, 65535, s40
    buffer_load_dword v253, v252, s[4:7], 0 offen sc1
    s_add_u32 s72, s92, s61
    s_addc_u32 s73, s93, 0
    s_add_u32 s61, s61, 8192
    s_add_u32 s74, s92, s61
    s_addc_u32 s75, s93, 0
    s_add_u32 s61, s61, 8192
    s_add_u32 s76, s92, s61
    s_addc_u32 s77, s93, 0
    s_add_u32 s61, s61, 8192
    s_add_u32 s78, s92, s61
    s_addc_u32 s79, s93, 0
    v_lshlrev_b32 v6, 3, v3
    s_lshl_b32 s59, s19, 7
    v_lshl_add_u32 v151, v4, 3, s59
    s_mov_b32 m0, s39
    s_lshl_b32 s57, s9, 1
    s_and_b32 s58, s10, 1
    s_add_u32 s57, s57, s58
    s_mul_i32 s57, s57, 229376
    s_mul_i32 s58, s8, 24576
    s_add_u32 s57, s57, s58
    s_add_u32 s57, s57, s49
    s_add_u32 s57, s57, 131072
    v_lshl_add_u32 v148, v1, 7, s57
    s_lshl_b32 s43, s11, 4
    s_add_u32 s43, s43, 14
    v_pk_add_f32 v[152:153], v[152:153], v[156:157]
    v_pk_add_f32 v[154:155], v[154:155], v[158:159]
    s_lshl_b32 s59, s8, 10
    v_add_u32 v150, s59, v2
    s_cmp_lt_u32 s10, s43
    s_cbranch_scc1 tc_1
    global_load_dword v149, v148, s[92:93] sc1
    v_add_u32 v148, 0x2000, v148
    global_load_dword v149, v148, s[92:93] sc1
    v_add_u32 v148, 0x2000, v148
    global_load_dword v149, v148, s[92:93] sc1
    v_add_u32 v148, 0x2000, v148
tc_1:
    ds_write_b128 v150, v[152:155]
    s_mov_b32 s57, 400000
pw0_p:
    s_waitcnt vmcnt(0)
    v_cmp_ne_u32 vcc, s38, v253
    s_nop 0
    s_and_b64 vcc, vcc, s[40:41]
    s_cbranch_scc0 pw0_q
    s_sub_u32 s57, s57, 1
    s_cmp_eq_u32 s57, 0
    s_cbranch_scc1 pw0_q
    buffer_load_dword v253, v252, s[4:7], 0 offen sc1
    s_waitcnt vmcnt(0)
    s_branch pw0_p
pw0_q:
    s_cmp_eq_u32 s83, 1
    s_cbranch_scc1 pw0_e
    buffer_inv sc1
    s_waitcnt vmcnt(0)
pw0_e:
    s_cmp_ge_u32 s10, 14
    s_cbranch_scc1 w_skip
    global_load_dwordx4 v[8:11], v2, s[72:73] offset:-4096 sc1
    global_load_dwordx4 v[12:15], v2, s[72:73] offset:-2048 sc1
    global_load_dwordx4 v[16:19], v2, s[72:73] offset:0 sc1
    global_load_dwordx4 v[20:23], v2, s[72:73] offset:2048 sc1
    global_load_dwordx4 v[24:27], v2, s[74:75] offset:-4096 sc1
    global_load_dwordx4 v[28:31], v2, s[74:75] offset:-2048 sc1
    global_load_dwordx4 v[32:35], v2, s[74:75] offset:0 sc1
    global_load_dwordx4 v[36:39], v2, s[74:75] offset:2048 sc1
    s_waitcnt vmcnt(7) lgkmcnt(8)
    v_mfma_f32_16x16x32_bf16 v[72:75], v[88:91], v[8:11], v[72:75]
    global_load_dwordx4 v[40:43], v2, s[76:77] offset:-4096 sc1
    ds_read_b128 v[120:123], v5 offset:8192
    s_waitcnt lgkmcnt(8)
    v_mfma_f32_16x16x32_bf16 v[76:79], v[92:95], v[8:11], v[76:79]
    ds_read_b128 v[124:127], v5 offset:9216
    s_waitcnt lgkmcnt(8)
    v_mfma_f32_16x16x32_bf16 v[80:83], v[96:99], v[8:11], v[80:83]
    ds_read_b128 v[128:131], v5 offset:10240
    s_waitcnt lgkmcnt(8)
    v_mfma_f32_16x16x32_bf16 v[84:87], v[100:103], v[8:11], v[84:87]
    ds_read_b128 v[132:135], v5 offset:11264
    s_waitcnt vmcnt(7) lgkmcnt(8)
    v_mfma_f32_16x16x32_bf16 v[72:75], v[104:107], v[12:15], v[72:75]
    global_load_dwordx4 v[44:47], v2, s[76:77] offset:-2048 sc1
    ds_read_b128 v[88:91], v5 offset:12288
    s_waitcnt lgkmcnt(8)
    v_mfma_f32_16x16x32_bf16 v[76:79], v[108:111], v[12:15], v[76:79]
    ds_read_b128 v[92:95], v5 offset:13312
    s_waitcnt lgkmcnt(8)
    v_mfma_f32_16x16x32_bf16 v[80:83], v[112:115], v[12:15], v[80:83]
    ds_read_b128 v[96:99], v5 offset:14336
    s_waitcnt lgkmcnt(8)
    v_mfma_f32_16x16x32_bf16 v[84:87], v[116:119], v[12:15], v[84:87]
    ds_read_b128 v[100:103], v5 offset:15360
    s_waitcnt vmcnt(7) lgkmcnt(7)
    v_mfma_f32_16x16x32_bf16 v[72:75], v[120:123], v[16:19], v[72:75]
    global_load_dwordx4 v[48:51], v2, s[76:77] offset:0 sc1
    ds_read_b128 v[104:107], v5 offset:16384
    s_waitcnt lgkmcnt(7)
    v_mfma_f32_16x16x32_bf16 v[76:79], v[124:127], v[16:19], v[76:79]
    ds_read_b128 v[108:111], v5 offset:17408
    s_waitcnt lgkmcnt(7)
    v_mfma_f32_16x16x32_bf16 v[80:83], v[128:131], v[16:19], v[80:83]
    ds_read_b128 v[112:115], v5 offset:18432
    s_waitcnt lgkmcnt(7)
    v_mfma_f32_16x16x32_bf16 v[84:87], v[132:135], v[16:19], v[84:87]
    ds_read_b128 v[116:119], v5 offset:19456
    s_waitcnt vmcnt(7) lgkmcnt(7)
    v_mfma_f32_16x16x32_bf16 v[72:75], v[88:91], v[20:23], v[72:75]
    global_load_dwordx4 v[52:55], v2, s[76:77] offset:2048 sc1
    ds_read_b128 v[120:123], v5 offset:20480
    s_waitcnt lgkmcnt(7)
    v_mfma_f32_16x16x32_bf16 v[76:79], v[92:95], v[20:23], v[76:79]
    ds_read_b128 v[124:127], v5 offset:21504
    s_waitcnt lgkmcnt(7)
    v_mfma_f32_16x16x32_bf16 v[80:83], v[96:99], v[20:23], v[80:83]
    ds_read_b128 v[128:131], v5 offset:22528
    s_waitcnt lgkmcnt(7)
    v_mfma_f32_16x16x32_bf16 v[84:87], v[100:103], v[20:23], v[84:87]
    ds_read_b128 v[132:135], v5 offset:23552
    s_waitcnt vmcnt(7) lgkmcnt(7)
    v_mfma_f32_16x16x32_bf16 v[72:75], v[104:107], v[24:27], v[72:75]
    global_load_dwordx4 v[56:59], v2, s[78:79] offset:-4096 sc1
    ds_read_b128 v[88:91], v5 offset:24576
    s_waitcnt lgkmcnt(7)
    v_mfma_f32_16x16x32_bf16 v[76:79], v[108:111], v[24:27], v[76:79]
    ds_read_b128 v[92:95], v5 offset:25600
    s_waitcnt lgkmcnt(7)
    v_mfma_f32_16x16x32_bf16 v[80:83], v[112:115], v[24:27], v[80:83]
    ds_read_b128 v[96:99], v5 offset:26624
    s_waitcnt lgkmcnt(7)
    v_mfma_f32_16x16x32_bf16 v[84:87], v[116:119], v[24:27], v[84:87]
    ds_read_b128 v[100:103], v5 offset:27648
    s_waitcnt vmcnt(7) lgkmcnt(7)
    v_mfma_f32_16x16x32_bf16 v[72:75], v[120:123], v[28:31], v[72:75]
    global_load_dwordx4 v[60:63], v2, s[78:79] offset:-2048 sc1
    ds_read_b128 v[104:107], v5 offset:28672
    s_waitcnt lgkmcnt(7)
    v_mfma_f32_16x16x32_bf16 v[76:79], v[124:127], v[28:31], v[76:79]
    ds_read_b128 v[108:111], v5 offset:29696
    s_waitcnt lgkmcnt(7)
    v_mfma_f32_16x16x32_bf16 v[80:83], v[128:131], v[28:31], v[80:83]
    ds_read_b128 v[112:115], v5 offset:30720
    s_waitcnt lgkmcnt(7)
    v_mfma_f32_16x16x32_bf16 v[84:87], v[132:135], v[28:31], v[84:87]
    ds_read_b128 v[116:119], v5 offset:31744
    s_waitcnt vmcnt(7) lgkmcnt(7)
    v_mfma_f32_16x16x32_bf16 v[72:75], v[88:91], v[32:35], v[72:75]
    global_load_dwordx4 v[64:67], v2, s[78:79] offset:0 sc1
    ds_read_b128 v[120:123], v5 offset:32768
    s_waitcnt lgkmcnt(7)
    v_mfma_f32_16x16x32_bf16 v[76:79], v[92:95], v[32:35], v[76:79]
    ds_read_b128 v[124:127], v5 offset:33792
    s_waitcnt lgkmcnt(7)
    v_mfma_f32_16x16x32_bf16 v[80:83], v[96:99], v[32:35], v[80:83]
    ds_read_b128 v[128:131], v5 offset:34816
    s_waitcnt lgkmcnt(7)
    v_mfma_f32_16x16x32_bf16 v[84:87], v[100:103], v[32:35], v[84:87]
    ds_read_b128 v[132:135], v5 offset:35840
    s_waitcnt vmcnt(7) lgkmcnt(7)
    v_mfma_f32_16x16x32_bf16 v[72:75], v[104:107], v[36:39], v[72:75]
    global_load_dwordx4 v[68:71], v2, s[78:79] offset:2048 sc1
    ds_read_b128 v[88:91], v5 offset:36864
    s_waitcnt lgkmcnt(7)
    v_mfma_f32_16x16x32_bf16 v[76:79], v[108:111], v[36:39], v[76:79]
    ds_read_b128 v[92:95], v5 offset:37888
    s_waitcnt lgkmcnt(7)
    v_mfma_f32_16x16x32_bf16 v[80:83], v[112:115], v[36:39], v[80:83]
    ds_read_b128 v[96:99], v5 offset:38912
    s_waitcnt lgkmcnt(7)
    v_mfma_f32_16x16x32_bf16 v[84:87], v[116:119], v[36:39], v[84:87]
    ds_read_b128 v[100:103], v5 offset:39936
    s_waitcnt vmcnt(7) lgkmcnt(7)
    v_mfma_f32_16x16x32_bf16 v[72:75], v[120:123], v[40:43], v[72:75]
    global_load_lds_dwordx4 v2, s[80:81] offset:0
    ds_read_b128 v[104:107], v5 offset:40960
    s_waitcnt lgkmcnt(7)
    v_mfma_f32_16x16x32_bf16 v[76:79], v[124:127], v[40:43], v[76:79]
    ds_read_b128 v[108:111], v5 offset:41984
    s_waitcnt lgkmcnt(7)
    v_mfma_f32_16x16x32_bf16 v[80:83], v[128:131], v[40:43], v[80:83]
    ds_read_b128 v[112:115], v5 offset:43008
    s_waitcnt lgkmcnt(7)
    v_mfma_f32_16x16x32_bf16 v[84:87], v[132:135], v[40:43], v[84:87]
    ds_read_b128 v[116:119], v5 offset:44032
    s_waitcnt vmcnt(7) lgkmcnt(7)
    v_mfma_f32_16x16x32_bf16 v[72:75], v[88:91], v[44:47], v[72:75]
    global_load_lds_dwordx4 v2, s[80:81] offset:1024
    ds_read_b128 v[120:123], v5 offset:45056
    s_waitcnt lgkmcnt(7)
    v_mfma_f32_16x16x32_bf16 v[76:79], v[92:95], v[44:47], v[76:79]
    ds_read_b128 v[124:127], v5 offset:46080
    s_waitcnt lgkmcnt(7)
    v_mfma_f32_16x16x32_bf16 v[80:83], v[96:99], v[44:47], v[80:83]
    ds_read_b128 v[128:131], v5 offset:47104
    s_waitcnt lgkmcnt(7)
    v_mfma_f32_16x16x32_bf16 v[84:87], v[100:103], v[44:47], v[84:87]
    ds_read_b128 v[132:135], v5 offset:48128
    s_waitcnt vmcnt(7) lgkmcnt(7)
    v_mfma_f32_16x16x32_bf16 v[72:75], v[104:107], v[48:51], v[72:75]
    global_load_lds_dwordx4 v2, s[80:81] offset:2048
    ds_read_b128 v[88:91], v5 offset:49152
    s_waitcnt lgkmcnt(7)
    v_mfma_f32_16x16x32_bf16 v[76:79], v[108:111], v[48:51], v[76:79]
    ds_read_b128 v[92:95], v5 offset:50176
    s_waitcnt lgkmcnt(7)
    v_mfma_f32_16x16x32_bf16 v[80:83], v[112:115], v[48:51], v[80:83]
    ds_read_b128 v[96:99], v5 offset:51200
    s_waitcnt lgkmcnt(7)
    v_mfma_f32_16x16x32_bf16 v[84:87], v[116:119], v[48:51], v[84:87]
    ds_read_b128 v[100:103], v5 offset:52224
    s_waitcnt vmcnt(7) lgkmcnt(7)
    v_mfma_f32_16x16x32_bf16 v[72:75], v[120:123], v[52:55], v[72:75]
    global_load_lds_dwordx4 v2, s[80:81] offset:3072
    s_add_u32 m0, m0, 4096
    s_add_u32 s80, s80, 4096
    s_addc_u32 s81, s81, 0
    ds_read_b128 v[104:107], v5 offset:53248
    s_waitcnt lgkmcnt(7)
    v_mfma_f32_16x16x32_bf16 v[76:79], v[124:127], v[52:55], v[76:79]
    ds_read_b128 v[108:111], v5 offset:54272
    s_waitcnt lgkmcnt(7)
    v_mfma_f32_16x16x32_bf16 v[80:83], v[128:131], v[52:55], v[80:83]
    ds_read_b128 v[112:115], v5 offset:55296
    s_waitcnt lgkmcnt(7)
    v_mfma_f32_16x16x32_bf16 v[84:87], v[132:135], v[52:55], v[84:87]
    ds_read_b128 v[116:119], v5 offset:56320
    s_waitcnt vmcnt(7) lgkmcnt(7)
    v_mfma_f32_16x16x32_bf16 v[72:75], v[88:91], v[56:59], v[72:75]
    global_load_lds_dwordx4 v2, s[80:81]
    ds_read_b128 v[120:123], v5 offset:57344
    s_waitcnt lgkmcnt(7)
    v_mfma_f32_16x16x32_bf16 v[76:79], v[92:95], v[56:59], v[76:79]
    ds_read_b128 v[124:127], v5 offset:58368
    s_waitcnt lgkmcnt(7)
    v_mfma_f32_16x16x32_bf16 v[80:83], v[96:99], v[56:59], v[80:83]
    ds_read_b128 v[128:131], v5 offset:59392
    s_waitcnt lgkmcnt(7)
    v_mfma_f32_16x16x32_bf16 v[84:87], v[100:103], v[56:59], v[84:87]
    ds_read_b128 v[132:135], v5 offset:60416
    s_waitcnt vmcnt(7) lgkmcnt(7)
    v_mfma_f32_16x16x32_bf16 v[72:75], v[104:107], v[60:63], v[72:75]
    buffer_load_dwordx2 a[240:241], v151, s[28:31], 0 offen offset:0
    buffer_load_dwordx2 a[242:243], v151, s[28:31], 0 offen offset:32
    s_waitcnt lgkmcnt(6)
    v_mfma_f32_16x16x32_bf16 v[76:79], v[108:111], v[60:63], v[76:79]
    s_waitcnt lgkmcnt(5)
    v_mfma_f32_16x16x32_bf16 v[80:83], v[112:115], v[60:63], v[80:83]
    s_waitcnt lgkmcnt(4)
    v_mfma_f32_16x16x32_bf16 v[84:87], v[116:119], v[60:63], v[84:87]
    s_waitcnt vmcnt(8) lgkmcnt(3)
    v_mfma_f32_16x16x32_bf16 v[72:75], v[120:123], v[64:67], v[72:75]
    buffer_load_dwordx2 a[244:245], v151, s[28:31], 0 offen offset:64
    buffer_load_dwordx2 a[246:247], v151, s[28:31], 0 offen offset:96
    s_waitcnt lgkmcnt(2)
    v_mfma_f32_16x16x32_bf16 v[76:79], v[124:127], v[64:67], v[76:79]
    s_waitcnt lgkmcnt(1)
    v_mfma_f32_16x16x32_bf16 v[80:83], v[128:131], v[64:67], v[80:83]
    s_waitcnt lgkmcnt(0)
    v_mfma_f32_16x16x32_bf16 v[84:87], v[132:135], v[64:67], v[84:87]
    s_waitcnt vmcnt(9)
    v_mfma_f32_16x16x32_bf16 v[72:75], a[224:227], v[68:71], v[72:75]
    v_mfma_f32_16x16x32_bf16 v[76:79], a[228:231], v[68:71], v[76:79]
    v_mfma_f32_16x16x32_bf16 v[80:83], a[232:235], v[68:71], v[80:83]
    v_mfma_f32_16x16x32_bf16 v[84:87], a[236:239], v[68:71], v[84:87]
    s_nop 4
    v_cvt_pk_bf16_f32 v244, v72, v73
    v_cvt_pk_bf16_f32 v245, v74, v75
    v_cvt_pk_bf16_f32 v246, v76, v77
    v_cvt_pk_bf16_f32 v247, v78, v79
    buffer_store_dwordx4 v[244:247], v2, s[4:7], s62 offen offset:0
    v_cvt_pk_bf16_f32 v248, v80, v81
    v_cvt_pk_bf16_f32 v249, v82, v83
    v_cvt_pk_bf16_f32 v250, v84, v85
    v_cvt_pk_bf16_f32 v251, v86, v87
    buffer_store_dwordx4 v[248:251], v2, s[4:7], s62 offen offset:1024
    v_mfma_f32_16x16x32_bf16 v[8:11], v[144:147], v[244:247], 0
    v_mfma_f32_16x16x32_bf16 v[12:15], v[244:247], v[244:247], 0
    v_mfma_f32_16x16x32_bf16 v[8:11], v[144:147], v[248:251], v[8:11]
    v_mfma_f32_16x16x32_bf16 v[12:15], v[248:251], v[248:251], v[12:15]
    s_mov_b32 exec_lo, 0x00f0000f
    s_mov_b32 exec_hi, 0xf0000f00
    s_nop 5
    v_cndmask_b32 v12, v12, v13, s[64:65]
    v_cndmask_b32 v14, v14, v15, s[64:65]
    v_cndmask_b32 v9, v12, v14, s[66:67]
    buffer_store_dwordx2 v[8:9], v6, s[4:7], s63 offen
    s_mov_b64 exec, -1
    s_branch w_done
w_skip:
    global_load_lds_dwordx4 v2, s[80:81] offset:0
    global_load_lds_dwordx4 v2, s[80:81] offset:1024
    global_load_lds_dwordx4 v2, s[80:81] offset:2048
    global_load_lds_dwordx4 v2, s[80:81] offset:3072
    s_add_u32 m0, m0, 4096
    s_add_u32 s80, s80, 4096
    s_addc_u32 s81, s81, 0
    global_load_lds_dwordx4 v2, s[80:81]
w_done:
    s_waitcnt lgkmcnt(0)
    s_lshl_b32 s66, s9, 3
    s_lshl_b32 s57, s8, 1
    s_add_u32 s66, s66, s57
    s_lshl_b32 s67, s66, 10
    s_add_u32 s67, s67, s48
    s_mul_i32 s57, s66, 14336
    s_add_u32 s57, s57, s47
    s_add_u32 s57, s57, 4096
    s_add_u32 s72, s92, s57
    s_addc_u32 s73, s93, 0
    s_add_u32 s57, s57, 14336
    s_add_u32 s74, s92, s57
    s_addc_u32 s75, s93, 0
    s_lshl_b32 s56, s9, 7
    s_add_u32 s56, s56, 4096
    s_add_u32 s56, s56, s50
    s_lshl_b32 s57, s10, 2
    s_add_u32 s57, s56, s57
    v_lshlrev_b32 v252, 2, v1
    v_mov_b32 v253, 1
    s_lshl_b32 s58, s8, 4
    s_add_u32 s58, s58, s10
    s_waitcnt vmcnt(0)
    s_barrier
    s_cmp_ge_u32 s58, 14
    s_cbranch_scc1 sy1_n
    s_mov_b64 exec, 1
    s_cmp_eq_u32 s83, 1
    s_cbranch_scc0 sy1_s
    buffer_store_dword v253, v252, s[4:7], s57 offen
    s_branch sy1_x
sy1_s:
    buffer_wbl2 sc1
    s_waitcnt vmcnt(0)
    buffer_atomic_add v253, v252, s[4:7], s56 offen offset:64 sc1
sy1_x:
    s_mov_b64 exec, -1
sy1_n:
    s_lshr_b32 s59, s10, 1
    s_mul_i32 s59, s59, 7168
    s_mul_i32 s61, s66, 57344
    s_add_u32 s59, s59, s61
    s_add_u32 s59, s59, s49
    s_and_b32 s61, s10, 1
    s_mul_i32 s62, s61, 3072
    s_add_u32 s62, s62, s59
    s_add_u32 s63, s62, 57344
    s_lshl_b32 s61, s61, 3
    s_add_u32 s61, s61, s59
    s_add_u32 s64, s61, 6144
    s_add_u32 s65, s64, 57344
    v_lshlrev_b32 v7, 3, v3
    v_lshl_add_u32 v7, v4, 8, v7
    v_lshlrev_b32 v5, 4, v4
    v_add_u32 v5, 100352, v5
    v_add_u32 v6, 0xc000, v2
    s_mul_i32 s39, s8, 7168
    s_add_u32 s59, s39, s42
    s_add_u32 s80, s92, s59
    s_addc_u32 s81, s93, 0
    s_mov_b32 m0, s39
    s_and_b32 s54, s10, 7
    s_mul_i32 s57, s54, 57344
    s_add_u32 s43, s57, 3674112
    s_mul_i32 s37, s8, 7168
    s_add_u32 s37, s37, 28672
    s_add_u32 s57, s43, s37
    s_add_u32 s78, s92, s57
    s_addc_u32 s79, s93, 0
    s_add_u32 s37, s37, 102400
    s_cmp_lg_u32 s8, 0
    s_cbranch_scc1 sy1_h
    s_lshl_b32 s58, s9, 7
    s_add_u32 s58, s58, 4096
    s_add_u32 s58, s58, s50
    s_mov_b32 s57, 400000
    s_cmp_eq_u32 s83, 1
    s_cbranch_scc0 sy1_w
    s_mov_b64 exec, 16383
sy1_p:
    buffer_load_dword v253, v252, s[4:7], s58 offen sc1
    s_sub_u32 s57, s57, 1
    s_cmp_eq_u32 s57, 0
    s_cbranch_scc1 sy1_q
    s_waitcnt vmcnt(0)
    v_cmp_ne_u32 vcc, 1, v253
    s_nop 4
    s_cbranch_vccnz sy1_p
sy1_q:
    s_mov_b64 exec, -1
    s_branch sy1_e
sy1_w:
    s_mov_b64 exec, 1
sy1_sp:
    buffer_load_dword v253, v252, s[4:7], s58 offen offset:64 sc1
    s_sub_u32 s57, s57, 1
    s_cmp_eq_u32 s57, 0
    s_cbranch_scc1 sy1_sq
    s_waitcnt vmcnt(0)
    v_cmp_gt_u32 vcc, 14, v253
    s_nop 4
    s_cbranch_vccnz sy1_sp
sy1_sq:
    buffer_inv sc1
    s_waitcnt vmcnt(0)
    s_mov_b64 exec, -1
    s_branch sy1_e
sy1_h:
    s_cmp_eq_u32 s11, 1
    s_cbranch_scc1 sy1_e
    s_cmp_eq_u32 s8, 1
    s_cbranch_scc1 ht_1
    s_sub_u32 s56, s8, 2
    s_mul_i32 s56, s56, 14336
    s_add_u32 s57, s56, s43
    s_add_u32 s76, s92, s57
    s_addc_u32 s77, s93, 0
    s_add_u32 m0, s56, 102400
    s_nop 0
    global_load_lds_dwordx4 v2, s[76:77] offset:0
    global_load_lds_dwordx4 v2, s[76:77] offset:1024
    global_load_lds_dwordx4 v2, s[76:77] offset:2048
    global_load_lds_dwordx4 v2, s[76:77] offset:3072
    s_add_u32 m0, m0, 4096
    s_add_u32 s76, s76, 4096
    s_addc_u32 s77, s77, 0
    global_load_lds_dwordx4 v2, s[76:77] offset:0
    global_load_lds_dwordx4 v2, s[76:77] offset:1024
    global_load_lds_dwordx4 v2, s[76:77] offset:2048
    global_load_lds_dwordx4 v2, s[76:77] offset:3072
    s_add_u32 m0, m0, 4096
    s_add_u32 s76, s76, 4096
    s_addc_u32 s77, s77, 0
    global_load_lds_dwordx4 v2, s[76:77] offset:0
    global_load_lds_dwordx4 v2, s[76:77] offset:1024
    global_load_lds_dwordx4 v2, s[76:77] offset:2048
    global_load_lds_dwordx4 v2, s[76:77] offset:3072
    s_add_u32 m0, m0, 4096
    s_add_u32 s76, s76, 4096
    s_addc_u32 s77, s77, 0
    global_load_lds_dwordx4 v2, s[76:77] offset:0
    global_load_lds_dwordx4 v2, s[76:77] offset:1024
    s_mov_b32 m0, s39
    s_branch sy1_e
ht_1:
    ds_read_b128 v[8:11], v2 offset:0
    ds_read_b128 v[12:15], v2 offset:512
    ds_read_b128 v[16:19], v2 offset:1024
    ds_read_b128 v[20:23], v2 offset:1536
    ds_read_b128 v[24:27], v2 offset:2048
    ds_read_b128 v[28:31], v2 offset:2560
    ds_read_b128 v[32:35], v2 offset:3072
    ds_read_b128 v[36:39], v2 offset:3584
    v_accvgpr_read_b32 v160, a248
    v_accvgpr_read_b32 v161, a249
    v_lshlrev_b32 v40, 16, v160
    v_and_b32 v41, s60, v160
    v_lshlrev_b32 v42, 16, v161
    v_and_b32 v43, s60, v161
    v_add_u32 v44, 100352, v2
    s_waitcnt lgkmcnt(6)
    v_pk_add_f32 v[8:9], v[8:9], v[12:13]
    v_pk_add_f32 v[10:11], v[10:11], v[14:15]
    s_waitcnt lgkmcnt(5)
    v_pk_add_f32 v[8:9], v[8:9], v[16:17]
    v_pk_add_f32 v[10:11], v[10:11], v[18:19]
    s_waitcnt lgkmcnt(4)
    v_pk_add_f32 v[8:9], v[8:9], v[20:21]
    v_pk_add_f32 v[10:11], v[10:11], v[22:23]
    s_waitcnt lgkmcnt(3)
    v_pk_add_f32 v[8:9], v[8:9], v[24:25]
    v_pk_add_f32 v[10:11], v[10:11], v[26:27]
    s_waitcnt lgkmcnt(2)
    v_pk_add_f32 v[8:9], v[8:9], v[28:29]
    v_pk_add_f32 v[10:11], v[10:11], v[30:31]
    s_waitcnt lgkmcnt(1)
    v_pk_add_f32 v[8:9], v[8:9], v[32:33]
    v_pk_add_f32 v[10:11], v[10:11], v[34:35]
    s_waitcnt lgkmcnt(0)
    v_pk_add_f32 v[8:9], v[8:9], v[36:37]
    v_pk_add_f32 v[10:11], v[10:11], v[38:39]
    s_mov_b64 exec, 0xfffffff
    ds_write_b128 v44, v[8:11]
    ds_write_b128 v44, v[40:43] offset:512
    s_mov_b64 exec, -1
    s_waitcnt lgkmcnt(0)
sy1_e:
    s_barrier
    global_load_dwordx4 v[8:11], v2, s[72:73] offset:-4096 sc1
    global_load_dwordx4 v[64:67], v2, s[74:75] offset:-4096 sc1
    global_load_dwordx4 v[12:15], v2, s[72:73] offset:-3072 sc1
    global_load_dwordx4 v[68:71], v2, s[74:75] offset:-3072 sc1
    buffer_load_dwordx2 v[208:209], v7, s[4:7], s67 offen offset:0 sc1
    buffer_load_dwordx2 v[210:211], v7, s[4:7], s67 offen offset:128 sc1
    buffer_load_dwordx2 v[212:213], v7, s[4:7], s67 offen offset:1024 sc1
    buffer_load_dwordx2 v[214:215], v7, s[4:7], s67 offen offset:1152 sc1
    global_load_dwordx4 v[16:19], v2, s[72:73] offset:-2048 sc1
    global_load_dwordx4 v[72:75], v2, s[74:75] offset:-2048 sc1
    global_load_dwordx4 v[20:23], v2, s[72:73] offset:-1024 sc1
    global_load_dwordx4 v[76:79], v2, s[74:75] offset:-1024 sc1
    ds_read_b128 v[176:179], v6 offset:0
    ds_read_b128 v[180:183], v6 offset:1024
    ds_read_b128 v[184:187], v6 offset:2048
    ds_read_b128 v[188:191], v6 offset:3072
    ds_read_b128 v[136:139], v5 offset:256
    ds_read_b128 v[226:229], v5 offset:768
    ds_read_b128 v[140:143], v5 offset:320
    ds_read_b128 v[230:233], v5 offset:832
    ds_read_b128 v[144:147], v5 offset:384
    ds_read_b128 v[234:237], v5 offset:896
    s_waitcnt vmcnt(11) lgkmcnt(9)
    v_mfma_f32_16x16x32_bf16 v[120:123], v[176:179], v[8:11], 0
    ds_read_b128 v[192:195], v6 offset:4096
    s_waitcnt vmcnt(10)
    v_mfma_f32_16x16x32_bf16 v[148:151], v[176:179], v[64:67], 0
    ds_read_b128 v[196:199], v6 offset:5120
    s_waitcnt lgkmcnt(10)
    v_mfma_f32_16x16x32_bf16 v[124:127], v[180:183], v[8:11], 0
    ds_read_b128 v[200:203], v6 offset:6144
    v_mfma_f32_16x16x32_bf16 v[152:155], v[180:183], v[64:67], 0
    s_waitcnt lgkmcnt(10)
    v_mfma_f32_16x16x32_bf16 v[128:131], v[184:187], v[8:11], 0
    ds_read_b128 v[204:207], v6 offset:7168
    v_mfma_f32_16x16x32_bf16 v[156:159], v[184:187], v[64:67], 0
    global_load_dwordx4 v[24:27], v2, s[72:73] offset:0 sc1
    s_waitcnt lgkmcnt(10)
    v_mfma_f32_16x16x32_bf16 v[132:135], v[188:191], v[8:11], 0
    global_load_dwordx4 v[80:83], v2, s[74:75] offset:0 sc1
    v_mfma_f32_16x16x32_bf16 v[160:163], v[188:191], v[64:67], 0
    s_waitcnt vmcnt(11) lgkmcnt(3)
    v_mfma_f32_16x16x32_bf16 v[120:123], v[192:195], v[12:15], v[120:123]
    ds_read_b128 v[176:179], v6 offset:8192
    v_cmp_eq_u32 vcc, 3, v4
    s_waitcnt vmcnt(8)
    s_nop 0
    v_cndmask_b32 v210, v210, 0, vcc
    v_mfma_f32_16x16x32_bf16 v[148:151], v[192:195], v[68:71], v[148:151]
    ds_read_b128 v[180:183], v6 offset:9216
    v_cndmask_b32 v211, v211, 0, vcc
    v_add_f32 v208, v208, v210
    s_waitcnt lgkmcnt(4)
    v_mfma_f32_16x16x32_bf16 v[124:127], v[196:199], v[12:15], v[124:127]
    ds_read_b128 v[184:187], v6 offset:10240
    v_add_f32 v209, v209, v211
    v_mfma_f32_16x16x32_bf16 v[152:155], v[196:199], v[68:71], v[152:155]
    v_mov_b32 v210, v208
    v_mov_b32 v211, v209
    s_waitcnt lgkmcnt(4)
    v_mfma_f32_16x16x32_bf16 v[128:131], v[200:203], v[12:15], v[128:131]
    ds_read_b128 v[188:191], v6 offset:11264
    v_permlane16_swap_b32 v208, v210
    v_permlane16_swap_b32 v209, v211
    v_mfma_f32_16x16x32_bf16 v[156:159], v[200:203], v[68:71], v[156:159]
    global_load_dwordx4 v[28:31], v2, s[72:73] offset:1024 sc1
    v_add_f32 v208, v208, v210
    s_waitcnt lgkmcnt(4)
    v_mfma_f32_16x16x32_bf16 v[132:135], v[204:207], v[12:15], v[132:135]
    global_load_dwordx4 v[84:87], v2, s[74:75] offset:1024 sc1
    v_add_f32 v209, v209, v211
    v_mov_b32 v210, v208
    v_mfma_f32_16x16x32_bf16 v[160:163], v[204:207], v[68:71], v[160:163]
    v_mov_b32 v211, v209
    s_waitcnt vmcnt(7) lgkmcnt(3)
    v_mfma_f32_16x16x32_bf16 v[120:123], v[176:179], v[16:19], v[120:123]
    ds_read_b128 v[192:195], v6 offset:12288
    v_permlane32_swap_b32 v208, v210
    v_permlane32_swap_b32 v209, v211
    s_waitcnt vmcnt(6)
    v_mfma_f32_16x16x32_bf16 v[148:151], v[176:179], v[72:75], v[148:151]
    ds_read_b128 v[196:199], v6 offset:13312
    v_add_f32 v208, v208, v210
    v_add_f32 v209, v209, v211
    s_waitcnt lgkmcnt(4)
    v_mfma_f32_16x16x32_bf16 v[124:127], v[180:183], v[16:19], v[124:127]
    ds_read_b128 v[200:203], v6 offset:14336
    v_mul_f32 v210, 0x3b124925, v208
    v_mul_f32 v211, 0x3b124925, v209
    v_mfma_f32_16x16x32_bf16 v[152:155], v[180:183], v[72:75], v[152:155]
    v_fma_f32 v211, -v210, v210, v211
    s_waitcnt lgkmcnt(4)
    v_mfma_f32_16x16x32_bf16 v[128:131], v[184:187], v[16:19], v[128:131]
    ds_read_b128 v[204:207], v6 offset:15360
    v_max_f32 v211, 0, v211
    v_add_f32 v211, 0x3727c5ac, v211
    v_mfma_f32_16x16x32_bf16 v[156:159], v[184:187], v[72:75], v[156:159]
    global_load_dwordx4 v[32:35], v2, s[72:73] offset:2048 sc1
    v_rsq_f32 v208, v211
    v_cndmask_b32 v214, v214, 0, vcc
    s_waitcnt lgkmcnt(4)
    v_mfma_f32_16x16x32_bf16 v[132:135], v[188:191], v[16:19], v[132:135]
    global_load_dwordx4 v[88:91], v2, s[74:75] offset:2048 sc1
    v_cndmask_b32 v215, v215, 0, vcc
    v_add_f32 v212, v212, v214
    v_mfma_f32_16x16x32_bf16 v[160:163], v[188:191], v[72:75], v[160:163]
    v_add_f32 v213, v213, v215
    s_waitcnt vmcnt(7) lgkmcnt(3)
    v_mfma_f32_16x16x32_bf16 v[120:123], v[192:195], v[20:23], v[120:123]
    ds_read_b128 v[176:179], v6 offset:16384
    v_mov_b32 v214, v212
    v_mov_b32 v215, v213
    s_waitcnt vmcnt(6)
    v_mfma_f32_16x16x32_bf16 v[148:151], v[192:195], v[76:79], v[148:151]
    ds_read_b128 v[180:183], v6 offset:17408
    v_permlane16_swap_b32 v212, v214
    v_permlane16_swap_b32 v213, v215
    s_waitcnt lgkmcnt(4)
    v_mfma_f32_16x16x32_bf16 v[124:127], v[196:199], v[20:23], v[124:127]
    ds_read_b128 v[184:187], v6 offset:18432
    v_add_f32 v212, v212, v214
    v_add_f32 v213, v213, v215
    v_mfma_f32_16x16x32_bf16 v[152:155], v[196:199], v[76:79], v[152:155]
    v_mov_b32 v214, v212
    s_waitcnt lgkmcnt(4)
    v_mfma_f32_16x16x32_bf16 v[128:131], v[200:203], v[20:23], v[128:131]
    ds_read_b128 v[188:191], v6 offset:19456
    v_mov_b32 v215, v213
    v_permlane32_swap_b32 v212, v214
    v_mfma_f32_16x16x32_bf16 v[156:159], v[200:203], v[76:79], v[156:159]
    global_load_dwordx4 v[36:39], v2, s[72:73] offset:3072 sc1
    v_permlane32_swap_b32 v213, v215
    v_add_f32 v212, v212, v214
    s_waitcnt lgkmcnt(4)
    v_mfma_f32_16x16x32_bf16 v[132:135], v[204:207], v[20:23], v[132:135]
    global_load_dwordx4 v[92:95], v2, s[74:75] offset:3072 sc1
    v_add_f32 v213, v213, v215
    v_mul_f32 v214, 0x3b124925, v212
    v_mfma_f32_16x16x32_bf16 v[160:163], v[204:207], v[76:79], v[160:163]
    v_mul_f32 v215, 0x3b124925, v213
    s_waitcnt vmcnt(7) lgkmcnt(3)
    v_mfma_f32_16x16x32_bf16 v[120:123], v[176:179], v[24:27], v[120:123]
    ds_read_b128 v[192:195], v6 offset:20480
    v_fma_f32 v215, -v214, v214, v215
    v_max_f32 v215, 0, v215
    s_waitcnt vmcnt(6)
    v_mfma_f32_16x16x32_bf16 v[148:151], v[176:179], v[80:83], v[148:151]
    ds_read_b128 v[196:199], v6 offset:21504
    v_add_f32 v215, 0x3727c5ac, v215
    v_rsq_f32 v212, v215
    s_waitcnt lgkmcnt(4)
    v_mfma_f32_16x16x32_bf16 v[124:127], v[180:183], v[24:27], v[124:127]
    ds_read_b128 v[200:203], v6 offset:22528
    v_mul_f32 v252, v211, v208
    v_mul_f32 v240, 0xc0135761, v208
    v_mfma_f32_16x16x32_bf16 v[152:155], v[180:183], v[80:83], v[152:155]
    ds_read_b128 v[204:207], v6 offset:23552
    v_mul_f32 v209, v208, v208
    s_waitcnt lgkmcnt(5)
    v_mfma_f32_16x16x32_bf16 v[128:131], v[184:187], v[24:27], v[128:131]
    s_add_u32 s72, s72, 8192
    s_addc_u32 s73, s73, 0
    v_mul_f32 v209, 0x3d372713, v209
    v_mul_f32 v241, v209, v240
    v_mfma_f32_16x16x32_bf16 v[156:159], v[184:187], v[80:83], v[156:159]
    s_add_u32 s74, s74, 8192
    s_addc_u32 s75, s75, 0
    v_mul_f32 v253, v215, v212
    v_mul_f32 v242, 0xc0135761, v212
    s_waitcnt lgkmcnt(4)
    v_mfma_f32_16x16x32_bf16 v[132:135], v[188:191], v[24:27], v[132:135]
    global_load_dwordx4 v[40:43], v2, s[72:73] offset:-4096 sc1
    v_mul_f32 v213, v212, v212
    v_mul_f32 v213, 0x3d372713, v213
    v_mfma_f32_16x16x32_bf16 v[160:163], v[188:191], v[80:83], v[160:163]
    global_load_dwordx4 v[96:99], v2, s[74:75] offset:-4096 sc1
    v_mul_f32 v243, v213, v242
    s_waitcnt vmcnt(7) lgkmcnt(3)
    v_mfma_f32_16x16x32_bf16 v[120:123], v[192:195], v[28:31], v[120:123]
    ds_read_b128 v[176:179], v6 offset:24576
    v_mul_f32 v164, v214, v136
    v_mul_f32 v136, v210, v136
    s_waitcnt vmcnt(6)
    v_mfma_f32_16x16x32_bf16 v[148:151], v[192:195], v[84:87], v[148:151]
    ds_read_b128 v[180:183], v6 offset:25600
    v_fma_f32 v164, v226, v253, -v164
    s_waitcnt lgkmcnt(4)
    v_mfma_f32_16x16x32_bf16 v[124:127], v[196:199], v[28:31], v[124:127]
    ds_read_b128 v[184:187], v6 offset:26624
    v_fma_f32 v136, v226, v252, -v136
    v_mul_f32 v165, v214, v137
    v_mfma_f32_16x16x32_bf16 v[152:155], v[196:199], v[84:87], v[152:155]
    v_mul_f32 v137, v210, v137
    s_waitcnt lgkmcnt(4)
    v_mfma_f32_16x16x32_bf16 v[128:131], v[200:203], v[28:31], v[128:131]
    ds_read_b128 v[188:191], v6 offset:27648
    v_fma_f32 v165, v227, v253, -v165
    v_fma_f32 v137, v227, v252, -v137
    v_mfma_f32_16x16x32_bf16 v[156:159], v[200:203], v[84:87], v[156:159]
    global_load_dwordx4 v[44:47], v2, s[72:73] offset:-3072 sc1
    v_mul_f32 v166, v214, v138
    s_waitcnt lgkmcnt(4)
    v_mfma_f32_16x16x32_bf16 v[132:135], v[204:207], v[28:31], v[132:135]
    global_load_dwordx4 v[100:103], v2, s[74:75] offset:-3072 sc1
    v_mul_f32 v138, v210, v138
    v_fma_f32 v166, v228, v253, -v166
    v_mfma_f32_16x16x32_bf16 v[160:163], v[204:207], v[84:87], v[160:163]
    v_fma_f32 v138, v228, v252, -v138
    s_waitcnt vmcnt(7) lgkmcnt(3)
    v_mfma_f32_16x16x32_bf16 v[120:123], v[176:179], v[32:35], v[120:123]
    ds_read_b128 v[192:195], v6 offset:28672
    v_mul_f32 v167, v214, v139
    v_mul_f32 v139, v210, v139
    s_waitcnt vmcnt(6)
    v_mfma_f32_16x16x32_bf16 v[148:151], v[176:179], v[88:91], v[148:151]
    ds_read_b128 v[196:199], v6 offset:29696
    v_fma_f32 v167, v229, v253, -v167
    s_waitcnt lgkmcnt(4)
    v_mfma_f32_16x16x32_bf16 v[124:127], v[180:183], v[32:35], v[124:127]
    ds_read_b128 v[200:203], v6 offset:30720
    v_fma_f32 v139, v229, v252, -v139
    v_mul_f32 v168, v214, v140
    v_mfma_f32_16x16x32_bf16 v[152:155], v[180:183], v[88:91], v[152:155]
    v_mul_f32 v140, v210, v140
    s_waitcnt lgkmcnt(4)
    v_mfma_f32_16x16x32_bf16 v[128:131], v[184:187], v[32:35], v[128:131]
    ds_read_b128 v[204:207], v6 offset:31744
    v_fma_f32 v168, v230, v253, -v168
    v_fma_f32 v140, v230, v252, -v140
    v_mfma_f32_16x16x32_bf16 v[156:159], v[184:187], v[88:91], v[156:159]
    global_load_dwordx4 v[48:51], v2, s[72:73] offset:-2048 sc1
    v_mul_f32 v169, v214, v141
    s_waitcnt lgkmcnt(4)
    v_mfma_f32_16x16x32_bf16 v[132:135], v[188:191], v[32:35], v[132:135]
    global_load_dwordx4 v[104:107], v2, s[74:75] offset:-2048 sc1
    v_mul_f32 v141, v210, v141
    v_fma_f32 v169, v231, v253, -v169
    v_mfma_f32_16x16x32_bf16 v[160:163], v[188:191], v[88:91], v[160:163]
    v_fma_f32 v141, v231, v252, -v141
    s_waitcnt vmcnt(7) lgkmcnt(3)
    v_mfma_f32_16x16x32_bf16 v[120:123], v[192:195], v[36:39], v[120:123]
    ds_read_b128 v[176:179], v6 offset:32768
    v_mul_f32 v170, v214, v142
    v_mul_f32 v142, v210, v142
    s_waitcnt vmcnt(6)
    v_mfma_f32_16x16x32_bf16 v[148:151], v[192:195], v[92:95], v[148:151]
    ds_read_b128 v[180:183], v6 offset:33792
    v_fma_f32 v170, v232, v253, -v170
    s_waitcnt lgkmcnt(4)
    v_mfma_f32_16x16x32_bf16 v[124:127], v[196:199], v[36:39], v[124:127]
    ds_read_b128 v[184:187], v6 offset:34816
    v_fma_f32 v142, v232, v252, -v142
    v_mul_f32 v171, v214, v143
    v_mfma_f32_16x16x32_bf16 v[152:155], v[196:199], v[92:95], v[152:155]
    v_mul_f32 v143, v210, v143
    s_waitcnt lgkmcnt(4)
    v_mfma_f32_16x16x32_bf16 v[128:131], v[200:203], v[36:39], v[128:131]
    ds_read_b128 v[188:191], v6 offset:35840
    v_fma_f32 v171, v233, v253, -v171
    v_fma_f32 v143, v233, v252, -v143
    v_mfma_f32_16x16x32_bf16 v[156:159], v[200:203], v[92:95], v[156:159]
    global_load_dwordx4 v[52:55], v2, s[72:73] offset:-1024 sc1
    v_mul_f32 v172, v214, v144
    s_waitcnt lgkmcnt(4)
    v_mfma_f32_16x16x32_bf16 v[132:135], v[204:207], v[36:39], v[132:135]
    global_load_dwordx4 v[108:111], v2, s[74:75] offset:-1024 sc1
    v_mul_f32 v144, v210, v144
    v_fma_f32 v172, v234, v253, -v172
    v_mfma_f32_16x16x32_bf16 v[160:163], v[204:207], v[92:95], v[160:163]
    v_fma_f32 v144, v234, v252, -v144
    s_waitcnt vmcnt(7) lgkmcnt(3)
    v_mfma_f32_16x16x32_bf16 v[120:123], v[176:179], v[40:43], v[120:123]
    ds_read_b128 v[192:195], v6 offset:36864
    v_mul_f32 v173, v214, v145
    v_mul_f32 v145, v210, v145
    s_waitcnt vmcnt(6)
    v_mfma_f32_16x16x32_bf16 v[148:151], v[176:179], v[96:99], v[148:151]
    ds_read_b128 v[196:199], v6 offset:37888
    v_fma_f32 v173, v235, v253, -v173
    s_waitcnt lgkmcnt(4)
    v_mfma_f32_16x16x32_bf16 v[124:127], v[180:183], v[40:43], v[124:127]
    ds_read_b128 v[200:203], v6 offset:38912
    v_fma_f32 v145, v235, v252, -v145
    v_mul_f32 v174, v214, v146
    v_mfma_f32_16x16x32_bf16 v[152:155], v[180:183], v[96:99], v[152:155]
    v_mul_f32 v146, v210, v146
    s_waitcnt lgkmcnt(4)
    v_mfma_f32_16x16x32_bf16 v[128:131], v[184:187], v[40:43], v[128:131]
    ds_read_b128 v[204:207], v6 offset:39936
    v_fma_f32 v174, v236, v253, -v174
    v_fma_f32 v146, v236, v252, -v146
    v_mfma_f32_16x16x32_bf16 v[156:159], v[184:187], v[96:99], v[156:159]
    global_load_dwordx4 v[56:59], v2, s[72:73] offset:0 sc1
    v_mul_f32 v175, v214, v147
    s_waitcnt lgkmcnt(4)
    v_mfma_f32_16x16x32_bf16 v[132:135], v[188:191], v[40:43], v[132:135]
    global_load_dwordx4 v[112:115], v2, s[74:75] offset:0 sc1
    v_mul_f32 v147, v210, v147
    v_fma_f32 v175, v237, v253, -v175
    v_mfma_f32_16x16x32_bf16 v[160:163], v[188:191], v[96:99], v[160:163]
    v_fma_f32 v147, v237, v252, -v147
    s_waitcnt vmcnt(7) lgkmcnt(3)
    v_mfma_f32_16x16x32_bf16 v[120:123], v[192:195], v[44:47], v[120:123]
    ds_read_b128 v[216:219], v5 offset:512
    ds_read_b128 v[220:223], v5 offset:0
    s_waitcnt vmcnt(6)
    v_mfma_f32_16x16x32_bf16 v[148:151], v[192:195], v[100:103], v[148:151]
    ds_read_b128 v[176:179], v6 offset:40960
    ds_read_b128 v[180:183], v6 offset:41984
    s_waitcnt lgkmcnt(6)
    v_mfma_f32_16x16x32_bf16 v[124:127], v[196:199], v[44:47], v[124:127]
    ds_read_b128 v[184:187], v6 offset:43008
    v_mfma_f32_16x16x32_bf16 v[152:155], v[196:199], v[100:103], v[152:155]
    ds_read_b128 v[188:191], v6 offset:44032
    global_load_dwordx4 v[60:63], v2, s[72:73] offset:1024 sc1
    s_waitcnt lgkmcnt(7)
    v_mfma_f32_16x16x32_bf16 v[128:131], v[200:203], v[44:47], v[128:131]
    global_load_dwordx4 v[116:119], v2, s[74:75] offset:1024 sc1
    v_mfma_f32_16x16x32_bf16 v[156:159], v[200:203], v[100:103], v[156:159]
    s_waitcnt lgkmcnt(5)
    v_fma_f32 v120, v216, v252, v120
    v_fma_f32 v121, v217, v252, v121
    v_fma_f32 v122, v218, v252, v122
    v_fma_f32 v123, v219, v252, v123
    s_waitcnt lgkmcnt(4)
    v_fma_f32 v120, -v210, v220, v120
    v_fma_f32 v121, -v210, v221, v121
    v_mfma_f32_16x16x32_bf16 v[132:135], v[204:207], v[44:47], v[132:135]
    v_fma_f32 v122, -v210, v222, v122
    v_fma_f32 v123, -v210, v223, v123
    v_fma_f32 v148, v216, v253, v148
    v_fma_f32 v149, v217, v253, v149
    v_fma_f32 v150, v218, v253, v150
    v_mfma_f32_16x16x32_bf16 v[160:163], v[204:207], v[100:103], v[160:163]
    v_fma_f32 v151, v219, v253, v151
    v_fma_f32 v148, -v214, v220, v148
    v_fma_f32 v149, -v214, v221, v149
    v_fma_f32 v150, -v214, v222, v150
    v_fma_f32 v151, -v214, v223, v151
    s_waitcnt vmcnt(7) lgkmcnt(2)
    v_mfma_f32_16x16x32_bf16 v[124:127], v[180:183], v[48:51], v[124:127]
    ds_read_b128 v[216:219], v5 offset:576
    ds_read_b128 v[220:223], v5 offset:64
    s_waitcnt vmcnt(6)
    v_mfma_f32_16x16x32_bf16 v[152:155], v[180:183], v[104:107], v[152:155]
    ds_read_b128 v[192:195], v6 offset:45056
    ds_read_b128 v[196:199], v6 offset:46080
    s_waitcnt lgkmcnt(5)
    v_mfma_f32_16x16x32_bf16 v[128:131], v[184:187], v[48:51], v[128:131]
    ds_read_b128 v[200:203], v6 offset:47104
    v_mfma_f32_16x16x32_bf16 v[156:159], v[184:187], v[104:107], v[156:159]
    ds_read_b128 v[204:207], v6 offset:48128
    global_load_lds_dwordx4 v2, s[80:81] offset:0
    s_waitcnt lgkmcnt(6)
    v_mfma_f32_16x16x32_bf16 v[132:135], v[188:191], v[48:51], v[132:135]
    global_load_lds_dwordx4 v2, s[80:81] offset:1024
    v_mfma_f32_16x16x32_bf16 v[160:163], v[188:191], v[104:107], v[160:163]
    s_waitcnt lgkmcnt(5)
    v_fma_f32 v124, v216, v252, v124
    v_fma_f32 v125, v217, v252, v125
    v_fma_f32 v126, v218, v252, v126
    v_fma_f32 v127, v219, v252, v127
    s_waitcnt lgkmcnt(4)
    v_fma_f32 v124, -v210, v220, v124
    v_fma_f32 v125, -v210, v221, v125
    v_mfma_f32_16x16x32_bf16 v[120:123], v[176:179], v[48:51], v[120:123]
    v_fma_f32 v126, -v210, v222, v126
    v_fma_f32 v127, -v210, v223, v127
    v_fma_f32 v152, v216, v253, v152
    v_fma_f32 v153, v217, v253, v153
    v_fma_f32 v154, v218, v253, v154
    v_mfma_f32_16x16x32_bf16 v[148:151], v[176:179], v[104:107], v[148:151]
    v_fma_f32 v155, v219, v253, v155
    v_fma_f32 v152, -v214, v220, v152
    v_fma_f32 v153, -v214, v221, v153
    v_fma_f32 v154, -v214, v222, v154
    v_fma_f32 v155, -v214, v223, v155
    s_waitcnt vmcnt(7) lgkmcnt(1)
    v_mfma_f32_16x16x32_bf16 v[128:131], v[200:203], v[52:55], v[128:131]
    ds_read_b128 v[216:219], v5 offset:640
    ds_read_b128 v[220:223], v5 offset:128
    s_waitcnt vmcnt(6)
    v_mfma_f32_16x16x32_bf16 v[156:159], v[200:203], v[108:111], v[156:159]
    ds_read_b128 v[176:179], v6 offset:49152
    ds_read_b128 v[180:183], v6 offset:50176
    s_waitcnt lgkmcnt(4)
    v_mfma_f32_16x16x32_bf16 v[132:135], v[204:207], v[52:55], v[132:135]
    ds_read_b128 v[184:187], v2 offset:43008
    v_mfma_f32_16x16x32_bf16 v[160:163], v[204:207], v[108:111], v[160:163]
    ds_read_b128 v[188:191], v2 offset:44032
    global_load_lds_dwordx4 v2, s[80:81] offset:2048
    v_mfma_f32_16x16x32_bf16 v[120:123], v[192:195], v[52:55], v[120:123]
    global_load_lds_dwordx4 v2, s[80:81] offset:3072
    s_add_u32 m0, m0, 4096
    s_add_u32 s80, s80, 4096
    s_addc_u32 s81, s81, 0
    v_mfma_f32_16x16x32_bf16 v[148:151], v[192:195], v[108:111], v[148:151]
    s_waitcnt lgkmcnt(5)
    v_fma_f32 v128, v216, v252, v128
    v_fma_f32 v129, v217, v252, v129
    v_fma_f32 v130, v218, v252, v130
    v_fma_f32 v131, v219, v252, v131
    s_waitcnt lgkmcnt(4)
    v_fma_f32 v128, -v210, v220, v128
    v_fma_f32 v129, -v210, v221, v129
    v_mfma_f32_16x16x32_bf16 v[124:127], v[196:199], v[52:55], v[124:127]
    v_fma_f32 v130, -v210, v222, v130
    v_fma_f32 v131, -v210, v223, v131
    v_fma_f32 v156, v216, v253, v156
    v_fma_f32 v157, v217, v253, v157
    v_fma_f32 v158, v218, v253, v158
    v_mfma_f32_16x16x32_bf16 v[152:155], v[196:199], v[108:111], v[152:155]
    v_fma_f32 v159, v219, v253, v159
    v_fma_f32 v156, -v214, v220, v156
    v_fma_f32 v157, -v214, v221, v157
    v_fma_f32 v158, -v214, v222, v158
    v_fma_f32 v159, -v214, v223, v159
    s_waitcnt vmcnt(7) lgkmcnt(0)
    v_mfma_f32_16x16x32_bf16 v[132:135], v[188:191], v[56:59], v[132:135]
    ds_read_b128 v[216:219], v5 offset:704
    ds_read_b128 v[220:223], v5 offset:192
    s_waitcnt vmcnt(6)
    v_mfma_f32_16x16x32_bf16 v[160:163], v[188:191], v[112:115], v[160:163]
    ds_read_b128 v[192:195], v2 offset:45056
    ds_read_b128 v[196:199], v2 offset:46080
    v_mfma_f32_16x16x32_bf16 v[120:123], v[176:179], v[56:59], v[120:123]
    ds_read_b128 v[200:203], v2 offset:47104
    v_mfma_f32_16x16x32_bf16 v[148:151], v[176:179], v[112:115], v[148:151]
    ds_read_b128 v[204:207], v2 offset:48128
    global_load_lds_dwordx4 v2, s[80:81] offset:0
    v_mfma_f32_16x16x32_bf16 v[124:127], v[180:183], v[56:59], v[124:127]
    global_load_lds_dwordx4 v2, s[80:81] offset:1024
    v_mfma_f32_16x16x32_bf16 v[152:155], v[180:183], v[112:115], v[152:155]
    s_waitcnt lgkmcnt(5)
    v_fma_f32 v132, v216, v252, v132
    v_fma_f32 v133, v217, v252, v133
    v_fma_f32 v134, v218, v252, v134
    v_fma_f32 v135, v219, v252, v135
    s_waitcnt lgkmcnt(4)
    v_fma_f32 v132, -v210, v220, v132
    v_fma_f32 v133, -v210, v221, v133
    v_mfma_f32_16x16x32_bf16 v[128:131], v[184:187], v[56:59], v[128:131]
    v_fma_f32 v134, -v210, v222, v134
    v_fma_f32 v135, -v210, v223, v135
    v_fma_f32 v160, v216, v253, v160
    v_fma_f32 v161, v217, v253, v161
    v_fma_f32 v162, v218, v253, v162
    v_mfma_f32_16x16x32_bf16 v[156:159], v[184:187], v[112:115], v[156:159]
    v_fma_f32 v163, v219, v253, v163
    v_fma_f32 v160, -v214, v220, v160
    v_fma_f32 v161, -v214, v221, v161
    v_fma_f32 v162, -v214, v222, v162
    v_fma_f32 v163, -v214, v223, v163
    s_waitcnt vmcnt(7) lgkmcnt(3)
    v_mfma_f32_16x16x32_bf16 v[120:123], v[192:195], v[60:63], v[120:123]
    global_load_lds_dwordx4 v2, s[80:81] offset:2048
    s_waitcnt vmcnt(7)
    v_mfma_f32_16x16x32_bf16 v[148:151], v[192:195], v[116:119], v[148:151]
    s_waitcnt lgkmcnt(2)
    v_mfma_f32_16x16x32_bf16 v[124:127], v[196:199], v[60:63], v[124:127]
    v_mfma_f32_16x16x32_bf16 v[152:155], v[196:199], v[116:119], v[152:155]
    s_waitcnt lgkmcnt(1)
    v_mfma_f32_16x16x32_bf16 v[128:131], v[200:203], v[60:63], v[128:131]
    v_mfma_f32_16x16x32_bf16 v[156:159], v[200:203], v[116:119], v[156:159]
    s_waitcnt lgkmcnt(0)
    v_mfma_f32_16x16x32_bf16 v[132:135], v[204:207], v[60:63], v[132:135]
    v_mfma_f32_16x16x32_bf16 v[160:163], v[204:207], v[116:119], v[160:163]
    v_pk_mul_f32 v[208:209], v[120:121], v[120:121]
    v_pk_mul_f32 v[210:211], v[122:123], v[122:123]
    v_pk_fma_f32 v[208:209], v[208:209], v[240:241], v[240:241] op_sel:[0,1,0] op_sel_hi:[1,1,0]
    v_pk_fma_f32 v[210:211], v[210:211], v[240:241], v[240:241] op_sel:[0,1,0] op_sel_hi:[1,1,0]
    v_pk_mul_f32 v[208:209], v[208:209], v[120:121]
    v_pk_mul_f32 v[210:211], v[210:211], v[122:123]
    v_exp_f32 v208, v208
    v_exp_f32 v209, v209
    v_exp_f32 v210, v210
    v_exp_f32 v211, v211
    v_pk_fma_f32 v[208:209], v[208:209], v[252:253], v[252:253] op_sel:[0,0,0] op_sel_hi:[1,0,0]
    v_pk_fma_f32 v[210:211], v[210:211], v[252:253], v[252:253] op_sel:[0,0,0] op_sel_hi:[1,0,0]
    v_rcp_f32 v208, v208
    v_rcp_f32 v209, v209
    v_rcp_f32 v210, v210
    v_rcp_f32 v211, v211
    v_pk_mul_f32 v[120:121], v[120:121], v[208:209]
    v_pk_mul_f32 v[122:123], v[122:123], v[210:211]
    v_cvt_pk_bf16_f32 v120, v120, v121
    v_cvt_pk_bf16_f32 v121, v122, v123
    v_pk_mul_f32 v[212:213], v[124:125], v[124:125]
    v_pk_mul_f32 v[214:215], v[126:127], v[126:127]
    v_pk_fma_f32 v[212:213], v[212:213], v[240:241], v[240:241] op_sel:[0,1,0] op_sel_hi:[1,1,0]
    v_pk_fma_f32 v[214:215], v[214:215], v[240:241], v[240:241] op_sel:[0,1,0] op_sel_hi:[1,1,0]
    v_pk_mul_f32 v[212:213], v[212:213], v[124:125]
    v_pk_mul_f32 v[214:215], v[214:215], v[126:127]
    v_exp_f32 v212, v212
    v_exp_f32 v213, v213
    v_exp_f32 v214, v214
    v_exp_f32 v215, v215
    v_pk_fma_f32 v[212:213], v[212:213], v[252:253], v[252:253] op_sel:[0,0,0] op_sel_hi:[1,0,0]
    v_pk_fma_f32 v[214:215], v[214:215], v[252:253], v[252:253] op_sel:[0,0,0] op_sel_hi:[1,0,0]
    v_rcp_f32 v212, v212
    v_rcp_f32 v213, v213
    v_rcp_f32 v214, v214
    v_rcp_f32 v215, v215
    v_pk_mul_f32 v[124:125], v[124:125], v[212:213]
    v_pk_mul_f32 v[126:127], v[126:127], v[214:215]
    v_cvt_pk_bf16_f32 v122, v124, v125
    v_cvt_pk_bf16_f32 v123, v126, v127
    buffer_store_dwordx4 v[120:123], v2, s[4:7], s62 offen offset:0
    v_pk_mul_f32 v[216:217], v[148:149], v[148:149]
    v_pk_mul_f32 v[218:219], v[150:151], v[150:151]
    v_pk_fma_f32 v[216:217], v[216:217], v[242:243], v[242:243] op_sel:[0,1,0] op_sel_hi:[1,1,0]
    v_pk_fma_f32 v[218:219], v[218:219], v[242:243], v[242:243] op_sel:[0,1,0] op_sel_hi:[1,1,0]
    v_pk_mul_f32 v[216:217], v[216:217], v[148:149]
    v_pk_mul_f32 v[218:219], v[218:219], v[150:151]
    v_exp_f32 v216, v216
    v_exp_f32 v217, v217
    v_exp_f32 v218, v218
    v_exp_f32 v219, v219
    v_pk_fma_f32 v[216:217], v[216:217], v[252:253], v[252:253] op_sel:[0,1,1] op_sel_hi:[1,1,1]
    v_pk_fma_f32 v[218:219], v[218:219], v[252:253], v[252:253] op_sel:[0,1,1] op_sel_hi:[1,1,1]
    v_rcp_f32 v216, v216
    v_rcp_f32 v217, v217
    v_rcp_f32 v218, v218
    v_rcp_f32 v219, v219
    v_pk_mul_f32 v[148:149], v[148:149], v[216:217]
    v_pk_mul_f32 v[150:151], v[150:151], v[218:219]
    v_cvt_pk_bf16_f32 v148, v148, v149
    v_cvt_pk_bf16_f32 v149, v150, v151
    v_pk_mul_f32 v[220:221], v[152:153], v[152:153]
    v_pk_mul_f32 v[222:223], v[154:155], v[154:155]
    v_pk_fma_f32 v[220:221], v[220:221], v[242:243], v[242:243] op_sel:[0,1,0] op_sel_hi:[1,1,0]
    v_pk_fma_f32 v[222:223], v[222:223], v[242:243], v[242:243] op_sel:[0,1,0] op_sel_hi:[1,1,0]
    v_pk_mul_f32 v[220:221], v[220:221], v[152:153]
    v_pk_mul_f32 v[222:223], v[222:223], v[154:155]
    v_exp_f32 v220, v220
    v_exp_f32 v221, v221
    v_exp_f32 v222, v222
    v_exp_f32 v223, v223
    v_pk_fma_f32 v[220:221], v[220:221], v[252:253], v[252:253] op_sel:[0,1,1] op_sel_hi:[1,1,1]
    v_pk_fma_f32 v[222:223], v[222:223], v[252:253], v[252:253] op_sel:[0,1,1] op_sel_hi:[1,1,1]
    v_rcp_f32 v220, v220
    v_rcp_f32 v221, v221
    v_rcp_f32 v222, v222
    v_rcp_f32 v223, v223
    v_pk_mul_f32 v[152:153], v[152:153], v[220:221]
    v_pk_mul_f32 v[154:155], v[154:155], v[222:223]
    v_cvt_pk_bf16_f32 v150, v152, v153
    v_cvt_pk_bf16_f32 v151, v154, v155
    buffer_store_dwordx4 v[148:151], v2, s[4:7], s63 offen offset:0
    v_pk_mul_f32 v[208:209], v[128:129], v[128:129]
    v_pk_mul_f32 v[210:211], v[130:131], v[130:131]
    v_pk_fma_f32 v[208:209], v[208:209], v[240:241], v[240:241] op_sel:[0,1,0] op_sel_hi:[1,1,0]
    v_pk_fma_f32 v[210:211], v[210:211], v[240:241], v[240:241] op_sel:[0,1,0] op_sel_hi:[1,1,0]
    v_pk_mul_f32 v[208:209], v[208:209], v[128:129]
    v_pk_mul_f32 v[210:211], v[210:211], v[130:131]
    v_exp_f32 v208, v208
    v_exp_f32 v209, v209
    v_exp_f32 v210, v210
    v_exp_f32 v211, v211
    v_pk_fma_f32 v[208:209], v[208:209], v[252:253], v[252:253] op_sel:[0,0,0] op_sel_hi:[1,0,0]
    v_pk_fma_f32 v[210:211], v[210:211], v[252:253], v[252:253] op_sel:[0,0,0] op_sel_hi:[1,0,0]
    v_rcp_f32 v208, v208
    v_rcp_f32 v209, v209
    v_rcp_f32 v210, v210
    v_rcp_f32 v211, v211
    v_pk_mul_f32 v[128:129], v[128:129], v[208:209]
    v_pk_mul_f32 v[130:131], v[130:131], v[210:211]
    v_cvt_pk_bf16_f32 v128, v128, v129
    v_cvt_pk_bf16_f32 v129, v130, v131
    v_pk_mul_f32 v[212:213], v[132:133], v[132:133]
    v_pk_mul_f32 v[214:215], v[134:135], v[134:135]
    v_pk_fma_f32 v[212:213], v[212:213], v[240:241], v[240:241] op_sel:[0,1,0] op_sel_hi:[1,1,0]
    v_pk_fma_f32 v[214:215], v[214:215], v[240:241], v[240:241] op_sel:[0,1,0] op_sel_hi:[1,1,0]
    v_pk_mul_f32 v[212:213], v[212:213], v[132:133]
    v_pk_mul_f32 v[214:215], v[214:215], v[134:135]
    v_exp_f32 v212, v212
    v_exp_f32 v213, v213
    v_exp_f32 v214, v214
    v_exp_f32 v215, v215
    v_pk_fma_f32 v[212:213], v[212:213], v[252:253], v[252:253] op_sel:[0,0,0] op_sel_hi:[1,0,0]
    v_pk_fma_f32 v[214:215], v[214:215], v[252:253], v[252:253] op_sel:[0,0,0] op_sel_hi:[1,0,0]
    v_rcp_f32 v212, v212
    v_rcp_f32 v213, v213
    v_rcp_f32 v214, v214
    v_rcp_f32 v215, v215
    v_pk_mul_f32 v[132:133], v[132:133], v[212:213]
    v_pk_mul_f32 v[134:135], v[134:135], v[214:215]
    v_cvt_pk_bf16_f32 v130, v132, v133
    v_cvt_pk_bf16_f32 v131, v134, v135
    buffer_store_dwordx4 v[128:131], v2, s[4:7], s62 offen offset:1024
    v_pk_mul_f32 v[216:217], v[156:157], v[156:157]
    v_pk_mul_f32 v[218:219], v[158:159], v[158:159]
    v_pk_fma_f32 v[216:217], v[216:217], v[242:243], v[242:243] op_sel:[0,1,0] op_sel_hi:[1,1,0]
    v_pk_fma_f32 v[218:219], v[218:219], v[242:243], v[242:243] op_sel:[0,1,0] op_sel_hi:[1,1,0]
    v_pk_mul_f32 v[216:217], v[216:217], v[156:157]
    v_pk_mul_f32 v[218:219], v[218:219], v[158:159]
    v_exp_f32 v216, v216
    v_exp_f32 v217, v217
    v_exp_f32 v218, v218
    v_exp_f32 v219, v219
    v_pk_fma_f32 v[216:217], v[216:217], v[252:253], v[252:253] op_sel:[0,1,1] op_sel_hi:[1,1,1]
    v_pk_fma_f32 v[218:219], v[218:219], v[252:253], v[252:253] op_sel:[0,1,1] op_sel_hi:[1,1,1]
    v_rcp_f32 v216, v216
    v_rcp_f32 v217, v217
    v_rcp_f32 v218, v218
    v_rcp_f32 v219, v219
    v_pk_mul_f32 v[156:157], v[156:157], v[216:217]
    v_pk_mul_f32 v[158:159], v[158:159], v[218:219]
    v_cvt_pk_bf16_f32 v156, v156, v157
    v_cvt_pk_bf16_f32 v157, v158, v159
    s_mov_b32 m0, s37
    ds_read_b128 v[176:179], v2 offset:39936
    ds_read_b128 v[180:183], v2 offset:40960
    ds_read_b128 v[184:187], v2 offset:41984
    ds_read_b128 v[188:191], v2 offset:36864
    ds_read_b128 v[192:195], v2 offset:37888
    ds_read_b128 v[196:199], v2 offset:38912
    v_pk_mul_f32 v[220:221], v[160:161], v[160:161]
    v_pk_mul_f32 v[222:223], v[162:163], v[162:163]
    v_pk_fma_f32 v[220:221], v[220:221], v[242:243], v[242:243] op_sel:[0,1,0] op_sel_hi:[1,1,0]
    v_pk_fma_f32 v[222:223], v[222:223], v[242:243], v[242:243] op_sel:[0,1,0] op_sel_hi:[1,1,0]
    v_pk_mul_f32 v[220:221], v[220:221], v[160:161]
    v_pk_mul_f32 v[222:223], v[222:223], v[162:163]
    v_exp_f32 v220, v220
    v_exp_f32 v221, v221
    v_exp_f32 v222, v222
    v_exp_f32 v223, v223
    v_pk_fma_f32 v[220:221], v[220:221], v[252:253], v[252:253] op_sel:[0,1,1] op_sel_hi:[1,1,1]
    v_pk_fma_f32 v[222:223], v[222:223], v[252:253], v[252:253] op_sel:[0,1,1] op_sel_hi:[1,1,1]
    v_rcp_f32 v220, v220
    v_rcp_f32 v221, v221
    v_rcp_f32 v222, v222
    v_rcp_f32 v223, v223
    v_pk_mul_f32 v[160:161], v[160:161], v[220:221]
    v_pk_mul_f32 v[162:163], v[162:163], v[222:223]
    v_cvt_pk_bf16_f32 v158, v160, v161
    v_cvt_pk_bf16_f32 v159, v162, v163
    buffer_store_dwordx4 v[156:159], v2, s[4:7], s63 offen offset:1024
    s_waitcnt lgkmcnt(5)
    v_mfma_f32_16x16x32_bf16 v[136:139], v[176:179], v[8:11], v[136:139]
    ds_read_b128 v[200:203], v2 offset:33792
    s_mul_i32 s61, s8, 14336
    s_mul_i32 s59, s55, 57344
    v_mfma_f32_16x16x32_bf16 v[164:167], v[176:179], v[64:67], v[164:167]
    s_add_u32 s61, s61, s59
    s_waitcnt lgkmcnt(5)
    v_mfma_f32_16x16x32_bf16 v[140:143], v[180:183], v[8:11], v[140:143]
    ds_read_b128 v[204:207], v2 offset:34816
    s_add_u32 s61, s61, s49
    s_add_u32 s61, s61, 4096
    v_mfma_f32_16x16x32_bf16 v[168:171], v[180:183], v[64:67], v[168:171]
    s_add_u32 s72, s92, s61
    s_addc_u32 s73, s93, 0
    s_waitcnt lgkmcnt(5)
    v_mfma_f32_16x16x32_bf16 v[144:147], v[184:187], v[8:11], v[144:147]
    ds_read_b128 v[208:211], v2 offset:35840
    s_add_u32 s61, s61, 8192
    s_add_u32 s74, s92, s61
    s_addc_u32 s75, s93, 0
    v_mfma_f32_16x16x32_bf16 v[172:175], v[184:187], v[64:67], v[172:175]
    s_add_u32 s59, s8, 0
    s_waitcnt lgkmcnt(5)
    v_mfma_f32_16x16x32_bf16 v[136:139], v[188:191], v[12:15], v[136:139]
    ds_read_b128 v[176:179], v2 offset:30720
    s_and_b32 s59, s59, 3
    s_mul_i32 s58, s59, 57344
    v_mfma_f32_16x16x32_bf16 v[164:167], v[188:191], v[68:71], v[164:167]
    v_add_u32 v232, s58, v2
    s_mul_i32 s32, s59, 12288
    s_waitcnt lgkmcnt(5)
    v_mfma_f32_16x16x32_bf16 v[140:143], v[192:195], v[12:15], v[140:143]
    ds_read_b128 v[180:183], v2 offset:31744
    s_add_u32 s59, s8, 1
    v_mfma_f32_16x16x32_bf16 v[168:171], v[192:195], v[68:71], v[168:171]
    s_and_b32 s59, s59, 3
    s_mul_i32 s58, s59, 57344
    s_waitcnt lgkmcnt(5)
    v_mfma_f32_16x16x32_bf16 v[144:147], v[196:199], v[12:15], v[144:147]
    ds_read_b128 v[184:187], v2 offset:32768
    v_add_u32 v233, s58, v2
    s_mul_i32 s33, s59, 12288
    v_mfma_f32_16x16x32_bf16 v[172:175], v[196:199], v[68:71], v[172:175]
    s_add_u32 s59, s8, 2
    s_waitcnt vmcnt(0)
    s_barrier
    s_cmp_lg_u32 s8, 0
    s_cbranch_scc1 sga_e
    s_lshl_b32 s56, s9, 7
    s_add_u32 s56, s56, 8192
    s_add_u32 s56, s56, s50
    v_mov_b32 v228, 0
    v_mov_b32 v229, 1
    s_mov_b64 exec, 1
    s_cmp_eq_u32 s83, 1
    s_cbranch_scc0 sga_s
    s_lshl_b32 s57, s10, 2
    s_add_u32 s56, s56, s57
    buffer_store_dword v229, v228, s[4:7], s56 offen
    s_branch sga_x
sga_s:
    buffer_wbl2 sc1
    s_waitcnt vmcnt(0)
    buffer_atomic_add v229, v228, s[4:7], s56 offen offset:64 sc1
sga_x:
    s_mov_b64 exec, -1
sga_e:
    s_waitcnt lgkmcnt(5)
    v_mfma_f32_16x16x32_bf16 v[136:139], v[200:203], v[16:19], v[136:139]
    ds_read_b128 v[188:191], v2 offset:27648
    s_and_b32 s59, s59, 3
    s_mul_i32 s58, s59, 57344
    v_mfma_f32_16x16x32_bf16 v[164:167], v[200:203], v[72:75], v[164:167]
    ds_read_b128 v[192:195], v2 offset:28672
    v_add_u32 v234, s58, v2
    s_mul_i32 s34, s59, 12288
    s_waitcnt lgkmcnt(6)
    v_mfma_f32_16x16x32_bf16 v[140:143], v[204:207], v[16:19], v[140:143]
    s_add_u32 s59, s8, 3
    v_mfma_f32_16x16x32_bf16 v[168:171], v[204:207], v[72:75], v[168:171]
    ds_read_b128 v[196:199], v2 offset:29696
    s_and_b32 s59, s59, 3
    s_mul_i32 s58, s59, 57344
    s_waitcnt lgkmcnt(6)
    v_mfma_f32_16x16x32_bf16 v[144:147], v[208:211], v[16:19], v[144:147]
    global_load_lds_dwordx4 v2, s[78:79] offset:0
    v_add_u32 v235, s58, v2
    s_mul_i32 s35, s59, 12288
    v_mfma_f32_16x16x32_bf16 v[172:175], v[208:211], v[72:75], v[172:175]
    s_mov_b32 s40, 0x10000
    s_waitcnt lgkmcnt(5)
    v_mfma_f32_16x16x32_bf16 v[136:139], v[176:179], v[20:23], v[136:139]
    ds_read_b128 v[200:203], v2 offset:24576
    s_cmp_eq_u32 s83, 1
    s_cselect_b32 s38, 1, 16
    s_cselect_b32 s40, 0xffff, s40
    s_mov_b32 s41, 0
    v_mfma_f32_16x16x32_bf16 v[164:167], v[176:179], v[76:79], v[164:167]
    ds_read_b128 v[204:207], v2 offset:25600
    s_lshl_b32 s59, s9, 7
    s_add_u32 s59, s59, s50
    s_waitcnt lgkmcnt(6)
    v_mfma_f32_16x16x32_bf16 v[140:143], v[180:183], v[20:23], v[140:143]
    s_add_u32 s59, s59, 8192
    v_mfma_f32_16x16x32_bf16 v[168:171], v[180:183], v[76:79], v[168:171]
    ds_read_b128 v[208:211], v2 offset:26624
    v_and_b32 v230, 31, v1
    v_lshl_add_u32 v230, v230, 2, s59
    s_waitcnt lgkmcnt(6)
    v_mfma_f32_16x16x32_bf16 v[144:147], v[184:187], v[20:23], v[144:147]
    global_load_lds_dwordx4 v2, s[78:79] offset:1024
    v_lshrrev_b32 v5, 1, v4
    v_and_b32 v7, 1, v4
    v_mfma_f32_16x16x32_bf16 v[172:175], v[184:187], v[76:79], v[172:175]
    v_lshl_or_b32 v5, v7, 1, v5
    s_waitcnt lgkmcnt(5)
    v_mfma_f32_16x16x32_bf16 v[136:139], v[188:191], v[24:27], v[136:139]
    ds_read_b128 v[176:179], v2 offset:21504
    v_mul_u32_u24 v7, 896, v3
    v_lshl_add_u32 v7, v5, 4, v7
    v_mfma_f32_16x16x32_bf16 v[164:167], v[188:191], v[80:83], v[164:167]
    ds_read_b128 v[180:183], v2 offset:22528
    v_lshlrev_b32 v5, 8, v5
    v_lshl_add_u32 v5, v3, 4, v5
    s_waitcnt lgkmcnt(6)
    v_mfma_f32_16x16x32_bf16 v[140:143], v[192:195], v[24:27], v[140:143]
    s_mov_b32 s66, s68
    v_mfma_f32_16x16x32_bf16 v[168:171], v[192:195], v[80:83], v[168:171]
    ds_read_b128 v[184:187], v2 offset:23552
    s_add_u32 s67, s55, s8
    s_mul_i32 s67, s67, 14336
    s_waitcnt lgkmcnt(6)
    v_mfma_f32_16x16x32_bf16 v[144:147], v[196:199], v[24:27], v[144:147]
    global_load_lds_dwordx4 v2, s[78:79] offset:2048
    s_lshl_b32 s59, s19, 11
    s_add_u32 s67, s67, s59
    v_mfma_f32_16x16x32_bf16 v[172:175], v[196:199], v[80:83], v[172:175]
    s_add_u32 s67, s67, 4558848
    s_waitcnt lgkmcnt(5)
    v_mfma_f32_16x16x32_bf16 v[136:139], v[200:203], v[28:31], v[136:139]
    ds_read_b128 v[188:191], v2 offset:18432
    v_accvgpr_read_b32 v216, a240
    v_mfma_f32_16x16x32_bf16 v[164:167], v[200:203], v[84:87], v[164:167]
    ds_read_b128 v[192:195], v2 offset:19456
    v_lshlrev_b32 v8, 16, v244
    s_waitcnt lgkmcnt(6)
    v_mfma_f32_16x16x32_bf16 v[140:143], v[204:207], v[28:31], v[140:143]
    v_and_b32 v9, s60, v244
    v_mfma_f32_16x16x32_bf16 v[168:171], v[204:207], v[84:87], v[168:171]
    ds_read_b128 v[196:199], v2 offset:20480
    v_and_b32 v217, s60, v216
    s_waitcnt lgkmcnt(6)
    v_mfma_f32_16x16x32_bf16 v[144:147], v[208:211], v[28:31], v[144:147]
    global_load_lds_dwordx4 v2, s[78:79] offset:3072
    s_add_u32 m0, m0, 4096
    s_add_u32 s78, s78, 4096
    s_addc_u32 s79, s79, 0
    v_lshlrev_b32 v216, 16, v216
    v_mfma_f32_16x16x32_bf16 v[172:175], v[208:211], v[84:87], v[172:175]
    v_add_f32 v9, v9, v217
    s_waitcnt lgkmcnt(5)
    v_mfma_f32_16x16x32_bf16 v[136:139], v[176:179], v[32:35], v[136:139]
    ds_read_b128 v[200:203], v2 offset:15360
    v_add_f32 v8, v8, v216
    v_mfma_f32_16x16x32_bf16 v[164:167], v[176:179], v[88:91], v[164:167]
    ds_read_b128 v[204:207], v2 offset:16384
    v_accvgpr_read_b32 v218, a241
    s_waitcnt lgkmcnt(6)
    v_mfma_f32_16x16x32_bf16 v[140:143], v[180:183], v[32:35], v[140:143]
    v_lshlrev_b32 v10, 16, v245
    v_mfma_f32_16x16x32_bf16 v[168:171], v[180:183], v[88:91], v[168:171]
    ds_read_b128 v[208:211], v2 offset:17408
    v_and_b32 v11, s60, v245
    s_waitcnt lgkmcnt(6)
    v_mfma_f32_16x16x32_bf16 v[144:147], v[184:187], v[32:35], v[144:147]
    global_load_lds_dwordx4 v2, s[78:79] offset:0
    v_and_b32 v219, s60, v218
    v_mfma_f32_16x16x32_bf16 v[172:175], v[184:187], v[88:91], v[172:175]
    v_lshlrev_b32 v218, 16, v218
    s_waitcnt lgkmcnt(5)
    v_mfma_f32_16x16x32_bf16 v[136:139], v[188:191], v[36:39], v[136:139]
    buffer_load_dword v231, v230, s[4:7], 0 offen offset:0 sc1
    v_add_f32 v11, v11, v219
    v_mfma_f32_16x16x32_bf16 v[164:167], v[188:191], v[92:95], v[164:167]
    ds_read_b128 v[176:179], v2 offset:12288
    v_add_f32 v10, v10, v218
    s_waitcnt lgkmcnt(5)
    v_mfma_f32_16x16x32_bf16 v[140:143], v[192:195], v[36:39], v[140:143]
    ds_read_b128 v[180:183], v2 offset:13312
    v_accvgpr_read_b32 v220, a242
    v_mfma_f32_16x16x32_bf16 v[168:171], v[192:195], v[92:95], v[168:171]
    ds_read_b128 v[184:187], v2 offset:14336
    v_lshlrev_b32 v12, 16, v246
    s_waitcnt lgkmcnt(6)
    v_mfma_f32_16x16x32_bf16 v[144:147], v[196:199], v[36:39], v[144:147]
    global_load_lds_dwordx4 v2, s[78:79] offset:1024
    v_and_b32 v13, s60, v246
    v_mfma_f32_16x16x32_bf16 v[172:175], v[196:199], v[92:95], v[172:175]
    v_and_b32 v221, s60, v220
    s_waitcnt lgkmcnt(5)
    v_mfma_f32_16x16x32_bf16 v[136:139], v[200:203], v[40:43], v[136:139]
    ds_read_b128 v[188:191], v2 offset:9216
    v_lshlrev_b32 v220, 16, v220
    v_mfma_f32_16x16x32_bf16 v[164:167], v[200:203], v[96:99], v[164:167]
    ds_read_b128 v[192:195], v2 offset:10240
    v_add_f32 v13, v13, v221
    s_waitcnt lgkmcnt(6)
    v_mfma_f32_16x16x32_bf16 v[140:143], v[204:207], v[40:43], v[140:143]
    v_add_f32 v12, v12, v220
    v_mfma_f32_16x16x32_bf16 v[168:171], v[204:207], v[96:99], v[168:171]
    ds_read_b128 v[196:199], v2 offset:11264
    v_accvgpr_read_b32 v222, a243
    s_waitcnt lgkmcnt(6)
    v_mfma_f32_16x16x32_bf16 v[144:147], v[208:211], v[40:43], v[144:147]
    global_load_lds_dwordx4 v2, s[78:79] offset:2048
    v_lshlrev_b32 v14, 16, v247
    v_mfma_f32_16x16x32_bf16 v[172:175], v[208:211], v[96:99], v[172:175]
    v_and_b32 v15, s60, v247
    s_waitcnt lgkmcnt(5)
    v_mfma_f32_16x16x32_bf16 v[136:139], v[176:179], v[44:47], v[136:139]
    ds_read_b128 v[200:203], v2 offset:6144
    v_and_b32 v223, s60, v222
    v_lshlrev_b32 v222, 16, v222
    v_mfma_f32_16x16x32_bf16 v[164:167], v[176:179], v[100:103], v[164:167]
    v_add_f32 v15, v15, v223
    s_waitcnt lgkmcnt(5)
    v_mfma_f32_16x16x32_bf16 v[140:143], v[180:183], v[44:47], v[140:143]
    ds_read_b128 v[204:207], v2 offset:7168
    v_add_f32 v14, v14, v222
    v_mfma_f32_16x16x32_bf16 v[168:171], v[180:183], v[100:103], v[168:171]
    v_accvgpr_read_b32 v216, a244
    s_waitcnt lgkmcnt(5)
    v_mfma_f32_16x16x32_bf16 v[144:147], v[184:187], v[44:47], v[144:147]
    ds_read_b128 v[208:211], v2 offset:8192
    v_lshlrev_b32 v16, 16, v248
    v_mfma_f32_16x16x32_bf16 v[172:175], v[184:187], v[100:103], v[172:175]
    v_and_b32 v17, s60, v248
    s_mov_b32 s57, 400000
pca_p:
    s_waitcnt vmcnt(2)
    v_cmp_ne_u32 vcc, s38, v231
    s_nop 0
    s_and_b64 vcc, vcc, s[40:41]
    s_cbranch_scc0 pca_q
    s_sub_u32 s57, s57, 1
    s_cmp_eq_u32 s57, 0
    s_cbranch_scc1 pca_q
    buffer_load_dword v231, v230, s[4:7], 0 offen offset:0 sc1
    s_waitcnt vmcnt(0)
    s_branch pca_p
pca_q:
    s_cmp_eq_u32 s83, 1
    s_cbranch_scc1 pca_e
    buffer_inv sc1
    s_waitcnt vmcnt(0)
pca_e:
    s_waitcnt lgkmcnt(5)
    v_mfma_f32_16x16x32_bf16 v[136:139], v[188:191], v[48:51], v[136:139]
    ds_read_b128 v[176:179], v2 offset:3072
    v_and_b32 v217, s60, v216
    v_mfma_f32_16x16x32_bf16 v[164:167], v[188:191], v[104:107], v[164:167]
    ds_read_b128 v[180:183], v2 offset:4096
    v_lshlrev_b32 v216, 16, v216
    s_waitcnt lgkmcnt(6)
    v_mfma_f32_16x16x32_bf16 v[140:143], v[192:195], v[48:51], v[140:143]
    ds_read_b128 v[184:187], v2 offset:5120
    v_add_f32 v17, v17, v217
    v_mfma_f32_16x16x32_bf16 v[168:171], v[192:195], v[104:107], v[168:171]
    global_load_dwordx4 v[124:127], v233, s[72:73] offset:-4096 sc1
    v_add_f32 v16, v16, v216
    s_waitcnt lgkmcnt(6)
    v_mfma_f32_16x16x32_bf16 v[144:147], v[196:199], v[48:51], v[144:147]
    global_load_dwordx4 v[128:131], v234, s[72:73] offset:-4096 sc1
    v_accvgpr_read_b32 v218, a245
    v_mfma_f32_16x16x32_bf16 v[172:175], v[196:199], v[104:107], v[172:175]
    v_lshlrev_b32 v18, 16, v249
    s_waitcnt lgkmcnt(5)
    v_mfma_f32_16x16x32_bf16 v[136:139], v[200:203], v[52:55], v[136:139]
    ds_read_b128 v[188:191], v2 offset:0
    v_and_b32 v19, s60, v249
    v_mfma_f32_16x16x32_bf16 v[164:167], v[200:203], v[108:111], v[164:167]
    ds_read_b128 v[192:195], v2 offset:1024
    v_and_b32 v219, s60, v218
    s_waitcnt lgkmcnt(6)
    v_mfma_f32_16x16x32_bf16 v[140:143], v[204:207], v[52:55], v[140:143]
    ds_read_b128 v[196:199], v2 offset:2048
    v_lshlrev_b32 v218, 16, v218
    v_mfma_f32_16x16x32_bf16 v[168:171], v[204:207], v[108:111], v[168:171]
    global_load_dwordx4 v[132:135], v235, s[72:73] offset:-4096 sc1
    v_add_f32 v19, v19, v219
    s_waitcnt lgkmcnt(6)
    v_mfma_f32_16x16x32_bf16 v[144:147], v[208:211], v[52:55], v[144:147]
    global_load_dwordx4 v[120:123], v232, s[72:73] offset:-4096 sc1
    v_add_f32 v18, v18, v218
    v_mfma_f32_16x16x32_bf16 v[172:175], v[208:211], v[108:111], v[172:175]
    v_accvgpr_read_b32 v220, a246
    s_waitcnt lgkmcnt(5)
    v_mfma_f32_16x16x32_bf16 v[136:139], v[176:179], v[56:59], v[136:139]
    global_load_dwordx4 v[152:155], v233, s[72:73] offset:-3072 sc1
    v_lshlrev_b32 v20, 16, v250
    v_mfma_f32_16x16x32_bf16 v[164:167], v[176:179], v[112:115], v[164:167]
    v_and_b32 v21, s60, v250
    s_waitcnt lgkmcnt(4)
    v_mfma_f32_16x16x32_bf16 v[140:143], v[180:183], v[56:59], v[140:143]
    v_and_b32 v221, s60, v220
    v_mfma_f32_16x16x32_bf16 v[168:171], v[180:183], v[112:115], v[168:171]
    global_load_dwordx4 v[156:159], v234, s[72:73] offset:-3072 sc1
    v_lshlrev_b32 v220, 16, v220
    s_waitcnt lgkmcnt(3)
    v_mfma_f32_16x16x32_bf16 v[144:147], v[184:187], v[56:59], v[144:147]
    v_add_f32 v21, v21, v221
    v_mfma_f32_16x16x32_bf16 v[172:175], v[184:187], v[112:115], v[172:175]
    v_add_f32 v20, v20, v220
    s_waitcnt lgkmcnt(2)
    v_mfma_f32_16x16x32_bf16 v[136:139], v[188:191], v[60:63], v[136:139]
    global_load_dwordx4 v[160:163], v235, s[72:73] offset:-3072 sc1
    v_accvgpr_read_b32 v222, a247
    v_lshlrev_b32 v22, 16, v251
    v_mfma_f32_16x16x32_bf16 v[164:167], v[188:191], v[116:119], v[164:167]
    v_and_b32 v23, s60, v251
    s_waitcnt lgkmcnt(1)
    v_mfma_f32_16x16x32_bf16 v[140:143], v[192:195], v[60:63], v[140:143]
    v_and_b32 v223, s60, v222
    v_mfma_f32_16x16x32_bf16 v[168:171], v[192:195], v[116:119], v[168:171]
    global_load_dwordx4 v[148:151], v232, s[72:73] offset:-3072 sc1
    v_lshlrev_b32 v222, 16, v222
    s_waitcnt lgkmcnt(0)
    v_mfma_f32_16x16x32_bf16 v[144:147], v[196:199], v[60:63], v[144:147]
    v_add_f32 v23, v23, v223
    v_mfma_f32_16x16x32_bf16 v[172:175], v[196:199], v[116:119], v[172:175]
    v_add_f32 v22, v22, v222
    v_pk_mul_f32 v[208:209], v[136:137], v[136:137]
    v_pk_mul_f32 v[210:211], v[138:139], v[138:139]
    v_pk_fma_f32 v[208:209], v[208:209], v[240:241], v[240:241] op_sel:[0,1,0] op_sel_hi:[1,1,0]
    v_pk_fma_f32 v[210:211], v[210:211], v[240:241], v[240:241] op_sel:[0,1,0] op_sel_hi:[1,1,0]
    v_pk_mul_f32 v[208:209], v[208:209], v[136:137]
    v_pk_mul_f32 v[210:211], v[210:211], v[138:139]
    v_exp_f32 v208, v208
    v_exp_f32 v209, v209
    v_exp_f32 v210, v210
    v_exp_f32 v211, v211
    v_pk_fma_f32 v[208:209], v[208:209], v[252:253], v[252:253] op_sel:[0,0,0] op_sel_hi:[1,0,0]
    v_pk_fma_f32 v[210:211], v[210:211], v[252:253], v[252:253] op_sel:[0,0,0] op_sel_hi:[1,0,0]
    v_rcp_f32 v208, v208
    v_rcp_f32 v209, v209
    v_rcp_f32 v210, v210
    v_rcp_f32 v211, v211
    v_pk_mul_f32 v[136:137], v[136:137], v[208:209]
    v_pk_mul_f32 v[138:139], v[138:139], v[210:211]
    v_cvt_pk_bf16_f32 v136, v136, v137
    v_cvt_pk_bf16_f32 v137, v138, v139
    global_load_dwordx4 v[76:79], v233, s[72:73] offset:-1024 sc1
    v_pk_mul_f32 v[212:213], v[140:141], v[140:141]
    v_pk_mul_f32 v[214:215], v[142:143], v[142:143]
    v_pk_fma_f32 v[212:213], v[212:213], v[240:241], v[240:241] op_sel:[0,1,0] op_sel_hi:[1,1,0]
    v_pk_fma_f32 v[214:215], v[214:215], v[240:241], v[240:241] op_sel:[0,1,0] op_sel_hi:[1,1,0]
    v_pk_mul_f32 v[212:213], v[212:213], v[140:141]
    v_pk_mul_f32 v[214:215], v[214:215], v[142:143]
    v_exp_f32 v212, v212
    v_exp_f32 v213, v213
    v_exp_f32 v214, v214
    v_exp_f32 v215, v215
    v_pk_fma_f32 v[212:213], v[212:213], v[252:253], v[252:253] op_sel:[0,0,0] op_sel_hi:[1,0,0]
    v_pk_fma_f32 v[214:215], v[214:215], v[252:253], v[252:253] op_sel:[0,0,0] op_sel_hi:[1,0,0]
    v_rcp_f32 v212, v212
    v_rcp_f32 v213, v213
    v_rcp_f32 v214, v214
    v_rcp_f32 v215, v215
    v_pk_mul_f32 v[140:141], v[140:141], v[212:213]
    v_pk_mul_f32 v[142:143], v[142:143], v[214:215]
    v_cvt_pk_bf16_f32 v138, v140, v141
    v_cvt_pk_bf16_f32 v139, v142, v143
    buffer_store_dwordx4 v[136:139], v2, s[4:7], s62 offen offset:2048
    global_load_dwordx4 v[80:83], v234, s[72:73] offset:-1024 sc1
    v_pk_mul_f32 v[216:217], v[164:165], v[164:165]
    v_pk_mul_f32 v[218:219], v[166:167], v[166:167]
    v_pk_fma_f32 v[216:217], v[216:217], v[242:243], v[242:243] op_sel:[0,1,0] op_sel_hi:[1,1,0]
    v_pk_fma_f32 v[218:219], v[218:219], v[242:243], v[242:243] op_sel:[0,1,0] op_sel_hi:[1,1,0]
    v_pk_mul_f32 v[216:217], v[216:217], v[164:165]
    v_pk_mul_f32 v[218:219], v[218:219], v[166:167]
    v_exp_f32 v216, v216
    v_exp_f32 v217, v217
    v_exp_f32 v218, v218
    v_exp_f32 v219, v219
    v_pk_fma_f32 v[216:217], v[216:217], v[252:253], v[252:253] op_sel:[0,1,1] op_sel_hi:[1,1,1]
    v_pk_fma_f32 v[218:219], v[218:219], v[252:253], v[252:253] op_sel:[0,1,1] op_sel_hi:[1,1,1]
    v_rcp_f32 v216, v216
    v_rcp_f32 v217, v217
    v_rcp_f32 v218, v218
    v_rcp_f32 v219, v219
    v_pk_mul_f32 v[164:165], v[164:165], v[216:217]
    v_pk_mul_f32 v[166:167], v[166:167], v[218:219]
    v_cvt_pk_bf16_f32 v164, v164, v165
    v_cvt_pk_bf16_f32 v165, v166, v167
    v_pk_mul_f32 v[220:221], v[168:169], v[168:169]
    v_pk_mul_f32 v[222:223], v[170:171], v[170:171]
    v_pk_fma_f32 v[220:221], v[220:221], v[242:243], v[242:243] op_sel:[0,1,0] op_sel_hi:[1,1,0]
    v_pk_fma_f32 v[222:223], v[222:223], v[242:243], v[242:243] op_sel:[0,1,0] op_sel_hi:[1,1,0]
    v_pk_mul_f32 v[220:221], v[220:221], v[168:169]
    v_pk_mul_f32 v[222:223], v[222:223], v[170:171]
    v_exp_f32 v220, v220
    v_exp_f32 v221, v221
    v_exp_f32 v222, v222
    v_exp_f32 v223, v223
    v_pk_fma_f32 v[220:221], v[220:221], v[252:253], v[252:253] op_sel:[0,1,1] op_sel_hi:[1,1,1]
    v_pk_fma_f32 v[222:223], v[222:223], v[252:253], v[252:253] op_sel:[0,1,1] op_sel_hi:[1,1,1]
    v_rcp_f32 v220, v220
    v_rcp_f32 v221, v221
    v_rcp_f32 v222, v222
    v_rcp_f32 v223, v223
    v_pk_mul_f32 v[168:169], v[168:169], v[220:221]
    v_pk_mul_f32 v[170:171], v[170:171], v[222:223]
    v_cvt_pk_bf16_f32 v166, v168, v169
    v_cvt_pk_bf16_f32 v167, v170, v171
    buffer_store_dwordx4 v[164:167], v2, s[4:7], s63 offen offset:2048
    global_load_dwordx4 v[84:87], v235, s[72:73] offset:-1024 sc1
    v_pk_mul_f32 v[208:209], v[144:145], v[144:145]
    v_pk_mul_f32 v[210:211], v[146:147], v[146:147]
    v_pk_fma_f32 v[208:209], v[208:209], v[240:241], v[240:241] op_sel:[0,1,0] op_sel_hi:[1,1,0]
    v_pk_fma_f32 v[210:211], v[210:211], v[240:241], v[240:241] op_sel:[0,1,0] op_sel_hi:[1,1,0]
    v_pk_mul_f32 v[208:209], v[208:209], v[144:145]
    v_pk_mul_f32 v[210:211], v[210:211], v[146:147]
    v_exp_f32 v208, v208
    v_exp_f32 v209, v209
    v_exp_f32 v210, v210
    v_exp_f32 v211, v211
    v_pk_fma_f32 v[208:209], v[208:209], v[252:253], v[252:253] op_sel:[0,0,0] op_sel_hi:[1,0,0]
    v_pk_fma_f32 v[210:211], v[210:211], v[252:253], v[252:253] op_sel:[0,0,0] op_sel_hi:[1,0,0]
    v_rcp_f32 v208, v208
    v_rcp_f32 v209, v209
    v_rcp_f32 v210, v210
    v_rcp_f32 v211, v211
    v_pk_mul_f32 v[144:145], v[144:145], v[208:209]
    v_pk_mul_f32 v[146:147], v[146:147], v[210:211]
    v_cvt_pk_bf16_f32 v144, v144, v145
    v_cvt_pk_bf16_f32 v145, v146, v147
    buffer_store_dwordx2 v[144:145], v2, s[4:7], s64 offen
    global_load_dwordx4 v[72:75], v232, s[72:73] offset:-1024 sc1
    v_pk_mul_f32 v[212:213], v[172:173], v[172:173]
    v_pk_mul_f32 v[214:215], v[174:175], v[174:175]
    v_pk_fma_f32 v[212:213], v[212:213], v[242:243], v[242:243] op_sel:[0,1,0] op_sel_hi:[1,1,0]
    v_pk_fma_f32 v[214:215], v[214:215], v[242:243], v[242:243] op_sel:[0,1,0] op_sel_hi:[1,1,0]
    v_pk_mul_f32 v[212:213], v[212:213], v[172:173]
    v_pk_mul_f32 v[214:215], v[214:215], v[174:175]
    v_exp_f32 v212, v212
    v_exp_f32 v213, v213
    v_exp_f32 v214, v214
    v_exp_f32 v215, v215
    v_pk_fma_f32 v[212:213], v[212:213], v[252:253], v[252:253] op_sel:[0,1,1] op_sel_hi:[1,1,1]
    v_pk_fma_f32 v[214:215], v[214:215], v[252:253], v[252:253] op_sel:[0,1,1] op_sel_hi:[1,1,1]
    v_rcp_f32 v212, v212
    v_rcp_f32 v213, v213
    v_rcp_f32 v214, v214
    v_rcp_f32 v215, v215
    v_pk_mul_f32 v[172:173], v[172:173], v[212:213]
    v_pk_mul_f32 v[174:175], v[174:175], v[214:215]
    v_cvt_pk_bf16_f32 v172, v172, v173
    v_cvt_pk_bf16_f32 v173, v174, v175
    buffer_store_dwordx2 v[172:173], v2, s[4:7], s65 offen
    s_cmp_ge_u32 s10, 14
    s_cbranch_scc1 f2_skip
    s_waitcnt vmcnt(15)
    v_mfma_f32_16x16x32_bf16 v[24:27], a[0:3], v[124:127], 0
    global_load_dwordx4 v[92:95], v233, s[72:73] offset:0 sc1
    v_mfma_f32_16x16x32_bf16 v[28:31], a[4:7], v[124:127], 0
    v_mfma_f32_16x16x32_bf16 v[32:35], a[8:11], v[124:127], 0
    v_mfma_f32_16x16x32_bf16 v[36:39], a[12:15], v[124:127], 0
    s_waitcnt vmcnt(15)
    v_mfma_f32_16x16x32_bf16 v[40:43], a[0:3], v[128:131], 0
    global_load_dwordx4 v[96:99], v234, s[72:73] offset:0 sc1
    v_mfma_f32_16x16x32_bf16 v[44:47], a[4:7], v[128:131], 0
    v_mfma_f32_16x16x32_bf16 v[48:51], a[8:11], v[128:131], 0
    v_mfma_f32_16x16x32_bf16 v[52:55], a[12:15], v[128:131], 0
    s_waitcnt vmcnt(15)
    v_mfma_f32_16x16x32_bf16 v[56:59], a[0:3], v[132:135], 0
    global_load_dwordx4 v[100:103], v235, s[72:73] offset:0 sc1
    v_mfma_f32_16x16x32_bf16 v[60:63], a[4:7], v[132:135], 0
    v_mfma_f32_16x16x32_bf16 v[64:67], a[8:11], v[132:135], 0
    v_mfma_f32_16x16x32_bf16 v[68:71], a[12:15], v[132:135], 0
    s_waitcnt vmcnt(15)
    v_mfma_f32_16x16x32_bf16 v[8:11], a[0:3], v[120:123], v[8:11]
    global_load_dwordx4 v[88:91], v232, s[72:73] offset:0 sc1
    v_mfma_f32_16x16x32_bf16 v[12:15], a[4:7], v[120:123], v[12:15]
    v_mfma_f32_16x16x32_bf16 v[16:19], a[8:11], v[120:123], v[16:19]
    v_mfma_f32_16x16x32_bf16 v[20:23], a[12:15], v[120:123], v[20:23]
    s_waitcnt vmcnt(15)
    v_mfma_f32_16x16x32_bf16 v[24:27], a[16:19], v[152:155], v[24:27]
    global_load_dwordx4 v[108:111], v233, s[72:73] offset:3072 sc1
    v_mfma_f32_16x16x32_bf16 v[28:31], a[20:23], v[152:155], v[28:31]
    v_mfma_f32_16x16x32_bf16 v[32:35], a[24:27], v[152:155], v[32:35]
    v_mfma_f32_16x16x32_bf16 v[36:39], a[28:31], v[152:155], v[36:39]
    s_waitcnt vmcnt(15)
    v_mfma_f32_16x16x32_bf16 v[40:43], a[16:19], v[156:159], v[40:43]
    global_load_dwordx4 v[112:115], v234, s[72:73] offset:3072 sc1
    v_mfma_f32_16x16x32_bf16 v[44:47], a[20:23], v[156:159], v[44:47]
    v_mfma_f32_16x16x32_bf16 v[48:51], a[24:27], v[156:159], v[48:51]
    v_mfma_f32_16x16x32_bf16 v[52:55], a[28:31], v[156:159], v[52:55]
    s_waitcnt vmcnt(15)
    v_mfma_f32_16x16x32_bf16 v[56:59], a[16:19], v[160:163], v[56:59]
    global_load_dwordx4 v[116:119], v235, s[72:73] offset:3072 sc1
    v_mfma_f32_16x16x32_bf16 v[60:63], a[20:23], v[160:163], v[60:63]
    v_mfma_f32_16x16x32_bf16 v[64:67], a[24:27], v[160:163], v[64:67]
    v_mfma_f32_16x16x32_bf16 v[68:71], a[28:31], v[160:163], v[68:71]
    s_waitcnt vmcnt(15)
    v_mfma_f32_16x16x32_bf16 v[8:11], a[16:19], v[148:151], v[8:11]
    global_load_dwordx4 v[104:107], v232, s[72:73] offset:3072 sc1
    v_mfma_f32_16x16x32_bf16 v[12:15], a[20:23], v[148:151], v[12:15]
    v_mfma_f32_16x16x32_bf16 v[16:19], a[24:27], v[148:151], v[16:19]
    v_mfma_f32_16x16x32_bf16 v[20:23], a[28:31], v[148:151], v[20:23]
    s_waitcnt vmcnt(8)
    s_barrier
    s_cmp_lg_u32 s8, 0
    s_cbranch_scc1 sgb_e
    s_lshl_b32 s56, s9, 7
    s_add_u32 s56, s56, 10240
    s_add_u32 s56, s56, s50
    v_mov_b32 v228, 0
    v_mov_b32 v229, 1
    s_mov_b64 exec, 1
    s_cmp_eq_u32 s83, 1
    s_cbranch_scc0 sgb_s
    s_lshl_b32 s57, s10, 2
    s_add_u32 s56, s56, s57
    buffer_store_dword v229, v228, s[4:7], s56 offen
    s_branch sgb_x
sgb_s:
    buffer_wbl2 sc1
    s_waitcnt vmcnt(0)
    buffer_atomic_add v229, v228, s[4:7], s56 offen offset:64 sc1
sgb_x:
    s_mov_b64 exec, -1
sgb_e:
    v_mfma_f32_16x16x32_bf16 v[24:27], a[48:51], v[76:79], v[24:27]
    global_load_dwordx4 v[180:183], v233, s[74:75] offset:-4096 sc1
    v_mfma_f32_16x16x32_bf16 v[28:31], a[52:55], v[76:79], v[28:31]
    v_mfma_f32_16x16x32_bf16 v[32:35], a[56:59], v[76:79], v[32:35]
    v_mfma_f32_16x16x32_bf16 v[36:39], a[60:63], v[76:79], v[36:39]
    v_mfma_f32_16x16x32_bf16 v[40:43], a[48:51], v[80:83], v[40:43]
    global_load_dwordx4 v[184:187], v234, s[74:75] offset:-4096 sc1
    v_mfma_f32_16x16x32_bf16 v[44:47], a[52:55], v[80:83], v[44:47]
    v_mfma_f32_16x16x32_bf16 v[48:51], a[56:59], v[80:83], v[48:51]
    v_mfma_f32_16x16x32_bf16 v[52:55], a[60:63], v[80:83], v[52:55]
    v_mfma_f32_16x16x32_bf16 v[56:59], a[48:51], v[84:87], v[56:59]
    global_load_dwordx4 v[188:191], v235, s[74:75] offset:-4096 sc1
    v_mfma_f32_16x16x32_bf16 v[60:63], a[52:55], v[84:87], v[60:63]
    v_mfma_f32_16x16x32_bf16 v[64:67], a[56:59], v[84:87], v[64:67]
    v_mfma_f32_16x16x32_bf16 v[68:71], a[60:63], v[84:87], v[68:71]
    v_mfma_f32_16x16x32_bf16 v[8:11], a[48:51], v[72:75], v[8:11]
    global_load_dwordx4 v[176:179], v232, s[74:75] offset:-4096 sc1
    v_mfma_f32_16x16x32_bf16 v[12:15], a[52:55], v[72:75], v[12:15]
    v_mfma_f32_16x16x32_bf16 v[16:19], a[56:59], v[72:75], v[16:19]
    v_mfma_f32_16x16x32_bf16 v[20:23], a[60:63], v[72:75], v[20:23]
    s_waitcnt vmcnt(11)
    v_mfma_f32_16x16x32_bf16 v[24:27], a[64:67], v[92:95], v[24:27]
    global_load_dwordx4 v[196:199], v233, s[74:75] offset:-2048 sc1
    v_mfma_f32_16x16x32_bf16 v[28:31], a[68:71], v[92:95], v[28:31]
    v_mfma_f32_16x16x32_bf16 v[32:35], a[72:75], v[92:95], v[32:35]
    v_mfma_f32_16x16x32_bf16 v[36:39], a[76:79], v[92:95], v[36:39]
    s_waitcnt vmcnt(11)
    v_mfma_f32_16x16x32_bf16 v[40:43], a[64:67], v[96:99], v[40:43]
    global_load_dwordx4 v[200:203], v234, s[74:75] offset:-2048 sc1
    v_mfma_f32_16x16x32_bf16 v[44:47], a[68:71], v[96:99], v[44:47]
    v_mfma_f32_16x16x32_bf16 v[48:51], a[72:75], v[96:99], v[48:51]
    v_mfma_f32_16x16x32_bf16 v[52:55], a[76:79], v[96:99], v[52:55]
    s_waitcnt vmcnt(11)
    v_mfma_f32_16x16x32_bf16 v[56:59], a[64:67], v[100:103], v[56:59]
    global_load_dwordx4 v[204:207], v235, s[74:75] offset:-2048 sc1
    v_mfma_f32_16x16x32_bf16 v[60:63], a[68:71], v[100:103], v[60:63]
    v_mfma_f32_16x16x32_bf16 v[64:67], a[72:75], v[100:103], v[64:67]
    v_mfma_f32_16x16x32_bf16 v[68:71], a[76:79], v[100:103], v[68:71]
    s_waitcnt vmcnt(11)
    v_mfma_f32_16x16x32_bf16 v[8:11], a[64:67], v[88:91], v[8:11]
    global_load_dwordx4 v[192:195], v232, s[74:75] offset:-2048 sc1
    v_mfma_f32_16x16x32_bf16 v[12:15], a[68:71], v[88:91], v[12:15]
    v_mfma_f32_16x16x32_bf16 v[16:19], a[72:75], v[88:91], v[16:19]
    v_mfma_f32_16x16x32_bf16 v[20:23], a[76:79], v[88:91], v[20:23]
    s_waitcnt vmcnt(11)
    v_mfma_f32_16x16x32_bf16 v[24:27], a[96:99], v[108:111], v[24:27]
    buffer_load_dword v231, v230, s[4:7], 0 offen offset:2048 sc1
    v_mfma_f32_16x16x32_bf16 v[28:31], a[100:103], v[108:111], v[28:31]
    v_mfma_f32_16x16x32_bf16 v[32:35], a[104:107], v[108:111], v[32:35]
    v_mfma_f32_16x16x32_bf16 v[36:39], a[108:111], v[108:111], v[36:39]
    global_load_dwordx4 v[124:127], v233, s[74:75] offset:-1024 sc1
    s_waitcnt vmcnt(12)
    v_mfma_f32_16x16x32_bf16 v[40:43], a[96:99], v[112:115], v[40:43]
    v_mfma_f32_16x16x32_bf16 v[44:47], a[100:103], v[112:115], v[44:47]
    v_mfma_f32_16x16x32_bf16 v[48:51], a[104:107], v[112:115], v[48:51]
    global_load_dwordx4 v[128:131], v234, s[74:75] offset:-1024 sc1
    v_mfma_f32_16x16x32_bf16 v[52:55], a[108:111], v[112:115], v[52:55]
    s_waitcnt vmcnt(12)
    v_mfma_f32_16x16x32_bf16 v[56:59], a[96:99], v[116:119], v[56:59]
    v_mfma_f32_16x16x32_bf16 v[60:63], a[100:103], v[116:119], v[60:63]
    global_load_dwordx4 v[132:135], v235, s[74:75] offset:-1024 sc1
    v_mfma_f32_16x16x32_bf16 v[64:67], a[104:107], v[116:119], v[64:67]
    v_mfma_f32_16x16x32_bf16 v[68:71], a[108:111], v[116:119], v[68:71]
    s_waitcnt vmcnt(12)
    v_mfma_f32_16x16x32_bf16 v[8:11], a[96:99], v[104:107], v[8:11]
    global_load_dwordx4 v[120:123], v232, s[74:75] offset:-1024 sc1
    v_mfma_f32_16x16x32_bf16 v[12:15], a[100:103], v[104:107], v[12:15]
    v_mfma_f32_16x16x32_bf16 v[16:19], a[104:107], v[104:107], v[16:19]
    v_mfma_f32_16x16x32_bf16 v[20:23], a[108:111], v[104:107], v[20:23]
    s_mov_b32 s57, 400000
pcb_p:
    s_waitcnt vmcnt(4)
    v_cmp_ne_u32 vcc, s38, v231
    s_nop 0
    s_and_b64 vcc, vcc, s[40:41]
    s_cbranch_scc0 pcb_q
    s_sub_u32 s57, s57, 1
    s_cmp_eq_u32 s57, 0
    s_cbranch_scc1 pcb_q
    buffer_load_dword v231, v230, s[4:7], 0 offen offset:2048 sc1
    s_waitcnt vmcnt(0)
    s_branch pcb_p
pcb_q:
    s_cmp_eq_u32 s83, 1
    s_cbranch_scc1 pcb_e
    buffer_inv sc1
    s_waitcnt vmcnt(0)
pcb_e:
    v_mfma_f32_16x16x32_bf16 v[24:27], a[112:115], v[180:183], v[24:27]
    global_load_dwordx4 v[152:155], v233, s[72:73] offset:-2048 sc1
    v_mfma_f32_16x16x32_bf16 v[28:31], a[116:119], v[180:183], v[28:31]
    v_mfma_f32_16x16x32_bf16 v[32:35], a[120:123], v[180:183], v[32:35]
    v_mfma_f32_16x16x32_bf16 v[36:39], a[124:127], v[180:183], v[36:39]
    v_mfma_f32_16x16x32_bf16 v[40:43], a[112:115], v[184:187], v[40:43]
    global_load_dwordx4 v[156:159], v234, s[72:73] offset:-2048 sc1
    v_mfma_f32_16x16x32_bf16 v[44:47], a[116:119], v[184:187], v[44:47]
    v_mfma_f32_16x16x32_bf16 v[48:51], a[120:123], v[184:187], v[48:51]
    v_mfma_f32_16x16x32_bf16 v[52:55], a[124:127], v[184:187], v[52:55]
    v_mfma_f32_16x16x32_bf16 v[56:59], a[112:115], v[188:191], v[56:59]
    global_load_dwordx4 v[160:163], v235, s[72:73] offset:-2048 sc1
    v_mfma_f32_16x16x32_bf16 v[60:63], a[116:119], v[188:191], v[60:63]
    v_mfma_f32_16x16x32_bf16 v[64:67], a[120:123], v[188:191], v[64:67]
    v_mfma_f32_16x16x32_bf16 v[68:71], a[124:127], v[188:191], v[68:71]
    v_mfma_f32_16x16x32_bf16 v[8:11], a[112:115], v[176:179], v[8:11]
    global_load_dwordx4 v[148:151], v232, s[72:73] offset:-2048 sc1
    v_mfma_f32_16x16x32_bf16 v[12:15], a[116:119], v[176:179], v[12:15]
    v_mfma_f32_16x16x32_bf16 v[16:19], a[120:123], v[176:179], v[16:19]
    v_mfma_f32_16x16x32_bf16 v[20:23], a[124:127], v[176:179], v[20:23]
    v_mfma_f32_16x16x32_bf16 v[24:27], a[144:147], v[196:199], v[24:27]
    global_load_dwordx4 v[76:79], v233, s[72:73] offset:1024 sc1
    v_mfma_f32_16x16x32_bf16 v[28:31], a[148:151], v[196:199], v[28:31]
    v_mfma_f32_16x16x32_bf16 v[32:35], a[152:155], v[196:199], v[32:35]
    v_mfma_f32_16x16x32_bf16 v[36:39], a[156:159], v[196:199], v[36:39]
    v_mfma_f32_16x16x32_bf16 v[40:43], a[144:147], v[200:203], v[40:43]
    global_load_dwordx4 v[80:83], v234, s[72:73] offset:1024 sc1
    v_mfma_f32_16x16x32_bf16 v[44:47], a[148:151], v[200:203], v[44:47]
    v_mfma_f32_16x16x32_bf16 v[48:51], a[152:155], v[200:203], v[48:51]
    v_mfma_f32_16x16x32_bf16 v[52:55], a[156:159], v[200:203], v[52:55]
    v_mfma_f32_16x16x32_bf16 v[56:59], a[144:147], v[204:207], v[56:59]
    global_load_dwordx4 v[84:87], v235, s[72:73] offset:1024 sc1
    v_mfma_f32_16x16x32_bf16 v[60:63], a[148:151], v[204:207], v[60:63]
    v_mfma_f32_16x16x32_bf16 v[64:67], a[152:155], v[204:207], v[64:67]
    v_mfma_f32_16x16x32_bf16 v[68:71], a[156:159], v[204:207], v[68:71]
    v_mfma_f32_16x16x32_bf16 v[8:11], a[144:147], v[192:195], v[8:11]
    global_load_dwordx4 v[72:75], v232, s[72:73] offset:1024 sc1
    v_mfma_f32_16x16x32_bf16 v[12:15], a[148:151], v[192:195], v[12:15]
    v_mfma_f32_16x16x32_bf16 v[16:19], a[152:155], v[192:195], v[16:19]
    v_mfma_f32_16x16x32_bf16 v[20:23], a[156:159], v[192:195], v[20:23]
    s_waitcnt vmcnt(11)
    v_mfma_f32_16x16x32_bf16 v[24:27], a[160:163], v[124:127], v[24:27]
    global_load_dwordx4 v[92:95], v233, s[74:75] offset:-3072 sc1
    v_mfma_f32_16x16x32_bf16 v[28:31], a[164:167], v[124:127], v[28:31]
    v_mfma_f32_16x16x32_bf16 v[32:35], a[168:171], v[124:127], v[32:35]
    v_mfma_f32_16x16x32_bf16 v[36:39], a[172:175], v[124:127], v[36:39]
    s_waitcnt vmcnt(11)
    v_mfma_f32_16x16x32_bf16 v[40:43], a[160:163], v[128:131], v[40:43]
    global_load_dwordx4 v[96:99], v234, s[74:75] offset:-3072 sc1
    v_mfma_f32_16x16x32_bf16 v[44:47], a[164:167], v[128:131], v[44:47]
    v_mfma_f32_16x16x32_bf16 v[48:51], a[168:171], v[128:131], v[48:51]
    v_mfma_f32_16x16x32_bf16 v[52:55], a[172:175], v[128:131], v[52:55]
    s_waitcnt vmcnt(11)
    v_mfma_f32_16x16x32_bf16 v[56:59], a[160:163], v[132:135], v[56:59]
    global_load_dwordx4 v[100:103], v235, s[74:75] offset:-3072 sc1
    v_mfma_f32_16x16x32_bf16 v[60:63], a[164:167], v[132:135], v[60:63]
    v_mfma_f32_16x16x32_bf16 v[64:67], a[168:171], v[132:135], v[64:67]
    v_mfma_f32_16x16x32_bf16 v[68:71], a[172:175], v[132:135], v[68:71]
    s_waitcnt vmcnt(11)
    v_mfma_f32_16x16x32_bf16 v[8:11], a[160:163], v[120:123], v[8:11]
    global_load_dwordx4 v[88:91], v232, s[74:75] offset:-3072 sc1
    v_mfma_f32_16x16x32_bf16 v[12:15], a[164:167], v[120:123], v[12:15]
    v_mfma_f32_16x16x32_bf16 v[16:19], a[168:171], v[120:123], v[16:19]
    v_mfma_f32_16x16x32_bf16 v[20:23], a[172:175], v[120:123], v[20:23]
    s_waitcnt vmcnt(11)
    v_mfma_f32_16x16x32_bf16 v[24:27], a[32:35], v[152:155], v[24:27]
    global_load_dwordx4 v[108:111], v233, s[74:75] offset:0 sc1
    v_mfma_f32_16x16x32_bf16 v[28:31], a[36:39], v[152:155], v[28:31]
    v_mfma_f32_16x16x32_bf16 v[32:35], a[40:43], v[152:155], v[32:35]
    v_mfma_f32_16x16x32_bf16 v[36:39], a[44:47], v[152:155], v[36:39]
    s_waitcnt vmcnt(11)
    v_mfma_f32_16x16x32_bf16 v[40:43], a[32:35], v[156:159], v[40:43]
    global_load_dwordx4 v[112:115], v234, s[74:75] offset:0 sc1
    v_mfma_f32_16x16x32_bf16 v[44:47], a[36:39], v[156:159], v[44:47]
    v_mfma_f32_16x16x32_bf16 v[48:51], a[40:43], v[156:159], v[48:51]
    v_mfma_f32_16x16x32_bf16 v[52:55], a[44:47], v[156:159], v[52:55]
    s_waitcnt vmcnt(11)
    v_mfma_f32_16x16x32_bf16 v[56:59], a[32:35], v[160:163], v[56:59]
    global_load_dwordx4 v[116:119], v235, s[74:75] offset:0 sc1
    v_mfma_f32_16x16x32_bf16 v[60:63], a[36:39], v[160:163], v[60:63]
    v_mfma_f32_16x16x32_bf16 v[64:67], a[40:43], v[160:163], v[64:67]
    v_mfma_f32_16x16x32_bf16 v[68:71], a[44:47], v[160:163], v[68:71]
    s_waitcnt vmcnt(11)
    v_mfma_f32_16x16x32_bf16 v[8:11], a[32:35], v[148:151], v[8:11]
    global_load_dwordx4 v[104:107], v232, s[74:75] offset:0 sc1
    v_mfma_f32_16x16x32_bf16 v[12:15], a[36:39], v[148:151], v[12:15]
    v_mfma_f32_16x16x32_bf16 v[16:19], a[40:43], v[148:151], v[16:19]
    v_mfma_f32_16x16x32_bf16 v[20:23], a[44:47], v[148:151], v[20:23]
    s_waitcnt vmcnt(11)
    v_mfma_f32_16x16x32_bf16 v[24:27], a[80:83], v[76:79], v[24:27]
    global_load_dwordx4 v[180:183], v233, s[72:73] offset:2048 sc1
    v_mfma_f32_16x16x32_bf16 v[28:31], a[84:87], v[76:79], v[28:31]
    v_mfma_f32_16x16x32_bf16 v[32:35], a[88:91], v[76:79], v[32:35]
    v_mfma_f32_16x16x32_bf16 v[36:39], a[92:95], v[76:79], v[36:39]
    s_waitcnt vmcnt(11)
    v_mfma_f32_16x16x32_bf16 v[40:43], a[80:83], v[80:83], v[40:43]
    global_load_dwordx4 v[184:187], v234, s[72:73] offset:2048 sc1
    v_mfma_f32_16x16x32_bf16 v[44:47], a[84:87], v[80:83], v[44:47]
    v_mfma_f32_16x16x32_bf16 v[48:51], a[88:91], v[80:83], v[48:51]
    v_mfma_f32_16x16x32_bf16 v[52:55], a[92:95], v[80:83], v[52:55]
    s_waitcnt vmcnt(11)
    v_mfma_f32_16x16x32_bf16 v[56:59], a[80:83], v[84:87], v[56:59]
    global_load_dwordx4 v[188:191], v235, s[72:73] offset:2048 sc1
    v_mfma_f32_16x16x32_bf16 v[60:63], a[84:87], v[84:87], v[60:63]
    v_mfma_f32_16x16x32_bf16 v[64:67], a[88:91], v[84:87], v[64:67]
    v_mfma_f32_16x16x32_bf16 v[68:71], a[92:95], v[84:87], v[68:71]
    s_waitcnt vmcnt(11)
    v_mfma_f32_16x16x32_bf16 v[8:11], a[80:83], v[72:75], v[8:11]
    global_load_dwordx4 v[176:179], v232, s[72:73] offset:2048 sc1
    v_mfma_f32_16x16x32_bf16 v[12:15], a[84:87], v[72:75], v[12:15]
    v_mfma_f32_16x16x32_bf16 v[16:19], a[88:91], v[72:75], v[16:19]
    v_mfma_f32_16x16x32_bf16 v[20:23], a[92:95], v[72:75], v[20:23]
    s_waitcnt vmcnt(11)
    v_mfma_f32_16x16x32_bf16 v[24:27], a[128:131], v[92:95], v[24:27]
    global_load_dwordx4 v[196:199], v233, s[74:75] offset:1024 sc1
    v_mfma_f32_16x16x32_bf16 v[28:31], a[132:135], v[92:95], v[28:31]
    v_mfma_f32_16x16x32_bf16 v[32:35], a[136:139], v[92:95], v[32:35]
    v_mfma_f32_16x16x32_bf16 v[36:39], a[140:143], v[92:95], v[36:39]
    s_waitcnt vmcnt(11)
    v_mfma_f32_16x16x32_bf16 v[40:43], a[128:131], v[96:99], v[40:43]
    global_load_dwordx4 v[200:203], v234, s[74:75] offset:1024 sc1
    v_mfma_f32_16x16x32_bf16 v[44:47], a[132:135], v[96:99], v[44:47]
    v_mfma_f32_16x16x32_bf16 v[48:51], a[136:139], v[96:99], v[48:51]
    v_mfma_f32_16x16x32_bf16 v[52:55], a[140:143], v[96:99], v[52:55]
    s_waitcnt vmcnt(11)
    v_mfma_f32_16x16x32_bf16 v[56:59], a[128:131], v[100:103], v[56:59]
    global_load_dwordx4 v[204:207], v235, s[74:75] offset:1024 sc1
    v_mfma_f32_16x16x32_bf16 v[60:63], a[132:135], v[100:103], v[60:63]
    v_mfma_f32_16x16x32_bf16 v[64:67], a[136:139], v[100:103], v[64:67]
    v_mfma_f32_16x16x32_bf16 v[68:71], a[140:143], v[100:103], v[68:71]
    s_waitcnt vmcnt(11)
    v_mfma_f32_16x16x32_bf16 v[8:11], a[128:131], v[88:91], v[8:11]
    global_load_dwordx4 v[192:195], v232, s[74:75] offset:1024 sc1
    v_mfma_f32_16x16x32_bf16 v[12:15], a[132:135], v[88:91], v[12:15]
    v_mfma_f32_16x16x32_bf16 v[16:19], a[136:139], v[88:91], v[16:19]
    v_mfma_f32_16x16x32_bf16 v[20:23], a[140:143], v[88:91], v[20:23]
    v_add_u32 v232, s32, v2
    v_add_u32 v233, s33, v2
    v_add_u32 v234, s34, v2
    v_add_u32 v235, s35, v2
    s_waitcnt vmcnt(11)
    v_mfma_f32_16x16x32_bf16 v[24:27], a[176:179], v[108:111], v[24:27]
    v_mfma_f32_16x16x32_bf16 v[28:31], a[180:183], v[108:111], v[28:31]
    v_mfma_f32_16x16x32_bf16 v[32:35], a[184:187], v[108:111], v[32:35]
    v_mfma_f32_16x16x32_bf16 v[36:39], a[188:191], v[108:111], v[36:39]
    s_waitcnt vmcnt(7)
    v_mfma_f32_16x16x32_bf16 v[24:27], a[192:195], v[180:183], v[24:27]
    v_mfma_f32_16x16x32_bf16 v[28:31], a[196:199], v[180:183], v[28:31]
    v_mfma_f32_16x16x32_bf16 v[32:35], a[200:203], v[180:183], v[32:35]
    v_mfma_f32_16x16x32_bf16 v[36:39], a[204:207], v[180:183], v[36:39]
    s_waitcnt vmcnt(3)
    v_mfma_f32_16x16x32_bf16 v[24:27], a[208:211], v[196:199], v[24:27]
    v_mfma_f32_16x16x32_bf16 v[28:31], a[212:215], v[196:199], v[28:31]
    v_mfma_f32_16x16x32_bf16 v[32:35], a[216:219], v[196:199], v[32:35]
    v_mfma_f32_16x16x32_bf16 v[36:39], a[220:223], v[196:199], v[36:39]
    v_mfma_f32_16x16x32_bf16 v[40:43], a[176:179], v[112:115], v[40:43]
    v_mfma_f32_16x16x32_bf16 v[44:47], a[180:183], v[112:115], v[44:47]
    v_mfma_f32_16x16x32_bf16 v[48:51], a[184:187], v[112:115], v[48:51]
    v_mfma_f32_16x16x32_bf16 v[52:55], a[188:191], v[112:115], v[52:55]
    v_mfma_f32_16x16x32_bf16 v[40:43], a[192:195], v[184:187], v[40:43]
    ds_write_b128 v233, v[24:27] offset:0
    v_mfma_f32_16x16x32_bf16 v[44:47], a[196:199], v[184:187], v[44:47]
    v_mfma_f32_16x16x32_bf16 v[48:51], a[200:203], v[184:187], v[48:51]
    ds_write_b128 v233, v[28:31] offset:1024
    v_mfma_f32_16x16x32_bf16 v[52:55], a[204:207], v[184:187], v[52:55]
    s_waitcnt vmcnt(2)
    v_mfma_f32_16x16x32_bf16 v[40:43], a[208:211], v[200:203], v[40:43]
    ds_write_b128 v233, v[32:35] offset:2048
    v_mfma_f32_16x16x32_bf16 v[44:47], a[212:215], v[200:203], v[44:47]
    v_mfma_f32_16x16x32_bf16 v[48:51], a[216:219], v[200:203], v[48:51]
    ds_write_b128 v233, v[36:39] offset:3072
    v_mfma_f32_16x16x32_bf16 v[52:55], a[220:223], v[200:203], v[52:55]
    v_mfma_f32_16x16x32_bf16 v[56:59], a[176:179], v[116:119], v[56:59]
    v_mfma_f32_16x16x32_bf16 v[60:63], a[180:183], v[116:119], v[60:63]
    v_mfma_f32_16x16x32_bf16 v[64:67], a[184:187], v[116:119], v[64:67]
    v_mfma_f32_16x16x32_bf16 v[68:71], a[188:191], v[116:119], v[68:71]
    v_mfma_f32_16x16x32_bf16 v[56:59], a[192:195], v[188:191], v[56:59]
    ds_write_b128 v234, v[40:43] offset:4096
    v_mfma_f32_16x16x32_bf16 v[60:63], a[196:199], v[188:191], v[60:63]
    v_mfma_f32_16x16x32_bf16 v[64:67], a[200:203], v[188:191], v[64:67]
    ds_write_b128 v234, v[44:47] offset:5120
    v_mfma_f32_16x16x32_bf16 v[68:71], a[204:207], v[188:191], v[68:71]
    s_waitcnt vmcnt(1)
    v_mfma_f32_16x16x32_bf16 v[56:59], a[208:211], v[204:207], v[56:59]
    ds_write_b128 v234, v[48:51] offset:6144
    v_mfma_f32_16x16x32_bf16 v[60:63], a[212:215], v[204:207], v[60:63]
    v_mfma_f32_16x16x32_bf16 v[64:67], a[216:219], v[204:207], v[64:67]
    ds_write_b128 v234, v[52:55] offset:7168
    v_mfma_f32_16x16x32_bf16 v[68:71], a[220:223], v[204:207], v[68:71]
    v_mfma_f32_16x16x32_bf16 v[8:11], a[176:179], v[104:107], v[8:11]
    v_mfma_f32_16x16x32_bf16 v[12:15], a[180:183], v[104:107], v[12:15]
    v_mfma_f32_16x16x32_bf16 v[16:19], a[184:187], v[104:107], v[16:19]
    v_mfma_f32_16x16x32_bf16 v[20:23], a[188:191], v[104:107], v[20:23]
    v_mfma_f32_16x16x32_bf16 v[8:11], a[192:195], v[176:179], v[8:11]
    ds_write_b128 v235, v[56:59] offset:8192
    v_mfma_f32_16x16x32_bf16 v[12:15], a[196:199], v[176:179], v[12:15]
    v_mfma_f32_16x16x32_bf16 v[16:19], a[200:203], v[176:179], v[16:19]
    ds_write_b128 v235, v[60:63] offset:9216
    v_mfma_f32_16x16x32_bf16 v[20:23], a[204:207], v[176:179], v[20:23]
    s_waitcnt vmcnt(0)
    v_mfma_f32_16x16x32_bf16 v[8:11], a[208:211], v[192:195], v[8:11]
    ds_write_b128 v235, v[64:67] offset:10240
    v_mfma_f32_16x16x32_bf16 v[12:15], a[212:215], v[192:195], v[12:15]
    v_mfma_f32_16x16x32_bf16 v[16:19], a[216:219], v[192:195], v[16:19]
    ds_write_b128 v235, v[68:71] offset:11264
    v_mfma_f32_16x16x32_bf16 v[20:23], a[220:223], v[192:195], v[20:23]
    s_waitcnt lgkmcnt(0)
    s_barrier
    ds_read_b128 v[24:27], v232 offset:0
    ds_read_b128 v[40:43], v232 offset:4096
    ds_read_b128 v[56:59], v232 offset:8192
    ds_read_b128 v[28:31], v232 offset:1024
    ds_read_b128 v[44:47], v232 offset:5120
    ds_read_b128 v[60:63], v232 offset:9216
    ds_read_b128 v[32:35], v232 offset:2048
    ds_read_b128 v[48:51], v232 offset:6144
    ds_read_b128 v[64:67], v232 offset:10240
    ds_read_b128 v[36:39], v232 offset:3072
    ds_read_b128 v[52:55], v232 offset:7168
    ds_read_b128 v[68:71], v232 offset:11264
    s_waitcnt lgkmcnt(11)
    v_pk_add_f32 v[8:9], v[8:9], v[24:25]
    v_pk_add_f32 v[10:11], v[10:11], v[26:27]
    s_waitcnt lgkmcnt(10)
    v_pk_add_f32 v[8:9], v[8:9], v[40:41]
    v_pk_add_f32 v[10:11], v[10:11], v[42:43]
    s_waitcnt lgkmcnt(9)
    v_pk_add_f32 v[8:9], v[8:9], v[56:57]
    v_pk_add_f32 v[10:11], v[10:11], v[58:59]
    v_cvt_pk_bf16_f32 v192, v8, v9
    v_cvt_pk_bf16_f32 v193, v10, v11
    s_waitcnt lgkmcnt(8)
    v_pk_add_f32 v[12:13], v[12:13], v[28:29]
    v_pk_add_f32 v[14:15], v[14:15], v[30:31]
    s_waitcnt lgkmcnt(7)
    v_pk_add_f32 v[12:13], v[12:13], v[44:45]
    v_pk_add_f32 v[14:15], v[14:15], v[46:47]
    s_waitcnt lgkmcnt(6)
    v_pk_add_f32 v[12:13], v[12:13], v[60:61]
    v_pk_add_f32 v[14:15], v[14:15], v[62:63]
    v_cvt_pk_bf16_f32 v194, v12, v13
    v_cvt_pk_bf16_f32 v195, v14, v15
    s_waitcnt lgkmcnt(5)
    v_pk_add_f32 v[16:17], v[16:17], v[32:33]
    v_pk_add_f32 v[18:19], v[18:19], v[34:35]
    s_waitcnt lgkmcnt(4)
    v_pk_add_f32 v[16:17], v[16:17], v[48:49]
    v_pk_add_f32 v[18:19], v[18:19], v[50:51]
    s_waitcnt lgkmcnt(3)
    v_pk_add_f32 v[16:17], v[16:17], v[64:65]
    v_pk_add_f32 v[18:19], v[18:19], v[66:67]
    v_cvt_pk_bf16_f32 v196, v16, v17
    v_cvt_pk_bf16_f32 v197, v18, v19
    s_waitcnt lgkmcnt(2)
    v_pk_add_f32 v[20:21], v[20:21], v[36:37]
    v_pk_add_f32 v[22:23], v[22:23], v[38:39]
    s_waitcnt lgkmcnt(1)
    v_pk_add_f32 v[20:21], v[20:21], v[52:53]
    v_pk_add_f32 v[22:23], v[22:23], v[54:55]
    s_waitcnt lgkmcnt(0)
    v_pk_add_f32 v[20:21], v[20:21], v[68:69]
    v_pk_add_f32 v[22:23], v[22:23], v[70:71]
    v_cvt_pk_bf16_f32 v198, v20, v21
    v_cvt_pk_bf16_f32 v199, v22, v23
    v_accvgpr_write_b32 a240, v192
    v_accvgpr_write_b32 a241, v193
    v_accvgpr_write_b32 a242, v194
    v_accvgpr_write_b32 a243, v195
    v_accvgpr_write_b32 a244, v196
    v_accvgpr_write_b32 a245, v197
    v_accvgpr_write_b32 a246, v198
    v_accvgpr_write_b32 a247, v199
    v_permlane16_swap_b32 v192, v194
    v_permlane16_swap_b32 v193, v195
    v_permlane16_swap_b32 v196, v198
    v_permlane16_swap_b32 v197, v199
    s_cmp_eq_u32 s11, 1
    s_cbranch_scc1 f2_out
    buffer_store_dwordx4 v[192:195], v5, s[4:7], s67 offen offset:0
    buffer_store_dwordx4 v[196:199], v5, s[4:7], s67 offen offset:1024
    s_branch f2_done
f2_out:
    buffer_store_dwordx4 v[192:195], v7, s[20:23], s66 offen offset:0 sc1
    buffer_store_dwordx4 v[196:199], v7, s[20:23], s66 offen offset:64 sc1
    s_branch f2_done
f2_skip:
    s_waitcnt vmcnt(0)
    s_barrier
    s_cmp_lg_u32 s8, 0
    s_cbranch_scc1 sgc_e
    s_lshl_b32 s56, s9, 7
    s_add_u32 s56, s56, 10240
    s_add_u32 s56, s56, s50
    v_mov_b32 v228, 0
    v_mov_b32 v229, 1
    s_mov_b64 exec, 1
    s_cmp_eq_u32 s83, 1
    s_cbranch_scc0 sgc_s
    s_lshl_b32 s57, s10, 2
    s_add_u32 s56, s56, s57
    buffer_store_dword v229, v228, s[4:7], s56 offen
    s_branch sgc_x
sgc_s:
    buffer_wbl2 sc1
    s_waitcnt vmcnt(0)
    buffer_atomic_add v229, v228, s[4:7], s56 offen offset:64 sc1
sgc_x:
    s_mov_b64 exec, -1
sgc_e:
f2_done:
    s_cmp_eq_u32 s11, 1
    s_cbranch_scc1 x_fin
    s_mov_b32 s51, 6524928
    s_mov_b32 s52, 13864960
    s_and_b32 s54, s10, 7
    s_lshl_b32 s78, s9, 1
    s_add_u32 s79, s78, s18
    s_lshr_b32 s53, s10, 3
    s_add_u32 s78, s78, s53
    s_lshl_b32 s53, s78, 2
    s_add_u32 s53, s53, s8
    s_lshl_b32 s56, s79, 7
    s_add_u32 s56, s56, 12288
    s_add_u32 s56, s56, s50
    s_lshl_b32 s57, s19, 2
    s_add_u32 s57, s56, s57
    v_lshlrev_b32 v252, 2, v1
    v_mov_b32 v253, 1
    s_lshl_b32 s58, s8, 4
    s_add_u32 s58, s58, s10
    s_waitcnt vmcnt(0)
    s_barrier
    s_cmp_ge_u32 s58, 14
    s_cbranch_scc1 sy3_n
    s_mov_b64 exec, 1
    s_cmp_eq_u32 s83, 1
    s_cbranch_scc0 sy3_s
    buffer_store_dword v253, v252, s[4:7], s57 offen
    s_branch sy3_x
sy3_s:
    buffer_wbl2 sc1
    s_waitcnt vmcnt(0)
    buffer_atomic_add v253, v252, s[4:7], s56 offen offset:64 sc1
sy3_x:
    s_mov_b64 exec, -1
sy3_n:
    s_mul_i32 s57, s53, 14336
    s_add_u32 s57, s57, 4562944
    s_add_u32 s72, s92, s57
    s_addc_u32 s73, s93, 0
    s_add_u32 s57, s57, 8192
    s_add_u32 s74, s92, s57
    s_addc_u32 s75, s93, 0
    s_lshl_b32 s38, s78, 7
    s_add_u32 s38, s38, 12288
    s_add_u32 s38, s38, s50
    v_and_b32 v252, 31, v1
    v_lshl_add_u32 v252, v252, 2, s38
    s_mov_b32 s40, 0x10000
    s_mov_b32 s41, 0
    s_cmp_eq_u32 s83, 1
    s_cselect_b32 s38, 1, 7
    s_cselect_b32 s40, 127, s40
    buffer_load_dword v253, v252, s[4:7], 0 offen sc1
    s_cmp_eq_u32 s54, 7
    s_cbranch_scc1 xq_kv
    v_mov_b32 v36, 0x3f803f80
    v_mov_b32 v37, 0x3f803f80
    v_mov_b32 v38, 0x3f803f80
    v_mov_b32 v39, 0x3f803f80
    v_add_u32 v88, 102400, v2
    s_lshl_b32 s65, s54, 8
    s_add_u32 s65, s65, 4136960
    v_lshlrev_b32 v5, 4, v4
    buffer_load_dwordx4 v[100:103], v5, s[4:7], s65 offen offset:0
    buffer_load_dwordx4 v[104:107], v5, s[4:7], s65 offen offset:64
    buffer_load_dwordx4 v[108:111], v5, s[4:7], s65 offen offset:128
    buffer_load_dwordx4 v[112:115], v5, s[4:7], s65 offen offset:192
    s_lshr_b32 s64, s53, 2
    s_mul_i32 s64, s64, 229376
    s_add_u32 s64, s64, s51
    s_bfe_u32 s65, s53, 0x10001
    s_lshl_b32 s65, s65, 15
    s_add_u32 s64, s64, s65
    s_and_b32 s65, s53, 1
    s_lshl_b32 s65, s65, 8
    s_add_u32 s64, s64, s65
    s_lshl_b32 s65, s54, 4
    v_add_u32 v5, s65, v4
    v_mul_u32_u24 v6, 147, v5
    v_lshrrev_b32 v6, 10, v6
    v_mul_u32_u24 v7, 7, v6
    v_sub_u32 v5, v5, v7
    v_lshlrev_b32 v6, 11, v6
    v_lshl_add_u32 v6, v3, 4, v6
    v_lshrrev_b32 v7, 1, v5
    v_lshl_add_u32 v6, v7, 9, v6
    v_and_b32 v5, 1, v5
    v_lshl_add_u32 v96, v5, 3, v6
    v_add_u32 v5, s65, v4
    v_add_u32 v5, 4, v5
    v_mul_u32_u24 v6, 147, v5
    v_lshrrev_b32 v6, 10, v6
    v_mul_u32_u24 v7, 7, v6
    v_sub_u32 v5, v5, v7
    v_lshlrev_b32 v6, 11, v6
    v_lshl_add_u32 v6, v3, 4, v6
    v_lshrrev_b32 v7, 1, v5
    v_lshl_add_u32 v6, v7, 9, v6
    v_and_b32 v5, 1, v5
    v_lshl_add_u32 v97, v5, 3, v6
    v_add_u32 v5, s65, v4
    v_add_u32 v5, 8, v5
    v_mul_u32_u24 v6, 147, v5
    v_lshrrev_b32 v6, 10, v6
    v_mul_u32_u24 v7, 7, v6
    v_sub_u32 v5, v5, v7
    v_lshlrev_b32 v6, 11, v6
    v_lshl_add_u32 v6, v3, 4, v6
    v_lshrrev_b32 v7, 1, v5
    v_lshl_add_u32 v6, v7, 9, v6
    v_and_b32 v5, 1, v5
    v_lshl_add_u32 v98, v5, 3, v6
    v_add_u32 v5, s65, v4
    v_add_u32 v5, 12, v5
    v_mul_u32_u24 v6, 147, v5
    v_lshrrev_b32 v6, 10, v6
    v_mul_u32_u24 v7, 7, v6
    v_sub_u32 v5, v5, v7
    v_lshlrev_b32 v6, 11, v6
    v_lshl_add_u32 v6, v3, 4, v6
    v_lshrrev_b32 v7, 1, v5
    v_lshl_add_u32 v6, v7, 9, v6
    v_and_b32 v5, 1, v5
    v_lshl_add_u32 v99, v5, 3, v6
    ds_read_b128 v[40:43], v88 offset:0
    ds_read_b128 v[44:47], v88 offset:1024
    ds_read_b128 v[48:51], v88 offset:2048
    ds_read_b128 v[52:55], v88 offset:3072
    s_mov_b32 s57, 400000
pw3a_p:
    s_waitcnt vmcnt(4)
    v_cmp_ne_u32 vcc, s38, v253
    s_nop 0
    s_and_b64 vcc, vcc, s[40:41]
    s_cbranch_scc0 pw3a_q
    s_sub_u32 s57, s57, 1
    s_cmp_eq_u32 s57, 0
    s_cbranch_scc1 pw3a_q
    buffer_load_dword v253, v252, s[4:7], 0 offen sc1
    s_waitcnt vmcnt(0)
    s_branch pw3a_p
pw3a_q:
    s_cmp_eq_u32 s83, 1
    s_cbranch_scc1 pw3a_e
    buffer_inv sc1
    s_waitcnt vmcnt(0)
pw3a_e:
    global_load_dwordx4 v[128:131], v2, s[72:73] offset:-4096 sc1
    global_load_dwordx4 v[132:135], v2, s[72:73] offset:-3072 sc1
    global_load_dwordx4 v[136:139], v2, s[72:73] offset:-2048 sc1
    global_load_dwordx4 v[140:143], v2, s[72:73] offset:-1024 sc1
    global_load_dwordx4 v[144:147], v2, s[72:73] offset:0 sc1
    global_load_dwordx4 v[148:151], v2, s[72:73] offset:1024 sc1
    global_load_dwordx4 v[152:155], v2, s[72:73] offset:2048 sc1
    s_waitcnt vmcnt(6)
    v_mfma_f32_16x16x32_bf16 v[24:27], v[36:39], v[128:131], 0
    global_load_dwordx4 v[156:159], v2, s[72:73] offset:3072 sc1
    v_mfma_f32_16x16x32_bf16 v[28:31], v[128:131], v[128:131], 0
    ds_read_b128 v[64:67], v88 offset:4096
    s_waitcnt lgkmcnt(4)
    v_mfma_f32_16x16x32_bf16 v[8:11], v[40:43], v[128:131], 0
    ds_read_b128 v[68:71], v88 offset:5120
    s_waitcnt lgkmcnt(4)
    v_mfma_f32_16x16x32_bf16 v[12:15], v[44:47], v[128:131], 0
    ds_read_b128 v[72:75], v88 offset:6144
    s_waitcnt lgkmcnt(4)
    v_mfma_f32_16x16x32_bf16 v[16:19], v[48:51], v[128:131], 0
    ds_read_b128 v[76:79], v88 offset:7168
    s_waitcnt lgkmcnt(4)
    v_mfma_f32_16x16x32_bf16 v[20:23], v[52:55], v[128:131], 0
    s_waitcnt vmcnt(6)
    v_mfma_f32_16x16x32_bf16 v[24:27], v[36:39], v[132:135], v[24:27]
    global_load_dwordx4 v[160:163], v2, s[74:75] offset:-4096 sc1
    v_mfma_f32_16x16x32_bf16 v[28:31], v[132:135], v[132:135], v[28:31]
    ds_read_b128 v[40:43], v88 offset:8192
    s_waitcnt lgkmcnt(4)
    v_mfma_f32_16x16x32_bf16 v[8:11], v[64:67], v[132:135], v[8:11]
    ds_read_b128 v[44:47], v88 offset:9216
    s_waitcnt lgkmcnt(4)
    v_mfma_f32_16x16x32_bf16 v[12:15], v[68:71], v[132:135], v[12:15]
    ds_read_b128 v[48:51], v88 offset:10240
    s_waitcnt lgkmcnt(4)
    v_mfma_f32_16x16x32_bf16 v[16:19], v[72:75], v[132:135], v[16:19]
    ds_read_b128 v[52:55], v88 offset:11264
    s_waitcnt lgkmcnt(4)
    v_mfma_f32_16x16x32_bf16 v[20:23], v[76:79], v[132:135], v[20:23]
    s_waitcnt vmcnt(6)
    v_mfma_f32_16x16x32_bf16 v[24:27], v[36:39], v[136:139], v[24:27]
    global_load_dwordx4 v[164:167], v2, s[74:75] offset:-3072 sc1
    v_mfma_f32_16x16x32_bf16 v[28:31], v[136:139], v[136:139], v[28:31]
    ds_read_b128 v[64:67], v88 offset:12288
    s_waitcnt lgkmcnt(4)
    v_mfma_f32_16x16x32_bf16 v[8:11], v[40:43], v[136:139], v[8:11]
    ds_read_b128 v[68:71], v88 offset:13312
    s_waitcnt lgkmcnt(4)
    v_mfma_f32_16x16x32_bf16 v[12:15], v[44:47], v[136:139], v[12:15]
    ds_read_b128 v[72:75], v88 offset:14336
    s_waitcnt lgkmcnt(4)
    v_mfma_f32_16x16x32_bf16 v[16:19], v[48:51], v[136:139], v[16:19]
    ds_read_b128 v[76:79], v88 offset:15360
    s_waitcnt lgkmcnt(4)
    v_mfma_f32_16x16x32_bf16 v[20:23], v[52:55], v[136:139], v[20:23]
    s_waitcnt vmcnt(6)
    v_mfma_f32_16x16x32_bf16 v[24:27], v[36:39], v[140:143], v[24:27]
    global_load_dwordx4 v[168:171], v2, s[74:75] offset:-2048 sc1
    v_mfma_f32_16x16x32_bf16 v[28:31], v[140:143], v[140:143], v[28:31]
    ds_read_b128 v[40:43], v88 offset:16384
    s_waitcnt lgkmcnt(4)
    v_mfma_f32_16x16x32_bf16 v[8:11], v[64:67], v[140:143], v[8:11]
    ds_read_b128 v[44:47], v88 offset:17408
    s_waitcnt lgkmcnt(4)
    v_mfma_f32_16x16x32_bf16 v[12:15], v[68:71], v[140:143], v[12:15]
    ds_read_b128 v[48:51], v88 offset:18432
    s_waitcnt lgkmcnt(4)
    v_mfma_f32_16x16x32_bf16 v[16:19], v[72:75], v[140:143], v[16:19]
    ds_read_b128 v[52:55], v88 offset:19456
    s_waitcnt lgkmcnt(4)
    v_mfma_f32_16x16x32_bf16 v[20:23], v[76:79], v[140:143], v[20:23]
    s_waitcnt vmcnt(6)
    v_mfma_f32_16x16x32_bf16 v[24:27], v[36:39], v[144:147], v[24:27]
    global_load_dwordx4 v[172:175], v2, s[74:75] offset:-1024 sc1
    v_mfma_f32_16x16x32_bf16 v[28:31], v[144:147], v[144:147], v[28:31]
    ds_read_b128 v[64:67], v88 offset:20480
    s_waitcnt lgkmcnt(4)
    v_mfma_f32_16x16x32_bf16 v[8:11], v[40:43], v[144:147], v[8:11]
    ds_read_b128 v[68:71], v88 offset:21504
    s_waitcnt lgkmcnt(4)
    v_mfma_f32_16x16x32_bf16 v[12:15], v[44:47], v[144:147], v[12:15]
    ds_read_b128 v[72:75], v88 offset:22528
    s_waitcnt lgkmcnt(4)
    v_mfma_f32_16x16x32_bf16 v[16:19], v[48:51], v[144:147], v[16:19]
    ds_read_b128 v[76:79], v88 offset:23552
    s_waitcnt lgkmcnt(4)
    v_mfma_f32_16x16x32_bf16 v[20:23], v[52:55], v[144:147], v[20:23]
    s_waitcnt vmcnt(6)
    v_mfma_f32_16x16x32_bf16 v[24:27], v[36:39], v[148:151], v[24:27]
    global_load_dwordx4 v[176:179], v2, s[74:75] offset:0 sc1
    v_mfma_f32_16x16x32_bf16 v[28:31], v[148:151], v[148:151], v[28:31]
    ds_read_b128 v[40:43], v88 offset:24576
    s_waitcnt lgkmcnt(4)
    v_mfma_f32_16x16x32_bf16 v[8:11], v[64:67], v[148:151], v[8:11]
    ds_read_b128 v[44:47], v88 offset:25600
    s_waitcnt lgkmcnt(4)
    v_mfma_f32_16x16x32_bf16 v[12:15], v[68:71], v[148:151], v[12:15]
    ds_read_b128 v[48:51], v88 offset:26624
    s_waitcnt lgkmcnt(4)
    v_mfma_f32_16x16x32_bf16 v[16:19], v[72:75], v[148:151], v[16:19]
    ds_read_b128 v[52:55], v88 offset:27648
    s_waitcnt lgkmcnt(4)
    v_mfma_f32_16x16x32_bf16 v[20:23], v[76:79], v[148:151], v[20:23]
    s_waitcnt vmcnt(6)
    v_mfma_f32_16x16x32_bf16 v[24:27], v[36:39], v[152:155], v[24:27]
    global_load_dwordx4 v[180:183], v2, s[74:75] offset:1024 sc1
    v_mfma_f32_16x16x32_bf16 v[28:31], v[152:155], v[152:155], v[28:31]
    ds_read_b128 v[64:67], v88 offset:28672
    s_waitcnt lgkmcnt(4)
    v_mfma_f32_16x16x32_bf16 v[8:11], v[40:43], v[152:155], v[8:11]
    ds_read_b128 v[68:71], v88 offset:29696
    s_waitcnt lgkmcnt(4)
    v_mfma_f32_16x16x32_bf16 v[12:15], v[44:47], v[152:155], v[12:15]
    ds_read_b128 v[72:75], v88 offset:30720
    s_waitcnt lgkmcnt(4)
    v_mfma_f32_16x16x32_bf16 v[16:19], v[48:51], v[152:155], v[16:19]
    ds_read_b128 v[76:79], v88 offset:31744
    s_waitcnt lgkmcnt(4)
    v_mfma_f32_16x16x32_bf16 v[20:23], v[52:55], v[152:155], v[20:23]
    s_waitcnt vmcnt(6)
    v_mfma_f32_16x16x32_bf16 v[24:27], v[36:39], v[156:159], v[24:27]
    ds_read_b128 v[40:43], v88 offset:32768
    v_mfma_f32_16x16x32_bf16 v[28:31], v[156:159], v[156:159], v[28:31]
    ds_read_b128 v[44:47], v88 offset:33792
    s_waitcnt lgkmcnt(5)
    v_mfma_f32_16x16x32_bf16 v[8:11], v[64:67], v[156:159], v[8:11]
    s_waitcnt lgkmcnt(4)
    v_mfma_f32_16x16x32_bf16 v[12:15], v[68:71], v[156:159], v[12:15]
    ds_read_b128 v[48:51], v88 offset:34816
    s_waitcnt lgkmcnt(4)
    v_mfma_f32_16x16x32_bf16 v[16:19], v[72:75], v[156:159], v[16:19]
    ds_read_b128 v[52:55], v88 offset:35840
    s_waitcnt lgkmcnt(4)
    v_mfma_f32_16x16x32_bf16 v[20:23], v[76:79], v[156:159], v[20:23]
    s_waitcnt vmcnt(5)
    v_mfma_f32_16x16x32_bf16 v[24:27], v[36:39], v[160:163], v[24:27]
    ds_read_b128 v[64:67], v88 offset:36864
    v_mfma_f32_16x16x32_bf16 v[28:31], v[160:163], v[160:163], v[28:31]
    ds_read_b128 v[68:71], v88 offset:37888
    s_waitcnt lgkmcnt(5)
    v_mfma_f32_16x16x32_bf16 v[8:11], v[40:43], v[160:163], v[8:11]
    s_waitcnt lgkmcnt(4)
    v_mfma_f32_16x16x32_bf16 v[12:15], v[44:47], v[160:163], v[12:15]
    ds_read_b128 v[72:75], v88 offset:38912
    s_waitcnt lgkmcnt(4)
    v_mfma_f32_16x16x32_bf16 v[16:19], v[48:51], v[160:163], v[16:19]
    ds_read_b128 v[76:79], v88 offset:39936
    s_waitcnt lgkmcnt(4)
    v_mfma_f32_16x16x32_bf16 v[20:23], v[52:55], v[160:163], v[20:23]
    s_waitcnt vmcnt(4)
    v_mfma_f32_16x16x32_bf16 v[24:27], v[36:39], v[164:167], v[24:27]
    ds_read_b128 v[40:43], v88 offset:40960
    v_mfma_f32_16x16x32_bf16 v[28:31], v[164:167], v[164:167], v[28:31]
    ds_read_b128 v[44:47], v88 offset:41984
    s_waitcnt lgkmcnt(5)
    v_mfma_f32_16x16x32_bf16 v[8:11], v[64:67], v[164:167], v[8:11]
    s_waitcnt lgkmcnt(4)
    v_mfma_f32_16x16x32_bf16 v[12:15], v[68:71], v[164:167], v[12:15]
    ds_read_b128 v[48:51], v88 offset:43008
    s_waitcnt lgkmcnt(4)
    v_mfma_f32_16x16x32_bf16 v[16:19], v[72:75], v[164:167], v[16:19]
    ds_read_b128 v[52:55], v88 offset:44032
    s_waitcnt lgkmcnt(4)
    v_mfma_f32_16x16x32_bf16 v[20:23], v[76:79], v[164:167], v[20:23]
    s_waitcnt vmcnt(3)
    v_mfma_f32_16x16x32_bf16 v[24:27], v[36:39], v[168:171], v[24:27]
    ds_read_b128 v[64:67], v88 offset:45056
    v_mfma_f32_16x16x32_bf16 v[28:31], v[168:171], v[168:171], v[28:31]
    ds_read_b128 v[68:71], v88 offset:46080
    s_waitcnt lgkmcnt(5)
    v_mfma_f32_16x16x32_bf16 v[8:11], v[40:43], v[168:171], v[8:11]
    s_waitcnt lgkmcnt(4)
    v_mfma_f32_16x16x32_bf16 v[12:15], v[44:47], v[168:171], v[12:15]
    ds_read_b128 v[72:75], v88 offset:47104
    s_waitcnt lgkmcnt(4)
    v_mfma_f32_16x16x32_bf16 v[16:19], v[48:51], v[168:171], v[16:19]
    ds_read_b128 v[76:79], v88 offset:48128
    s_waitcnt lgkmcnt(4)
    v_mfma_f32_16x16x32_bf16 v[20:23], v[52:55], v[168:171], v[20:23]
    s_waitcnt vmcnt(2)
    v_mfma_f32_16x16x32_bf16 v[24:27], v[36:39], v[172:175], v[24:27]
    ds_read_b128 v[40:43], v88 offset:49152
    v_mfma_f32_16x16x32_bf16 v[28:31], v[172:175], v[172:175], v[28:31]
    ds_read_b128 v[44:47], v88 offset:50176
    s_waitcnt lgkmcnt(5)
    v_mfma_f32_16x16x32_bf16 v[8:11], v[64:67], v[172:175], v[8:11]
    s_waitcnt lgkmcnt(4)
    v_mfma_f32_16x16x32_bf16 v[12:15], v[68:71], v[172:175], v[12:15]
    ds_read_b128 v[48:51], v88 offset:51200
    s_waitcnt lgkmcnt(4)
    v_mfma_f32_16x16x32_bf16 v[16:19], v[72:75], v[172:175], v[16:19]
    ds_read_b128 v[52:55], v88 offset:52224
    s_waitcnt lgkmcnt(4)
    v_mfma_f32_16x16x32_bf16 v[20:23], v[76:79], v[172:175], v[20:23]
    s_waitcnt vmcnt(1)
    v_mfma_f32_16x16x32_bf16 v[24:27], v[36:39], v[176:179], v[24:27]
    ds_read_b128 v[64:67], v88 offset:53248
    v_mfma_f32_16x16x32_bf16 v[28:31], v[176:179], v[176:179], v[28:31]
    ds_read_b128 v[68:71], v88 offset:54272
    s_waitcnt lgkmcnt(5)
    v_mfma_f32_16x16x32_bf16 v[8:11], v[40:43], v[176:179], v[8:11]
    s_waitcnt lgkmcnt(4)
    v_mfma_f32_16x16x32_bf16 v[12:15], v[44:47], v[176:179], v[12:15]
    ds_read_b128 v[72:75], v88 offset:55296
    s_waitcnt lgkmcnt(4)
    v_mfma_f32_16x16x32_bf16 v[16:19], v[48:51], v[176:179], v[16:19]
    ds_read_b128 v[76:79], v88 offset:56320
    s_waitcnt lgkmcnt(4)
    v_mfma_f32_16x16x32_bf16 v[20:23], v[52:55], v[176:179], v[20:23]
    s_waitcnt vmcnt(0)
    v_mfma_f32_16x16x32_bf16 v[24:27], v[36:39], v[180:183], v[24:27]
    v_mfma_f32_16x16x32_bf16 v[28:31], v[180:183], v[180:183], v[28:31]
    s_waitcnt lgkmcnt(3)
    v_mfma_f32_16x16x32_bf16 v[8:11], v[64:67], v[180:183], v[8:11]
    s_waitcnt lgkmcnt(2)
    v_mfma_f32_16x16x32_bf16 v[12:15], v[68:71], v[180:183], v[12:15]
    s_waitcnt lgkmcnt(1)
    v_mfma_f32_16x16x32_bf16 v[16:19], v[72:75], v[180:183], v[16:19]
    s_waitcnt lgkmcnt(0)
    v_mfma_f32_16x16x32_bf16 v[20:23], v[76:79], v[180:183], v[20:23]
    v_and_b32 v6, 3, v1
    v_cmp_eq_u32 vcc, 1, v6
    s_nop 1
    v_cndmask_b32 v116, v28, v29, vcc
    v_cmp_eq_u32 vcc, 2, v6
    s_nop 1
    v_cndmask_b32 v116, v116, v30, vcc
    v_cmp_eq_u32 vcc, 3, v6
    s_nop 1
    v_cndmask_b32 v116, v116, v31, vcc
    v_lshrrev_b32 v6, 2, v3
    v_cmp_eq_u32 vcc, v6, v4
    s_nop 1
    v_cndmask_b32 v116, 0, v116, vcc
    v_mov_b32 v117, v116
    s_nop 1
    v_permlane16_swap_b32 v116, v117
    v_add_f32 v116, v116, v117
    v_mov_b32 v117, v116
    s_nop 1
    v_permlane32_swap_b32 v116, v117
    v_add_f32 v116, v116, v117
    v_mul_f32 v118, 0x3b124925, v24
    v_mul_f32 v117, 0x3b124925, v116
    v_fma_f32 v117, -v118, v118, v117
    v_max_f32 v117, 0, v117
    v_add_f32 v117, 0x3727c5ac, v117
    v_rsq_f32 v119, v117
    s_nop 0
    v_mul_f32 v119, 0x3e8b97f6, v119
    v_fma_f32 v8, -v118, v100, v8
    v_fma_f32 v9, -v118, v101, v9
    v_fma_f32 v10, -v118, v102, v10
    v_fma_f32 v11, -v118, v103, v11
    v_mul_f32 v8, v8, v119
    v_mul_f32 v9, v9, v119
    v_mul_f32 v10, v10, v119
    v_mul_f32 v11, v11, v119
    v_cvt_pk_bf16_f32 v8, v8, v9
    v_cvt_pk_bf16_f32 v9, v10, v11
    buffer_store_dwordx2 v[8:9], v96, s[4:7], s64 offen
    v_fma_f32 v12, -v118, v104, v12
    v_fma_f32 v13, -v118, v105, v13
    v_fma_f32 v14, -v118, v106, v14
    v_fma_f32 v15, -v118, v107, v15
    v_mul_f32 v12, v12, v119
    v_mul_f32 v13, v13, v119
    v_mul_f32 v14, v14, v119
    v_mul_f32 v15, v15, v119
    v_cvt_pk_bf16_f32 v12, v12, v13
    v_cvt_pk_bf16_f32 v13, v14, v15
    buffer_store_dwordx2 v[12:13], v97, s[4:7], s64 offen
    v_fma_f32 v16, -v118, v108, v16
    v_fma_f32 v17, -v118, v109, v17
    v_fma_f32 v18, -v118, v110, v18
    v_fma_f32 v19, -v118, v111, v19
    v_mul_f32 v16, v16, v119
    v_mul_f32 v17, v17, v119
    v_mul_f32 v18, v18, v119
    v_mul_f32 v19, v19, v119
    v_cvt_pk_bf16_f32 v16, v16, v17
    v_cvt_pk_bf16_f32 v17, v18, v19
    buffer_store_dwordx2 v[16:17], v98, s[4:7], s64 offen
    v_fma_f32 v20, -v118, v112, v20
    v_fma_f32 v21, -v118, v113, v21
    v_fma_f32 v22, -v118, v114, v22
    v_fma_f32 v23, -v118, v115, v23
    v_mul_f32 v20, v20, v119
    v_mul_f32 v21, v21, v119
    v_mul_f32 v22, v22, v119
    v_mul_f32 v23, v23, v119
    v_cvt_pk_bf16_f32 v20, v20, v21
    v_cvt_pk_bf16_f32 v21, v22, v23
    buffer_store_dwordx2 v[20:21], v99, s[4:7], s64 offen
    s_branch xq_done
xq_kv:
    v_mov_b32 v36, 0x3f803f80
    v_mov_b32 v37, 0x3f803f80
    v_mov_b32 v38, 0x3f803f80
    v_mov_b32 v39, 0x3f803f80
    v_add_u32 v88, 102400, v2
    s_lshl_b32 s65, s54, 8
    s_add_u32 s65, s65, 4136960
    v_lshlrev_b32 v5, 4, v4
    buffer_load_dwordx4 v[100:103], v5, s[4:7], s65 offen offset:0
    buffer_load_dwordx4 v[104:107], v5, s[4:7], s65 offen offset:64
    v_lshlrev_b32 v5, 2, v3
    buffer_load_dword v108, v5, s[4:7], s65 offen offset:128
    buffer_load_dword v109, v5, s[4:7], s65 offen offset:192
    s_lshr_b32 s64, s53, 1
    s_lshl_b32 s64, s64, 12
    s_add_u32 s64, s64, s52
    s_and_b32 s65, s53, 1
    s_lshl_b32 s66, s65, 8
    v_lshl_add_u32 v5, v3, 4, s66
    v_lshrrev_b32 v6, 1, v4
    v_lshl_add_u32 v5, v6, 9, v5
    v_and_b32 v7, 1, v4
    v_lshl_add_u32 v96, v7, 3, v5
    v_xor_b32 v7, v7, v6
    v_lshl_add_u32 v97, v7, 3, v5
    s_lshl_b32 s66, s65, 10
    v_and_b32 v7, 1, v4
    v_lshl_add_u32 v5, v7, 9, s66
    v_lshl_add_u32 v5, v6, 3, v5
    v_lshl_add_u32 v98, v3, 4, v5
    v_lshrrev_b32 v6, 3, v3
    v_lshlrev_b32 v6, 2, v6
    v_xor_b32 v6, v6, v3
    v_lshl_add_u32 v99, v6, 4, v5
    ds_read_b128 v[40:43], v88 offset:0
    ds_read_b128 v[44:47], v88 offset:1024
    ds_read_b128 v[48:51], v88 offset:2048
    ds_read_b128 v[52:55], v88 offset:3072
    s_mov_b32 s57, 400000
pw3b_p:
    s_waitcnt vmcnt(4)
    v_cmp_ne_u32 vcc, s38, v253
    s_nop 0
    s_and_b64 vcc, vcc, s[40:41]
    s_cbranch_scc0 pw3b_q
    s_sub_u32 s57, s57, 1
    s_cmp_eq_u32 s57, 0
    s_cbranch_scc1 pw3b_q
    buffer_load_dword v253, v252, s[4:7], 0 offen sc1
    s_waitcnt vmcnt(0)
    s_branch pw3b_p
pw3b_q:
    s_cmp_eq_u32 s83, 1
    s_cbranch_scc1 pw3b_e
    buffer_inv sc1
    s_waitcnt vmcnt(0)
pw3b_e:
    global_load_dwordx4 v[128:131], v2, s[72:73] offset:-4096 sc1
    global_load_dwordx4 v[132:135], v2, s[72:73] offset:-3072 sc1
    global_load_dwordx4 v[136:139], v2, s[72:73] offset:-2048 sc1
    global_load_dwordx4 v[140:143], v2, s[72:73] offset:-1024 sc1
    global_load_dwordx4 v[144:147], v2, s[72:73] offset:0 sc1
    global_load_dwordx4 v[148:151], v2, s[72:73] offset:1024 sc1
    global_load_dwordx4 v[152:155], v2, s[72:73] offset:2048 sc1
    s_waitcnt vmcnt(6)
    v_mfma_f32_16x16x32_bf16 v[24:27], v[36:39], v[128:131], 0
    global_load_dwordx4 v[156:159], v2, s[72:73] offset:3072 sc1
    v_mfma_f32_16x16x32_bf16 v[28:31], v[128:131], v[128:131], 0
    ds_read_b128 v[64:67], v88 offset:4096
    s_waitcnt lgkmcnt(4)
    v_mfma_f32_16x16x32_bf16 v[8:11], v[40:43], v[128:131], 0
    ds_read_b128 v[68:71], v88 offset:5120
    s_waitcnt lgkmcnt(4)
    v_mfma_f32_16x16x32_bf16 v[12:15], v[44:47], v[128:131], 0
    ds_read_b128 v[72:75], v88 offset:6144
    s_waitcnt lgkmcnt(4)
    v_mfma_f32_16x16x32_bf16 v[16:19], v[128:131], v[48:51], 0
    ds_read_b128 v[76:79], v88 offset:7168
    s_waitcnt lgkmcnt(4)
    v_mfma_f32_16x16x32_bf16 v[20:23], v[128:131], v[52:55], 0
    s_waitcnt vmcnt(6)
    v_mfma_f32_16x16x32_bf16 v[24:27], v[36:39], v[132:135], v[24:27]
    global_load_dwordx4 v[160:163], v2, s[74:75] offset:-4096 sc1
    v_mfma_f32_16x16x32_bf16 v[28:31], v[132:135], v[132:135], v[28:31]
    ds_read_b128 v[40:43], v88 offset:8192
    s_waitcnt lgkmcnt(4)
    v_mfma_f32_16x16x32_bf16 v[8:11], v[64:67], v[132:135], v[8:11]
    ds_read_b128 v[44:47], v88 offset:9216
    s_waitcnt lgkmcnt(4)
    v_mfma_f32_16x16x32_bf16 v[12:15], v[68:71], v[132:135], v[12:15]
    ds_read_b128 v[48:51], v88 offset:10240
    s_waitcnt lgkmcnt(4)
    v_mfma_f32_16x16x32_bf16 v[16:19], v[132:135], v[72:75], v[16:19]
    ds_read_b128 v[52:55], v88 offset:11264
    s_waitcnt lgkmcnt(4)
    v_mfma_f32_16x16x32_bf16 v[20:23], v[132:135], v[76:79], v[20:23]
    s_waitcnt vmcnt(6)
    v_mfma_f32_16x16x32_bf16 v[24:27], v[36:39], v[136:139], v[24:27]
    global_load_dwordx4 v[164:167], v2, s[74:75] offset:-3072 sc1
    v_mfma_f32_16x16x32_bf16 v[28:31], v[136:139], v[136:139], v[28:31]
    ds_read_b128 v[64:67], v88 offset:12288
    s_waitcnt lgkmcnt(4)
    v_mfma_f32_16x16x32_bf16 v[8:11], v[40:43], v[136:139], v[8:11]
    ds_read_b128 v[68:71], v88 offset:13312
    s_waitcnt lgkmcnt(4)
    v_mfma_f32_16x16x32_bf16 v[12:15], v[44:47], v[136:139], v[12:15]
    ds_read_b128 v[72:75], v88 offset:14336
    s_waitcnt lgkmcnt(4)
    v_mfma_f32_16x16x32_bf16 v[16:19], v[136:139], v[48:51], v[16:19]
    ds_read_b128 v[76:79], v88 offset:15360
    s_waitcnt lgkmcnt(4)
    v_mfma_f32_16x16x32_bf16 v[20:23], v[136:139], v[52:55], v[20:23]
    s_waitcnt vmcnt(6)
    v_mfma_f32_16x16x32_bf16 v[24:27], v[36:39], v[140:143], v[24:27]
    global_load_dwordx4 v[168:171], v2, s[74:75] offset:-2048 sc1
    v_mfma_f32_16x16x32_bf16 v[28:31], v[140:143], v[140:143], v[28:31]
    ds_read_b128 v[40:43], v88 offset:16384
    s_waitcnt lgkmcnt(4)
    v_mfma_f32_16x16x32_bf16 v[8:11], v[64:67], v[140:143], v[8:11]
    ds_read_b128 v[44:47], v88 offset:17408
    s_waitcnt lgkmcnt(4)
    v_mfma_f32_16x16x32_bf16 v[12:15], v[68:71], v[140:143], v[12:15]
    ds_read_b128 v[48:51], v88 offset:18432
    s_waitcnt lgkmcnt(4)
    v_mfma_f32_16x16x32_bf16 v[16:19], v[140:143], v[72:75], v[16:19]
    ds_read_b128 v[52:55], v88 offset:19456
    s_waitcnt lgkmcnt(4)
    v_mfma_f32_16x16x32_bf16 v[20:23], v[140:143], v[76:79], v[20:23]
    s_waitcnt vmcnt(6)
    v_mfma_f32_16x16x32_bf16 v[24:27], v[36:39], v[144:147], v[24:27]
    global_load_dwordx4 v[172:175], v2, s[74:75] offset:-1024 sc1
    v_mfma_f32_16x16x32_bf16 v[28:31], v[144:147], v[144:147], v[28:31]
    ds_read_b128 v[64:67], v88 offset:20480
    s_waitcnt lgkmcnt(4)
    v_mfma_f32_16x16x32_bf16 v[8:11], v[40:43], v[144:147], v[8:11]
    ds_read_b128 v[68:71], v88 offset:21504
    s_waitcnt lgkmcnt(4)
    v_mfma_f32_16x16x32_bf16 v[12:15], v[44:47], v[144:147], v[12:15]
    ds_read_b128 v[72:75], v88 offset:22528
    s_waitcnt lgkmcnt(4)
    v_mfma_f32_16x16x32_bf16 v[16:19], v[144:147], v[48:51], v[16:19]
    ds_read_b128 v[76:79], v88 offset:23552
    s_waitcnt lgkmcnt(4)
    v_mfma_f32_16x16x32_bf16 v[20:23], v[144:147], v[52:55], v[20:23]
    s_waitcnt vmcnt(6)
    v_mfma_f32_16x16x32_bf16 v[24:27], v[36:39], v[148:151], v[24:27]
    global_load_dwordx4 v[176:179], v2, s[74:75] offset:0 sc1
    v_mfma_f32_16x16x32_bf16 v[28:31], v[148:151], v[148:151], v[28:31]
    ds_read_b128 v[40:43], v88 offset:24576
    s_waitcnt lgkmcnt(4)
    v_mfma_f32_16x16x32_bf16 v[8:11], v[64:67], v[148:151], v[8:11]
    ds_read_b128 v[44:47], v88 offset:25600
    s_waitcnt lgkmcnt(4)
    v_mfma_f32_16x16x32_bf16 v[12:15], v[68:71], v[148:151], v[12:15]
    ds_read_b128 v[48:51], v88 offset:26624
    s_waitcnt lgkmcnt(4)
    v_mfma_f32_16x16x32_bf16 v[16:19], v[148:151], v[72:75], v[16:19]
    ds_read_b128 v[52:55], v88 offset:27648
    s_waitcnt lgkmcnt(4)
    v_mfma_f32_16x16x32_bf16 v[20:23], v[148:151], v[76:79], v[20:23]
    s_waitcnt vmcnt(6)
    v_mfma_f32_16x16x32_bf16 v[24:27], v[36:39], v[152:155], v[24:27]
    global_load_dwordx4 v[180:183], v2, s[74:75] offset:1024 sc1
    v_mfma_f32_16x16x32_bf16 v[28:31], v[152:155], v[152:155], v[28:31]
    ds_read_b128 v[64:67], v88 offset:28672
    s_waitcnt lgkmcnt(4)
    v_mfma_f32_16x16x32_bf16 v[8:11], v[40:43], v[152:155], v[8:11]
    ds_read_b128 v[68:71], v88 offset:29696
    s_waitcnt lgkmcnt(4)
    v_mfma_f32_16x16x32_bf16 v[12:15], v[44:47], v[152:155], v[12:15]
    ds_read_b128 v[72:75], v88 offset:30720
    s_waitcnt lgkmcnt(4)
    v_mfma_f32_16x16x32_bf16 v[16:19], v[152:155], v[48:51], v[16:19]
    ds_read_b128 v[76:79], v88 offset:31744
    s_waitcnt lgkmcnt(4)
    v_mfma_f32_16x16x32_bf16 v[20:23], v[152:155], v[52:55], v[20:23]
    s_waitcnt vmcnt(6)
    v_mfma_f32_16x16x32_bf16 v[24:27], v[36:39], v[156:159], v[24:27]
    ds_read_b128 v[40:43], v88 offset:32768
    v_mfma_f32_16x16x32_bf16 v[28:31], v[156:159], v[156:159], v[28:31]
    ds_read_b128 v[44:47], v88 offset:33792
    s_waitcnt lgkmcnt(5)
    v_mfma_f32_16x16x32_bf16 v[8:11], v[64:67], v[156:159], v[8:11]
    s_waitcnt lgkmcnt(4)
    v_mfma_f32_16x16x32_bf16 v[12:15], v[68:71], v[156:159], v[12:15]
    ds_read_b128 v[48:51], v88 offset:34816
    s_waitcnt lgkmcnt(4)
    v_mfma_f32_16x16x32_bf16 v[16:19], v[156:159], v[72:75], v[16:19]
    ds_read_b128 v[52:55], v88 offset:35840
    s_waitcnt lgkmcnt(4)
    v_mfma_f32_16x16x32_bf16 v[20:23], v[156:159], v[76:79], v[20:23]
    s_waitcnt vmcnt(5)
    v_mfma_f32_16x16x32_bf16 v[24:27], v[36:39], v[160:163], v[24:27]
    ds_read_b128 v[64:67], v88 offset:36864
    v_mfma_f32_16x16x32_bf16 v[28:31], v[160:163], v[160:163], v[28:31]
    ds_read_b128 v[68:71], v88 offset:37888
    s_waitcnt lgkmcnt(5)
    v_mfma_f32_16x16x32_bf16 v[8:11], v[40:43], v[160:163], v[8:11]
    s_waitcnt lgkmcnt(4)
    v_mfma_f32_16x16x32_bf16 v[12:15], v[44:47], v[160:163], v[12:15]
    ds_read_b128 v[72:75], v88 offset:38912
    s_waitcnt lgkmcnt(4)
    v_mfma_f32_16x16x32_bf16 v[16:19], v[160:163], v[48:51], v[16:19]
    ds_read_b128 v[76:79], v88 offset:39936
    s_waitcnt lgkmcnt(4)
    v_mfma_f32_16x16x32_bf16 v[20:23], v[160:163], v[52:55], v[20:23]
    s_waitcnt vmcnt(4)
    v_mfma_f32_16x16x32_bf16 v[24:27], v[36:39], v[164:167], v[24:27]
    ds_read_b128 v[40:43], v88 offset:40960
    v_mfma_f32_16x16x32_bf16 v[28:31], v[164:167], v[164:167], v[28:31]
    ds_read_b128 v[44:47], v88 offset:41984
    s_waitcnt lgkmcnt(5)
    v_mfma_f32_16x16x32_bf16 v[8:11], v[64:67], v[164:167], v[8:11]
    s_waitcnt lgkmcnt(4)
    v_mfma_f32_16x16x32_bf16 v[12:15], v[68:71], v[164:167], v[12:15]
    ds_read_b128 v[48:51], v88 offset:43008
    s_waitcnt lgkmcnt(4)
    v_mfma_f32_16x16x32_bf16 v[16:19], v[164:167], v[72:75], v[16:19]
    ds_read_b128 v[52:55], v88 offset:44032
    s_waitcnt lgkmcnt(4)
    v_mfma_f32_16x16x32_bf16 v[20:23], v[164:167], v[76:79], v[20:23]
    s_waitcnt vmcnt(3)
    v_mfma_f32_16x16x32_bf16 v[24:27], v[36:39], v[168:171], v[24:27]
    ds_read_b128 v[64:67], v88 offset:45056
    v_mfma_f32_16x16x32_bf16 v[28:31], v[168:171], v[168:171], v[28:31]
    ds_read_b128 v[68:71], v88 offset:46080
    s_waitcnt lgkmcnt(5)
    v_mfma_f32_16x16x32_bf16 v[8:11], v[40:43], v[168:171], v[8:11]
    s_waitcnt lgkmcnt(4)
    v_mfma_f32_16x16x32_bf16 v[12:15], v[44:47], v[168:171], v[12:15]
    ds_read_b128 v[72:75], v88 offset:47104
    s_waitcnt lgkmcnt(4)
    v_mfma_f32_16x16x32_bf16 v[16:19], v[168:171], v[48:51], v[16:19]
    ds_read_b128 v[76:79], v88 offset:48128
    s_waitcnt lgkmcnt(4)
    v_mfma_f32_16x16x32_bf16 v[20:23], v[168:171], v[52:55], v[20:23]
    s_waitcnt vmcnt(2)
    v_mfma_f32_16x16x32_bf16 v[24:27], v[36:39], v[172:175], v[24:27]
    ds_read_b128 v[40:43], v88 offset:49152
    v_mfma_f32_16x16x32_bf16 v[28:31], v[172:175], v[172:175], v[28:31]
    ds_read_b128 v[44:47], v88 offset:50176
    s_waitcnt lgkmcnt(5)
    v_mfma_f32_16x16x32_bf16 v[8:11], v[64:67], v[172:175], v[8:11]
    s_waitcnt lgkmcnt(4)
    v_mfma_f32_16x16x32_bf16 v[12:15], v[68:71], v[172:175], v[12:15]
    ds_read_b128 v[48:51], v88 offset:51200
    s_waitcnt lgkmcnt(4)
    v_mfma_f32_16x16x32_bf16 v[16:19], v[172:175], v[72:75], v[16:19]
    ds_read_b128 v[52:55], v88 offset:52224
    s_waitcnt lgkmcnt(4)
    v_mfma_f32_16x16x32_bf16 v[20:23], v[172:175], v[76:79], v[20:23]
    s_waitcnt vmcnt(1)
    v_mfma_f32_16x16x32_bf16 v[24:27], v[36:39], v[176:179], v[24:27]
    ds_read_b128 v[64:67], v88 offset:53248
    v_mfma_f32_16x16x32_bf16 v[28:31], v[176:179], v[176:179], v[28:31]
    ds_read_b128 v[68:71], v88 offset:54272
    s_waitcnt lgkmcnt(5)
    v_mfma_f32_16x16x32_bf16 v[8:11], v[40:43], v[176:179], v[8:11]
    s_waitcnt lgkmcnt(4)
    v_mfma_f32_16x16x32_bf16 v[12:15], v[44:47], v[176:179], v[12:15]
    ds_read_b128 v[72:75], v88 offset:55296
    s_waitcnt lgkmcnt(4)
    v_mfma_f32_16x16x32_bf16 v[16:19], v[176:179], v[48:51], v[16:19]
    ds_read_b128 v[76:79], v88 offset:56320
    s_waitcnt lgkmcnt(4)
    v_mfma_f32_16x16x32_bf16 v[20:23], v[176:179], v[52:55], v[20:23]
    s_waitcnt vmcnt(0)
    v_mfma_f32_16x16x32_bf16 v[24:27], v[36:39], v[180:183], v[24:27]
    v_mfma_f32_16x16x32_bf16 v[28:31], v[180:183], v[180:183], v[28:31]
    s_waitcnt lgkmcnt(3)
    v_mfma_f32_16x16x32_bf16 v[8:11], v[64:67], v[180:183], v[8:11]
    s_waitcnt lgkmcnt(2)
    v_mfma_f32_16x16x32_bf16 v[12:15], v[68:71], v[180:183], v[12:15]
    s_waitcnt lgkmcnt(1)
    v_mfma_f32_16x16x32_bf16 v[16:19], v[180:183], v[72:75], v[16:19]
    s_waitcnt lgkmcnt(0)
    v_mfma_f32_16x16x32_bf16 v[20:23], v[180:183], v[76:79], v[20:23]
    v_and_b32 v6, 3, v1
    v_cmp_eq_u32 vcc, 1, v6
    s_nop 1
    v_cndmask_b32 v116, v28, v29, vcc
    v_cmp_eq_u32 vcc, 2, v6
    s_nop 1
    v_cndmask_b32 v116, v116, v30, vcc
    v_cmp_eq_u32 vcc, 3, v6
    s_nop 1
    v_cndmask_b32 v116, v116, v31, vcc
    v_lshrrev_b32 v6, 2, v3
    v_cmp_eq_u32 vcc, v6, v4
    s_nop 1
    v_cndmask_b32 v116, 0, v116, vcc
    v_mov_b32 v117, v116
    s_nop 1
    v_permlane16_swap_b32 v116, v117
    v_add_f32 v116, v116, v117
    v_mov_b32 v117, v116
    s_nop 1
    v_permlane32_swap_b32 v116, v117
    v_add_f32 v116, v116, v117
    v_mul_f32 v118, 0x3b124925, v24
    v_mul_f32 v117, 0x3b124925, v116
    v_fma_f32 v117, -v118, v118, v117
    v_max_f32 v117, 0, v117
    v_add_f32 v117, 0x3727c5ac, v117
    v_rsq_f32 v119, v117
    s_lshl_b32 s65, s8, 7
    s_add_u32 s65, s65, 101376
    v_lshl_add_u32 v5, v3, 2, s65
    ds_write_b32 v5, v118
    ds_write_b32 v5, v119 offset:64
    v_lshl_add_u32 v5, v4, 4, s65
    s_waitcnt lgkmcnt(0)
    ds_read_b128 v[40:43], v5
    ds_read_b128 v[44:47], v5 offset:64
    v_fma_f32 v8, -v118, v100, v8
    v_fma_f32 v9, -v118, v101, v9
    v_fma_f32 v10, -v118, v102, v10
    v_fma_f32 v11, -v118, v103, v11
    v_mul_f32 v8, v8, v119
    v_mul_f32 v9, v9, v119
    v_mul_f32 v10, v10, v119
    v_mul_f32 v11, v11, v119
    v_cvt_pk_bf16_f32 v8, v8, v9
    v_cvt_pk_bf16_f32 v9, v10, v11
    buffer_store_dwordx2 v[8:9], v96, s[4:7], s64 offen offset:0 sc1
    v_fma_f32 v12, -v118, v104, v12
    v_fma_f32 v13, -v118, v105, v13
    v_fma_f32 v14, -v118, v106, v14
    v_fma_f32 v15, -v118, v107, v15
    v_mul_f32 v12, v12, v119
    v_mul_f32 v13, v13, v119
    v_mul_f32 v14, v14, v119
    v_mul_f32 v15, v15, v119
    v_cvt_pk_bf16_f32 v12, v12, v13
    v_cvt_pk_bf16_f32 v13, v14, v15
    v_cmp_eq_u32 vcc, 2, v4
    v_mov_b32 v6, 0x3f80
    s_nop 0
    v_cndmask_b32 v12, v12, v36, vcc
    v_cndmask_b32 v13, v13, v6, vcc
    buffer_store_dwordx2 v[12:13], v97, s[4:7], s64 offen offset:1024 sc1
    s_waitcnt lgkmcnt(1)
    v_fma_f32 v16, -v40, v108, v16
    v_fma_f32 v17, -v41, v108, v17
    v_fma_f32 v18, -v42, v108, v18
    v_fma_f32 v19, -v43, v108, v19
    s_waitcnt lgkmcnt(0)
    v_mul_f32 v16, v16, v44
    v_mul_f32 v17, v17, v45
    v_mul_f32 v18, v18, v46
    v_mul_f32 v19, v19, v47
    v_cvt_pk_bf16_f32 v16, v16, v17
    v_cvt_pk_bf16_f32 v17, v18, v19
    buffer_store_dwordx2 v[16:17], v98, s[4:7], s64 offen offset:2048 sc1
    v_fma_f32 v20, -v40, v109, v20
    v_fma_f32 v21, -v41, v109, v21
    v_fma_f32 v22, -v42, v109, v22
    v_fma_f32 v23, -v43, v109, v23
    v_mul_f32 v20, v20, v44
    v_mul_f32 v21, v21, v45
    v_mul_f32 v22, v22, v46
    v_mul_f32 v23, v23, v47
    v_cvt_pk_bf16_f32 v20, v20, v21
    v_cvt_pk_bf16_f32 v21, v22, v23
    v_cmp_eq_u32 vcc, 8, v3
    s_nop 1
    v_cndmask_b32 v6, 0, v36, vcc
    v_lshrrev_b32 v7, 2, v3
    v_cmp_eq_u32 vcc, 2, v7
    s_nop 1
    v_cndmask_b32 v20, v20, v6, vcc
    v_cndmask_b32 v21, v21, v6, vcc
    buffer_store_dwordx2 v[20:21], v99, s[4:7], s64 offen offset:2304 sc1
xq_done:
    s_mov_b32 s37, s50
    s_mov_b32 s11, 1
    s_mov_b32 s44, 6524928
    s_mov_b32 s45, 13864960
    s_mov_b32 s46, 6524928
    s_mov_b32 s47, 4558848
    s_mov_b32 s48, 6393856
    s_mov_b32 s49, 6524928
    s_mov_b32 s50, 4276224
    s_mul_i32 s56, s9, 458752
    s_lshl_b32 s57, s10, 11
    s_add_u32 s56, s56, s57
    s_add_u32 s56, s56, s44
    s_add_u32 s57, s8, 0
    s_bfe_u32 s58, s57, 0x10001
    s_mul_i32 s58, s58, 229376
    s_and_b32 s57, s57, 1
    s_lshl_b32 s57, s57, 15
    s_add_u32 s57, s57, s58
    s_add_u32 s32, s57, s56
    s_add_u32 s57, s8, 1
    s_bfe_u32 s58, s57, 0x10001
    s_mul_i32 s58, s58, 229376
    s_and_b32 s57, s57, 1
    s_lshl_b32 s57, s57, 15
    s_add_u32 s57, s57, s58
    s_add_u32 s33, s57, s56
    s_add_u32 s57, s8, 2
    s_bfe_u32 s58, s57, 0x10001
    s_mul_i32 s58, s58, 229376
    s_and_b32 s57, s57, 1
    s_lshl_b32 s57, s57, 15
    s_add_u32 s57, s57, s58
    s_add_u32 s34, s57, s56
    s_add_u32 s57, s8, 3
    s_bfe_u32 s58, s57, 0x10001
    s_mul_i32 s58, s58, 229376
    s_and_b32 s57, s57, 1
    s_lshl_b32 s57, s57, 15
    s_add_u32 s57, s57, s58
    s_add_u32 s35, s57, s56
    s_lshl_b32 s36, s8, 16
    s_add_u32 s36, s36, s45
    s_add_u32 s36, s36, 4096
    s_mov_b32 s50, s37
    v_lshlrev_b32 v250, 7, v1
    v_mov_b32 v251, 1
    s_add_u32 s43, s50, 18432
    s_and_b32 s59, s10, 7
    s_lshl_b32 s59, s59, 2
    s_add_u32 s59, s59, s8
    s_lshl_b32 s56, s9, 7
    s_add_u32 s56, s56, 16384
    s_add_u32 s56, s56, s50
    s_lshl_b32 s57, s10, 2
    s_add_u32 s57, s56, s57
    v_lshlrev_b32 v252, 2, v1
    v_mov_b32 v253, 1
    s_lshl_b32 s58, s8, 4
    s_add_u32 s58, s58, s10
    s_waitcnt vmcnt(0)
    s_barrier
    s_cmp_ge_u32 s58, 16
    s_cbranch_scc1 sy4_n
    s_mov_b64 exec, 1
    s_cmp_eq_u32 s83, 1
    s_cbranch_scc0 sy4_s
    buffer_store_dword v253, v252, s[4:7], s57 offen
    s_branch sy4_x
sy4_s:
    buffer_wbl2 sc1
    s_waitcnt vmcnt(0)
    buffer_atomic_add v253, v252, s[4:7], s56 offen offset:64 sc1
sy4_x:
    s_mov_b64 exec, -1
sy4_n:
    s_cmp_lg_u32 s59, 29
    s_cbranch_scc1 hg_n
    s_mov_b64 exec, 0xffff
    buffer_atomic_add v251, v250, s[4:7], s43 offen sc1
    s_mov_b64 exec, -1
hg_n:
    s_mov_b32 s60, 0xffff0000
    s_mov_b32 s61, 0x07060302
    s_mov_b32 s62, 0
    s_mov_b32 s63, -1
    s_lshl_b32 s56, s19, 16
    s_add_u32 s56, s56, 0
    s_mul_i32 s59, s8, 15360
    s_add_u32 s57, s56, s59
    s_add_u32 s72, s92, s57
    s_addc_u32 s73, s93, 0
    s_add_u32 m0, s59, 102400
    s_add_u32 s56, s56, 61440
    s_add_u32 s74, s92, s56
    s_addc_u32 s75, s93, 0
    s_mul_i32 s56, s10, 100352
    s_add_u32 s56, s56, 458752
    s_mov_b32 s42, s56
    s_mul_i32 s39, s8, 5120
    s_add_u32 s39, s39, 28672
    s_add_u32 s57, s39, s56
    s_add_u32 s80, s92, s57
    s_addc_u32 s81, s93, 0
    v_min_u32 v244, 39, v1
    v_lshlrev_b32 v244, 7, v244
    v_bfe_u32 v7, v1, 4, 1
    v_lshlrev_b32 v7, 10, v7
    v_lshl_add_u32 v7, v3, 4, v7
    v_lshrrev_b32 v5, 5, v1
    v_lshl_add_u32 v7, v5, 8, v7
    s_sub_u32 s56, s32, s44
    s_add_u32 s56, s56, s46
    v_add_u32 v7, s56, v7
    s_add_u32 s56, s8, 0
    s_and_b32 s56, s56, 3
    s_mul_i32 s56, s56, 12288
    v_add_u32 v240, s56, v2
    s_add_u32 s56, s8, 1
    s_and_b32 s56, s56, 3
    s_mul_i32 s56, s56, 12288
    v_add_u32 v241, s56, v2
    s_add_u32 s56, s8, 2
    s_and_b32 s56, s56, 3
    s_mul_i32 s56, s56, 12288
    v_add_u32 v242, s56, v2
    s_add_u32 s56, s8, 3
    s_and_b32 s56, s56, 3
    s_mul_i32 s56, s56, 12288
    v_add_u32 v243, s56, v2
    s_cmp_lg_u32 s8, 0
    s_cbranch_scc1 sy4_h
    s_lshl_b32 s58, s9, 7
    s_add_u32 s58, s58, 16384
    s_add_u32 s58, s58, s50
    s_mov_b32 s57, 400000
    s_cmp_eq_u32 s83, 1
    s_cbranch_scc0 sy4_w
    s_mov_b64 exec, 65535
sy4_p:
    buffer_load_dword v253, v252, s[4:7], s58 offen sc1
    s_sub_u32 s57, s57, 1
    s_cmp_eq_u32 s57, 0
    s_cbranch_scc1 sy4_q
    s_waitcnt vmcnt(0)
    v_cmp_ne_u32 vcc, 1, v253
    s_nop 4
    s_cbranch_vccnz sy4_p
sy4_q:
    s_mov_b64 exec, -1
    s_branch sy4_e
sy4_w:
    s_mov_b64 exec, 1
sy4_sp:
    buffer_load_dword v253, v252, s[4:7], s58 offen offset:64 sc1
    s_sub_u32 s57, s57, 1
    s_cmp_eq_u32 s57, 0
    s_cbranch_scc1 sy4_sq
    s_waitcnt vmcnt(0)
    v_cmp_gt_u32 vcc, 16, v253
    s_nop 4
    s_cbranch_vccnz sy4_sp
sy4_sq:
    buffer_inv sc1
    s_waitcnt vmcnt(0)
    s_mov_b64 exec, -1
    s_branch sy4_e
sy4_h:
    s_cmp_lg_u32 s8, 1
    s_cbranch_scc1 sy4_e
    s_lshl_b32 s58, s9, 7
    s_add_u32 s58, s58, s43
    s_mov_b32 s57, 200000
    s_mov_b64 exec, 1
hg_p:
    buffer_load_dword v253, v252, s[4:7], s58 offen sc1
    s_sub_u32 s57, s57, 1
    s_cmp_eq_u32 s57, 0
    s_cbranch_scc1 hg_q
    s_waitcnt vmcnt(0)
    v_cmp_gt_u32 vcc, 32, v253
    s_nop 4
    s_cbranch_vccnz hg_p
hg_q:
    s_mov_b64 exec, -1
sy4_e:
    s_barrier
    s_mov_b32 s50, 4276224
    buffer_load_dwordx4 v[152:155], v2, s[4:7], s45 offen sc1
    buffer_load_dwordx4 v[156:159], v2, s[4:7], s45 offen offset:1024 sc1
    buffer_load_dwordx4 v[16:19], v2, s[4:7], s33 offen sc1
    buffer_load_dwordx4 v[20:23], v2, s[4:7], s33 offen offset:1024 sc1
    buffer_load_dwordx4 v[24:27], v2, s[4:7], s34 offen sc1
    buffer_load_dwordx4 v[28:31], v2, s[4:7], s34 offen offset:1024 sc1
    buffer_load_dwordx4 v[32:35], v2, s[4:7], s35 offen sc1
    buffer_load_dwordx4 v[36:39], v2, s[4:7], s35 offen offset:1024 sc1
    buffer_load_dwordx4 v[8:11], v2, s[4:7], s32 offen sc1
    buffer_load_dwordx4 v[12:15], v2, s[4:7], s32 offen offset:1024 sc1
    s_add_u32 s70, s92, s36
    s_addc_u32 s71, s93, 0
    s_mov_b64 exec, s[62:63]
    s_waitcnt vmcnt(6)
    v_mov_b32 v22, 0
    v_mov_b32 v23, 0
    s_mov_b64 exec, -1
    v_mfma_f32_32x32x16_bf16 v[56:71], v[152:155], v[16:19], 0
    global_load_dwordx4 v[160:163], v2, s[70:71] offset:-4096 sc1
    v_mfma_f32_32x32x16_bf16 v[56:71], v[156:159], v[20:23], v[56:71]
    global_load_dwordx4 v[164:167], v2, s[70:71] offset:-3072 sc1
    s_mov_b64 exec, s[62:63]
    s_waitcnt vmcnt(6)
    v_mov_b32 v30, 0
    v_mov_b32 v31, 0
    s_mov_b64 exec, -1
    v_mfma_f32_32x32x16_bf16 v[72:87], v[152:155], v[24:27], 0
    global_load_dwordx4 v[168:171], v2, s[70:71] offset:-2048 sc1
    v_mfma_f32_32x32x16_bf16 v[72:87], v[156:159], v[28:31], v[72:87]
    global_load_dwordx4 v[172:175], v2, s[70:71] offset:-1024 sc1
    s_mov_b64 exec, s[62:63]
    s_waitcnt vmcnt(6)
    v_mov_b32 v38, 0
    v_mov_b32 v39, 0
    s_mov_b64 exec, -1
    v_mfma_f32_32x32x16_bf16 v[88:103], v[152:155], v[32:35], 0
    global_load_dwordx4 v[176:179], v2, s[70:71] offset:0 sc1
    v_mfma_f32_32x32x16_bf16 v[88:103], v[156:159], v[36:39], v[88:103]
    global_load_dwordx4 v[180:183], v2, s[70:71] offset:1024 sc1
    v_max3_f32 v228, v56, v57, v58
    v_max3_f32 v229, v59, v60, v61
    v_max3_f32 v228, v228, v62, v63
    v_max3_f32 v229, v229, v64, v65
    s_mov_b64 exec, s[62:63]
    s_waitcnt vmcnt(6)
    v_mov_b32 v14, 0
    v_mov_b32 v15, 0
    s_mov_b64 exec, -1
    v_mfma_f32_32x32x16_bf16 v[40:55], v[152:155], v[8:11], 0
    global_load_dwordx4 v[184:187], v2, s[70:71] offset:2048 sc1
    v_max3_f32 v228, v228, v66, v67
    v_max3_f32 v229, v229, v68, v69
    v_max3_f32 v228, v228, v70, v71
    v_min_f32 v228, -v228, -v229
    v_mfma_f32_32x32x16_bf16 v[40:55], v[156:159], v[12:15], v[40:55]
    global_load_dwordx4 v[188:191], v2, s[70:71] offset:3072 sc1
    s_add_u32 s70, s70, 8192
    s_addc_u32 s71, s71, 0
    v_max3_f32 v232, v72, v73, v74
    v_max3_f32 v233, v75, v76, v77
    v_max3_f32 v232, v232, v78, v79
    v_max3_f32 v233, v233, v80, v81
    v_max3_f32 v232, v232, v82, v83
    v_max3_f32 v233, v233, v84, v85
    v_max3_f32 v232, v232, v86, v87
    v_min_f32 v232, -v232, -v233
    v_max3_f32 v236, v88, v89, v90
    v_max3_f32 v237, v91, v92, v93
    v_max3_f32 v236, v236, v94, v95
    v_max3_f32 v237, v237, v96, v97
    v_max3_f32 v236, v236, v98, v99
    v_max3_f32 v237, v237, v100, v101
    v_max3_f32 v236, v236, v102, v103
    v_min_f32 v236, -v236, -v237
    v_max3_f32 v224, v40, v41, v42
    v_max3_f32 v225, v43, v44, v45
    v_max3_f32 v224, v224, v46, v47
    v_max3_f32 v225, v225, v48, v49
    v_max3_f32 v224, v224, v50, v51
    v_max3_f32 v225, v225, v52, v53
    v_max3_f32 v224, v224, v54, v55
    v_min_f32 v224, -v224, -v225
    s_mov_b64 exec, s[62:63]
    v_lshrrev_b32 v22, 16, v228
    v_lshrrev_b32 v30, 16, v232
    v_lshrrev_b32 v38, 16, v236
    v_lshrrev_b32 v14, 16, v224
    s_mov_b64 exec, -1
    s_waitcnt vmcnt(7)
    v_mfma_f32_32x32x16_bf16 v[104:119], v[160:163], v[16:19], 0
    s_waitcnt vmcnt(6)
    v_mfma_f32_32x32x16_bf16 v[104:119], v[164:167], v[20:23], v[104:119]
    v_mfma_f32_32x32x16_bf16 v[120:135], v[160:163], v[24:27], 0
    s_waitcnt vmcnt(4)
    s_nop 9
    v_exp_f32 v104, v104
    v_exp_f32 v105, v105
    v_exp_f32 v106, v106
    v_exp_f32 v107, v107
    v_mfma_f32_32x32x16_bf16 v[120:135], v[164:167], v[28:31], v[120:135]
    global_load_dwordx4 v[192:195], v2, s[70:71] offset:-4096 sc1
    v_exp_f32 v108, v108
    v_exp_f32 v109, v109
    v_exp_f32 v110, v110
    v_exp_f32 v111, v111
    v_cvt_pk_bf16_f32 v136, v104, v105
    v_cvt_pk_bf16_f32 v137, v106, v107
    v_exp_f32 v112, v112
    v_exp_f32 v113, v113
    v_exp_f32 v114, v114
    v_exp_f32 v115, v115
    v_cvt_pk_bf16_f32 v138, v108, v109
    v_cvt_pk_bf16_f32 v139, v110, v111
    global_load_dwordx4 v[196:199], v2, s[70:71] offset:-3072 sc1
    v_exp_f32 v116, v116
    v_exp_f32 v117, v117
    v_exp_f32 v118, v118
    v_exp_f32 v119, v119
    v_cvt_pk_bf16_f32 v140, v112, v113
    v_cvt_pk_bf16_f32 v141, v114, v115
    v_cvt_pk_bf16_f32 v142, v116, v117
    v_cvt_pk_bf16_f32 v143, v118, v119
    v_mfma_f32_32x32x16_bf16 v[104:119], v[160:163], v[32:35], 0
    v_exp_f32 v120, v120
    v_exp_f32 v121, v121
    v_exp_f32 v122, v122
    v_exp_f32 v123, v123
    v_mfma_f32_32x32x16_bf16 v[104:119], v[164:167], v[36:39], v[104:119]
    global_load_dwordx4 v[200:203], v2, s[70:71] offset:-2048 sc1
    v_exp_f32 v124, v124
    v_exp_f32 v125, v125
    v_exp_f32 v126, v126
    v_exp_f32 v127, v127
    v_cvt_pk_bf16_f32 v144, v120, v121
    v_cvt_pk_bf16_f32 v145, v122, v123
    v_mfma_f32_32x32x16_bf16 v[56:71], v[168:171], v[136:139], 0
    v_exp_f32 v128, v128
    v_exp_f32 v129, v129
    v_exp_f32 v130, v130
    v_exp_f32 v131, v131
    v_cvt_pk_bf16_f32 v146, v124, v125
    v_cvt_pk_bf16_f32 v147, v126, v127
    v_mfma_f32_32x32x16_bf16 v[56:71], v[172:175], v[140:143], v[56:71]
    global_load_dwordx4 v[204:207], v2, s[70:71] offset:-1024 sc1
    v_exp_f32 v132, v132
    v_exp_f32 v133, v133
    v_exp_f32 v134, v134
    v_exp_f32 v135, v135
    v_cvt_pk_bf16_f32 v148, v128, v129
    v_cvt_pk_bf16_f32 v149, v130, v131
    v_cvt_pk_bf16_f32 v150, v132, v133
    v_cvt_pk_bf16_f32 v151, v134, v135
    v_mfma_f32_32x32x16_bf16 v[120:135], v[160:163], v[8:11], 0
    s_waitcnt vmcnt(6)
    v_exp_f32 v104, v104
    v_exp_f32 v105, v105
    v_exp_f32 v106, v106
    v_exp_f32 v107, v107
    v_mfma_f32_32x32x16_bf16 v[120:135], v[164:167], v[12:15], v[120:135]
    global_load_dwordx4 v[208:211], v2, s[70:71] offset:0 sc1
    v_exp_f32 v108, v108
    v_exp_f32 v109, v109
    v_exp_f32 v110, v110
    v_exp_f32 v111, v111
    v_cvt_pk_bf16_f32 v136, v104, v105
    v_cvt_pk_bf16_f32 v137, v106, v107
    v_mfma_f32_32x32x16_bf16 v[72:87], v[168:171], v[144:147], 0
    v_exp_f32 v112, v112
    v_exp_f32 v113, v113
    v_exp_f32 v114, v114
    v_exp_f32 v115, v115
    v_cvt_pk_bf16_f32 v138, v108, v109
    v_cvt_pk_bf16_f32 v139, v110, v111
    v_mfma_f32_32x32x16_bf16 v[72:87], v[172:175], v[148:151], v[72:87]
    global_load_dwordx4 v[212:215], v2, s[70:71] offset:1024 sc1
    v_exp_f32 v116, v116
    v_exp_f32 v117, v117
    v_exp_f32 v118, v118
    v_exp_f32 v119, v119
    v_cvt_pk_bf16_f32 v140, v112, v113
    v_cvt_pk_bf16_f32 v141, v114, v115
    v_cvt_pk_bf16_f32 v142, v116, v117
    v_cvt_pk_bf16_f32 v143, v118, v119
    v_mfma_f32_32x32x16_bf16 v[104:119], v[176:179], v[16:19], 0
    v_exp_f32 v120, v120
    v_exp_f32 v121, v121
    v_exp_f32 v122, v122
    v_exp_f32 v123, v123
    v_mfma_f32_32x32x16_bf16 v[104:119], v[180:183], v[20:23], v[104:119]
    global_load_dwordx4 v[216:219], v2, s[70:71] offset:2048 sc1
    v_exp_f32 v124, v124
    v_exp_f32 v125, v125
    v_exp_f32 v126, v126
    v_exp_f32 v127, v127
    v_cvt_pk_bf16_f32 v144, v120, v121
    v_cvt_pk_bf16_f32 v145, v122, v123
    v_mfma_f32_32x32x16_bf16 v[88:103], v[168:171], v[136:139], 0
    v_exp_f32 v128, v128
    v_exp_f32 v129, v129
    v_exp_f32 v130, v130
    v_exp_f32 v131, v131
    v_cvt_pk_bf16_f32 v146, v124, v125
    v_cvt_pk_bf16_f32 v147, v126, v127
    v_mfma_f32_32x32x16_bf16 v[88:103], v[172:175], v[140:143], v[88:103]
    global_load_dwordx4 v[220:223], v2, s[70:71] offset:3072 sc1
    v_exp_f32 v132, v132
    v_exp_f32 v133, v133
    v_exp_f32 v134, v134
    v_exp_f32 v135, v135
    v_cvt_pk_bf16_f32 v148, v128, v129
    v_cvt_pk_bf16_f32 v149, v130, v131
    v_cvt_pk_bf16_f32 v150, v132, v133
    v_cvt_pk_bf16_f32 v151, v134, v135
    v_mfma_f32_32x32x16_bf16 v[120:135], v[176:179], v[24:27], 0
    s_waitcnt vmcnt(8)
    s_add_u32 s70, s70, 8192
    s_addc_u32 s71, s71, 0
    v_exp_f32 v104, v104
    v_exp_f32 v105, v105
    v_exp_f32 v106, v106
    v_exp_f32 v107, v107
    v_mfma_f32_32x32x16_bf16 v[120:135], v[180:183], v[28:31], v[120:135]
    v_exp_f32 v108, v108
    v_exp_f32 v109, v109
    v_exp_f32 v110, v110
    v_exp_f32 v111, v111
    v_cvt_pk_bf16_f32 v136, v104, v105
    v_cvt_pk_bf16_f32 v137, v106, v107
    v_mfma_f32_32x32x16_bf16 v[40:55], v[168:171], v[144:147], 0
    v_exp_f32 v112, v112
    v_exp_f32 v113, v113
    v_exp_f32 v114, v114
    v_exp_f32 v115, v115
    v_cvt_pk_bf16_f32 v138, v108, v109
    v_cvt_pk_bf16_f32 v139, v110, v111
    v_mfma_f32_32x32x16_bf16 v[40:55], v[172:175], v[148:151], v[40:55]
    global_load_dwordx4 v[160:163], v2, s[70:71] offset:-4096 sc1
    v_exp_f32 v116, v116
    v_exp_f32 v117, v117
    v_exp_f32 v118, v118
    v_exp_f32 v119, v119
    v_cvt_pk_bf16_f32 v140, v112, v113
    v_cvt_pk_bf16_f32 v141, v114, v115
    v_cvt_pk_bf16_f32 v142, v116, v117
    v_cvt_pk_bf16_f32 v143, v118, v119
    s_mov_b32 s57, 3
a2_loop:
    v_mfma_f32_32x32x16_bf16 v[104:119], v[176:179], v[32:35], 0
    v_exp_f32 v120, v120
    v_exp_f32 v121, v121
    v_exp_f32 v122, v122
    v_exp_f32 v123, v123
    v_mfma_f32_32x32x16_bf16 v[104:119], v[180:183], v[36:39], v[104:119]
    v_exp_f32 v124, v124
    v_exp_f32 v125, v125
    v_exp_f32 v126, v126
    v_exp_f32 v127, v127
    v_cvt_pk_bf16_f32 v144, v120, v121
    v_cvt_pk_bf16_f32 v145, v122, v123
    v_mfma_f32_32x32x16_bf16 v[56:71], v[184:187], v[136:139], v[56:71]
    v_exp_f32 v128, v128
    v_exp_f32 v129, v129
    v_exp_f32 v130, v130
    v_exp_f32 v131, v131
    v_cvt_pk_bf16_f32 v146, v124, v125
    v_cvt_pk_bf16_f32 v147, v126, v127
    v_mfma_f32_32x32x16_bf16 v[56:71], v[188:191], v[140:143], v[56:71]
    global_load_dwordx4 v[164:167], v2, s[70:71] offset:-3072 sc1
    v_exp_f32 v132, v132
    v_exp_f32 v133, v133
    v_exp_f32 v134, v134
    v_exp_f32 v135, v135
    v_cvt_pk_bf16_f32 v148, v128, v129
    v_cvt_pk_bf16_f32 v149, v130, v131
    v_cvt_pk_bf16_f32 v150, v132, v133
    v_cvt_pk_bf16_f32 v151, v134, v135
    v_mfma_f32_32x32x16_bf16 v[120:135], v[176:179], v[8:11], 0
    s_waitcnt vmcnt(8)
    v_exp_f32 v104, v104
    v_exp_f32 v105, v105
    v_exp_f32 v106, v106
    v_exp_f32 v107, v107
    v_mfma_f32_32x32x16_bf16 v[120:135], v[180:183], v[12:15], v[120:135]
    v_exp_f32 v108, v108
    v_exp_f32 v109, v109
    v_exp_f32 v110, v110
    v_exp_f32 v111, v111
    v_cvt_pk_bf16_f32 v136, v104, v105
    v_cvt_pk_bf16_f32 v137, v106, v107
    v_mfma_f32_32x32x16_bf16 v[72:87], v[184:187], v[144:147], v[72:87]
    global_load_lds_dwordx4 v2, s[72:73] offset:0
    v_exp_f32 v112, v112
    v_exp_f32 v113, v113
    v_exp_f32 v114, v114
    v_exp_f32 v115, v115
    v_cvt_pk_bf16_f32 v138, v108, v109
    v_cvt_pk_bf16_f32 v139, v110, v111
    v_mfma_f32_32x32x16_bf16 v[72:87], v[188:191], v[148:151], v[72:87]
    global_load_dwordx4 v[168:171], v2, s[70:71] offset:-2048 sc1
    v_exp_f32 v116, v116
    v_exp_f32 v117, v117
    v_exp_f32 v118, v118
    v_exp_f32 v119, v119
    v_cvt_pk_bf16_f32 v140, v112, v113
    v_cvt_pk_bf16_f32 v141, v114, v115
    v_cvt_pk_bf16_f32 v142, v116, v117
    v_cvt_pk_bf16_f32 v143, v118, v119
    v_mfma_f32_32x32x16_bf16 v[104:119], v[192:195], v[16:19], 0
    v_exp_f32 v120, v120
    v_exp_f32 v121, v121
    v_exp_f32 v122, v122
    v_exp_f32 v123, v123
    v_mfma_f32_32x32x16_bf16 v[104:119], v[196:199], v[20:23], v[104:119]
    v_exp_f32 v124, v124
    v_exp_f32 v125, v125
    v_exp_f32 v126, v126
    v_exp_f32 v127, v127
    v_cvt_pk_bf16_f32 v144, v120, v121
    v_cvt_pk_bf16_f32 v145, v122, v123
    v_mfma_f32_32x32x16_bf16 v[88:103], v[184:187], v[136:139], v[88:103]
    v_exp_f32 v128, v128
    v_exp_f32 v129, v129
    v_exp_f32 v130, v130
    v_exp_f32 v131, v131
    v_cvt_pk_bf16_f32 v146, v124, v125
    v_cvt_pk_bf16_f32 v147, v126, v127
    v_mfma_f32_32x32x16_bf16 v[88:103], v[188:191], v[140:143], v[88:103]
    global_load_dwordx4 v[172:175], v2, s[70:71] offset:-1024 sc1
    v_exp_f32 v132, v132
    v_exp_f32 v133, v133
    v_exp_f32 v134, v134
    v_exp_f32 v135, v135
    v_cvt_pk_bf16_f32 v148, v128, v129
    v_cvt_pk_bf16_f32 v149, v130, v131
    v_cvt_pk_bf16_f32 v150, v132, v133
    v_cvt_pk_bf16_f32 v151, v134, v135
    v_mfma_f32_32x32x16_bf16 v[120:135], v[192:195], v[24:27], 0
    s_waitcnt vmcnt(9)
    v_exp_f32 v104, v104
    v_exp_f32 v105, v105
    v_exp_f32 v106, v106
    v_exp_f32 v107, v107
    v_mfma_f32_32x32x16_bf16 v[120:135], v[196:199], v[28:31], v[120:135]
    v_exp_f32 v108, v108
    v_exp_f32 v109, v109
    v_exp_f32 v110, v110
    v_exp_f32 v111, v111
    v_cvt_pk_bf16_f32 v136, v104, v105
    v_cvt_pk_bf16_f32 v137, v106, v107
    v_mfma_f32_32x32x16_bf16 v[40:55], v[184:187], v[144:147], v[40:55]
    global_load_lds_dwordx4 v2, s[72:73] offset:1024
    v_exp_f32 v112, v112
    v_exp_f32 v113, v113
    v_exp_f32 v114, v114
    v_exp_f32 v115, v115
    v_cvt_pk_bf16_f32 v138, v108, v109
    v_cvt_pk_bf16_f32 v139, v110, v111
    v_mfma_f32_32x32x16_bf16 v[40:55], v[188:191], v[148:151], v[40:55]
    global_load_dwordx4 v[176:179], v2, s[70:71] offset:0 sc1
    v_exp_f32 v116, v116
    v_exp_f32 v117, v117
    v_exp_f32 v118, v118
    v_exp_f32 v119, v119
    v_cvt_pk_bf16_f32 v140, v112, v113
    v_cvt_pk_bf16_f32 v141, v114, v115
    v_cvt_pk_bf16_f32 v142, v116, v117
    v_cvt_pk_bf16_f32 v143, v118, v119
    v_mfma_f32_32x32x16_bf16 v[104:119], v[192:195], v[32:35], 0
    v_exp_f32 v120, v120
    v_exp_f32 v121, v121
    v_exp_f32 v122, v122
    v_exp_f32 v123, v123
    v_mfma_f32_32x32x16_bf16 v[104:119], v[196:199], v[36:39], v[104:119]
    v_exp_f32 v124, v124
    v_exp_f32 v125, v125
    v_exp_f32 v126, v126
    v_exp_f32 v127, v127
    v_cvt_pk_bf16_f32 v144, v120, v121
    v_cvt_pk_bf16_f32 v145, v122, v123
    v_mfma_f32_32x32x16_bf16 v[56:71], v[200:203], v[136:139], v[56:71]
    v_exp_f32 v128, v128
    v_exp_f32 v129, v129
    v_exp_f32 v130, v130
    v_exp_f32 v131, v131
    v_cvt_pk_bf16_f32 v146, v124, v125
    v_cvt_pk_bf16_f32 v147, v126, v127
    v_mfma_f32_32x32x16_bf16 v[56:71], v[204:207], v[140:143], v[56:71]
    global_load_dwordx4 v[180:183], v2, s[70:71] offset:1024 sc1
    v_exp_f32 v132, v132
    v_exp_f32 v133, v133
    v_exp_f32 v134, v134
    v_exp_f32 v135, v135
    v_cvt_pk_bf16_f32 v148, v128, v129
    v_cvt_pk_bf16_f32 v149, v130, v131
    v_cvt_pk_bf16_f32 v150, v132, v133
    v_cvt_pk_bf16_f32 v151, v134, v135
    v_mfma_f32_32x32x16_bf16 v[120:135], v[192:195], v[8:11], 0
    s_waitcnt vmcnt(10)
    v_exp_f32 v104, v104
    v_exp_f32 v105, v105
    v_exp_f32 v106, v106
    v_exp_f32 v107, v107
    v_mfma_f32_32x32x16_bf16 v[120:135], v[196:199], v[12:15], v[120:135]
    v_exp_f32 v108, v108
    v_exp_f32 v109, v109
    v_exp_f32 v110, v110
    v_exp_f32 v111, v111
    v_cvt_pk_bf16_f32 v136, v104, v105
    v_cvt_pk_bf16_f32 v137, v106, v107
    v_mfma_f32_32x32x16_bf16 v[72:87], v[200:203], v[144:147], v[72:87]
    global_load_lds_dwordx4 v2, s[72:73] offset:2048
    v_exp_f32 v112, v112
    v_exp_f32 v113, v113
    v_exp_f32 v114, v114
    v_exp_f32 v115, v115
    v_cvt_pk_bf16_f32 v138, v108, v109
    v_cvt_pk_bf16_f32 v139, v110, v111
    v_mfma_f32_32x32x16_bf16 v[72:87], v[204:207], v[148:151], v[72:87]
    global_load_dwordx4 v[184:187], v2, s[70:71] offset:2048 sc1
    v_exp_f32 v116, v116
    v_exp_f32 v117, v117
    v_exp_f32 v118, v118
    v_exp_f32 v119, v119
    v_cvt_pk_bf16_f32 v140, v112, v113
    v_cvt_pk_bf16_f32 v141, v114, v115
    v_cvt_pk_bf16_f32 v142, v116, v117
    v_cvt_pk_bf16_f32 v143, v118, v119
    v_mfma_f32_32x32x16_bf16 v[104:119], v[208:211], v[16:19], 0
    v_exp_f32 v120, v120
    v_exp_f32 v121, v121
    v_exp_f32 v122, v122
    v_exp_f32 v123, v123
    v_mfma_f32_32x32x16_bf16 v[104:119], v[212:215], v[20:23], v[104:119]
    v_exp_f32 v124, v124
    v_exp_f32 v125, v125
    v_exp_f32 v126, v126
    v_exp_f32 v127, v127
    v_cvt_pk_bf16_f32 v144, v120, v121
    v_cvt_pk_bf16_f32 v145, v122, v123
    v_mfma_f32_32x32x16_bf16 v[88:103], v[200:203], v[136:139], v[88:103]
    v_exp_f32 v128, v128
    v_exp_f32 v129, v129
    v_exp_f32 v130, v130
    v_exp_f32 v131, v131
    v_cvt_pk_bf16_f32 v146, v124, v125
    v_cvt_pk_bf16_f32 v147, v126, v127
    v_mfma_f32_32x32x16_bf16 v[88:103], v[204:207], v[140:143], v[88:103]
    global_load_dwordx4 v[188:191], v2, s[70:71] offset:3072 sc1
    v_exp_f32 v132, v132
    v_exp_f32 v133, v133
    v_exp_f32 v134, v134
    v_exp_f32 v135, v135
    v_cvt_pk_bf16_f32 v148, v128, v129
    v_cvt_pk_bf16_f32 v149, v130, v131
    v_cvt_pk_bf16_f32 v150, v132, v133
    v_cvt_pk_bf16_f32 v151, v134, v135
    v_mfma_f32_32x32x16_bf16 v[120:135], v[208:211], v[24:27], 0
    s_waitcnt vmcnt(11)
    s_add_u32 s70, s70, 8192
    s_addc_u32 s71, s71, 0
    v_exp_f32 v104, v104
    v_exp_f32 v105, v105
    v_exp_f32 v106, v106
    v_exp_f32 v107, v107
    v_mfma_f32_32x32x16_bf16 v[120:135], v[212:215], v[28:31], v[120:135]
    v_exp_f32 v108, v108
    v_exp_f32 v109, v109
    v_exp_f32 v110, v110
    v_exp_f32 v111, v111
    v_cvt_pk_bf16_f32 v136, v104, v105
    v_cvt_pk_bf16_f32 v137, v106, v107
    v_mfma_f32_32x32x16_bf16 v[40:55], v[200:203], v[144:147], v[40:55]
    global_load_lds_dwordx4 v2, s[72:73] offset:3072
    v_exp_f32 v112, v112
    v_exp_f32 v113, v113
    v_exp_f32 v114, v114
    v_exp_f32 v115, v115
    v_cvt_pk_bf16_f32 v138, v108, v109
    v_cvt_pk_bf16_f32 v139, v110, v111
    v_mfma_f32_32x32x16_bf16 v[40:55], v[204:207], v[148:151], v[40:55]
    global_load_dwordx4 v[192:195], v2, s[70:71] offset:-4096 sc1
    v_exp_f32 v116, v116
    v_exp_f32 v117, v117
    v_exp_f32 v118, v118
    v_exp_f32 v119, v119
    v_cvt_pk_bf16_f32 v140, v112, v113
    v_cvt_pk_bf16_f32 v141, v114, v115
    v_cvt_pk_bf16_f32 v142, v116, v117
    v_cvt_pk_bf16_f32 v143, v118, v119
    v_mfma_f32_32x32x16_bf16 v[104:119], v[208:211], v[32:35], 0
    v_exp_f32 v120, v120
    v_exp_f32 v121, v121
    v_exp_f32 v122, v122
    v_exp_f32 v123, v123
    v_mfma_f32_32x32x16_bf16 v[104:119], v[212:215], v[36:39], v[104:119]
    v_exp_f32 v124, v124
    v_exp_f32 v125, v125
    v_exp_f32 v126, v126
    v_exp_f32 v127, v127
    v_cvt_pk_bf16_f32 v144, v120, v121
    v_cvt_pk_bf16_f32 v145, v122, v123
    v_mfma_f32_32x32x16_bf16 v[56:71], v[216:219], v[136:139], v[56:71]
    v_exp_f32 v128, v128
    v_exp_f32 v129, v129
    v_exp_f32 v130, v130
    v_exp_f32 v131, v131
    v_cvt_pk_bf16_f32 v146, v124, v125
    v_cvt_pk_bf16_f32 v147, v126, v127
    v_mfma_f32_32x32x16_bf16 v[56:71], v[220:223], v[140:143], v[56:71]
    global_load_dwordx4 v[196:199], v2, s[70:71] offset:-3072 sc1
    v_exp_f32 v132, v132
    v_exp_f32 v133, v133
    v_exp_f32 v134, v134
    v_exp_f32 v135, v135
    v_cvt_pk_bf16_f32 v148, v128, v129
    v_cvt_pk_bf16_f32 v149, v130, v131
    v_cvt_pk_bf16_f32 v150, v132, v133
    v_cvt_pk_bf16_f32 v151, v134, v135
    v_mfma_f32_32x32x16_bf16 v[120:135], v[208:211], v[8:11], 0
    s_waitcnt vmcnt(12)
    v_exp_f32 v104, v104
    v_exp_f32 v105, v105
    v_exp_f32 v106, v106
    v_exp_f32 v107, v107
    v_mfma_f32_32x32x16_bf16 v[120:135], v[212:215], v[12:15], v[120:135]
    v_exp_f32 v108, v108
    v_exp_f32 v109, v109
    v_exp_f32 v110, v110
    v_exp_f32 v111, v111
    v_cvt_pk_bf16_f32 v136, v104, v105
    v_cvt_pk_bf16_f32 v137, v106, v107
    v_mfma_f32_32x32x16_bf16 v[72:87], v[216:219], v[144:147], v[72:87]
    s_add_u32 m0, m0, 4096
    s_add_u32 s72, s72, 4096
    s_addc_u32 s73, s73, 0
    v_exp_f32 v112, v112
    v_exp_f32 v113, v113
    v_exp_f32 v114, v114
    v_exp_f32 v115, v115
    v_cvt_pk_bf16_f32 v138, v108, v109
    v_cvt_pk_bf16_f32 v139, v110, v111
    v_mfma_f32_32x32x16_bf16 v[72:87], v[220:223], v[148:151], v[72:87]
    global_load_dwordx4 v[200:203], v2, s[70:71] offset:-2048 sc1
    v_exp_f32 v116, v116
    v_exp_f32 v117, v117
    v_exp_f32 v118, v118
    v_exp_f32 v119, v119
    v_cvt_pk_bf16_f32 v140, v112, v113
    v_cvt_pk_bf16_f32 v141, v114, v115
    v_cvt_pk_bf16_f32 v142, v116, v117
    v_cvt_pk_bf16_f32 v143, v118, v119
    v_mfma_f32_32x32x16_bf16 v[104:119], v[160:163], v[16:19], 0
    v_exp_f32 v120, v120
    v_exp_f32 v121, v121
    v_exp_f32 v122, v122
    v_exp_f32 v123, v123
    v_mfma_f32_32x32x16_bf16 v[104:119], v[164:167], v[20:23], v[104:119]
    v_exp_f32 v124, v124
    v_exp_f32 v125, v125
    v_exp_f32 v126, v126
    v_exp_f32 v127, v127
    v_cvt_pk_bf16_f32 v144, v120, v121
    v_cvt_pk_bf16_f32 v145, v122, v123
    v_mfma_f32_32x32x16_bf16 v[88:103], v[216:219], v[136:139], v[88:103]
    v_exp_f32 v128, v128
    v_exp_f32 v129, v129
    v_exp_f32 v130, v130
    v_exp_f32 v131, v131
    v_cvt_pk_bf16_f32 v146, v124, v125
    v_cvt_pk_bf16_f32 v147, v126, v127
    v_mfma_f32_32x32x16_bf16 v[88:103], v[220:223], v[140:143], v[88:103]
    global_load_dwordx4 v[204:207], v2, s[70:71] offset:-1024 sc1
    v_exp_f32 v132, v132
    v_exp_f32 v133, v133
    v_exp_f32 v134, v134
    v_exp_f32 v135, v135
    v_cvt_pk_bf16_f32 v148, v128, v129
    v_cvt_pk_bf16_f32 v149, v130, v131
    v_cvt_pk_bf16_f32 v150, v132, v133
    v_cvt_pk_bf16_f32 v151, v134, v135
    v_mfma_f32_32x32x16_bf16 v[120:135], v[160:163], v[24:27], 0
    s_waitcnt vmcnt(11)
    v_exp_f32 v104, v104
    v_exp_f32 v105, v105
    v_exp_f32 v106, v106
    v_exp_f32 v107, v107
    v_mfma_f32_32x32x16_bf16 v[120:135], v[164:167], v[28:31], v[120:135]
    v_exp_f32 v108, v108
    v_exp_f32 v109, v109
    v_exp_f32 v110, v110
    v_exp_f32 v111, v111
    v_cvt_pk_bf16_f32 v136, v104, v105
    v_cvt_pk_bf16_f32 v137, v106, v107
    v_mfma_f32_32x32x16_bf16 v[40:55], v[216:219], v[144:147], v[40:55]
    global_load_lds_dwordx4 v2, s[72:73] offset:0
    v_exp_f32 v112, v112
    v_exp_f32 v113, v113
    v_exp_f32 v114, v114
    v_exp_f32 v115, v115
    v_cvt_pk_bf16_f32 v138, v108, v109
    v_cvt_pk_bf16_f32 v139, v110, v111
    v_mfma_f32_32x32x16_bf16 v[40:55], v[220:223], v[148:151], v[40:55]
    global_load_dwordx4 v[208:211], v2, s[70:71] offset:0 sc1
    v_exp_f32 v116, v116
    v_exp_f32 v117, v117
    v_exp_f32 v118, v118
    v_exp_f32 v119, v119
    v_cvt_pk_bf16_f32 v140, v112, v113
    v_cvt_pk_bf16_f32 v141, v114, v115
    v_cvt_pk_bf16_f32 v142, v116, v117
    v_cvt_pk_bf16_f32 v143, v118, v119
    v_mfma_f32_32x32x16_bf16 v[104:119], v[160:163], v[32:35], 0
    v_exp_f32 v120, v120
    v_exp_f32 v121, v121
    v_exp_f32 v122, v122
    v_exp_f32 v123, v123
    v_mfma_f32_32x32x16_bf16 v[104:119], v[164:167], v[36:39], v[104:119]
    v_exp_f32 v124, v124
    v_exp_f32 v125, v125
    v_exp_f32 v126, v126
    v_exp_f32 v127, v127
    v_cvt_pk_bf16_f32 v144, v120, v121
    v_cvt_pk_bf16_f32 v145, v122, v123
    v_mfma_f32_32x32x16_bf16 v[56:71], v[168:171], v[136:139], v[56:71]
    v_exp_f32 v128, v128
    v_exp_f32 v129, v129
    v_exp_f32 v130, v130
    v_exp_f32 v131, v131
    v_cvt_pk_bf16_f32 v146, v124, v125
    v_cvt_pk_bf16_f32 v147, v126, v127
    v_mfma_f32_32x32x16_bf16 v[56:71], v[172:175], v[140:143], v[56:71]
    global_load_dwordx4 v[212:215], v2, s[70:71] offset:1024 sc1
    v_exp_f32 v132, v132
    v_exp_f32 v133, v133
    v_exp_f32 v134, v134
    v_exp_f32 v135, v135
    v_cvt_pk_bf16_f32 v148, v128, v129
    v_cvt_pk_bf16_f32 v149, v130, v131
    v_cvt_pk_bf16_f32 v150, v132, v133
    v_cvt_pk_bf16_f32 v151, v134, v135
    v_mfma_f32_32x32x16_bf16 v[120:135], v[160:163], v[8:11], 0
    s_waitcnt vmcnt(11)
    v_exp_f32 v104, v104
    v_exp_f32 v105, v105
    v_exp_f32 v106, v106
    v_exp_f32 v107, v107
    v_mfma_f32_32x32x16_bf16 v[120:135], v[164:167], v[12:15], v[120:135]
    v_exp_f32 v108, v108
    v_exp_f32 v109, v109
    v_exp_f32 v110, v110
    v_exp_f32 v111, v111
    v_cvt_pk_bf16_f32 v136, v104, v105
    v_cvt_pk_bf16_f32 v137, v106, v107
    v_mfma_f32_32x32x16_bf16 v[72:87], v[168:171], v[144:147], v[72:87]
    s_add_u32 m0, m0, 1024
    s_add_u32 s72, s72, 1024
    s_addc_u32 s73, s73, 0
    v_exp_f32 v112, v112
    v_exp_f32 v113, v113
    v_exp_f32 v114, v114
    v_exp_f32 v115, v115
    v_cvt_pk_bf16_f32 v138, v108, v109
    v_cvt_pk_bf16_f32 v139, v110, v111
    v_mfma_f32_32x32x16_bf16 v[72:87], v[172:175], v[148:151], v[72:87]
    global_load_dwordx4 v[216:219], v2, s[70:71] offset:2048 sc1
    v_exp_f32 v116, v116
    v_exp_f32 v117, v117
    v_exp_f32 v118, v118
    v_exp_f32 v119, v119
    v_cvt_pk_bf16_f32 v140, v112, v113
    v_cvt_pk_bf16_f32 v141, v114, v115
    v_cvt_pk_bf16_f32 v142, v116, v117
    v_cvt_pk_bf16_f32 v143, v118, v119
    v_mfma_f32_32x32x16_bf16 v[104:119], v[176:179], v[16:19], 0
    v_exp_f32 v120, v120
    v_exp_f32 v121, v121
    v_exp_f32 v122, v122
    v_exp_f32 v123, v123
    v_mfma_f32_32x32x16_bf16 v[104:119], v[180:183], v[20:23], v[104:119]
    v_exp_f32 v124, v124
    v_exp_f32 v125, v125
    v_exp_f32 v126, v126
    v_exp_f32 v127, v127
    v_cvt_pk_bf16_f32 v144, v120, v121
    v_cvt_pk_bf16_f32 v145, v122, v123
    v_mfma_f32_32x32x16_bf16 v[88:103], v[168:171], v[136:139], v[88:103]
    v_exp_f32 v128, v128
    v_exp_f32 v129, v129
    v_exp_f32 v130, v130
    v_exp_f32 v131, v131
    v_cvt_pk_bf16_f32 v146, v124, v125
    v_cvt_pk_bf16_f32 v147, v126, v127
    v_mfma_f32_32x32x16_bf16 v[88:103], v[172:175], v[140:143], v[88:103]
    global_load_dwordx4 v[220:223], v2, s[70:71] offset:3072 sc1
    v_exp_f32 v132, v132
    v_exp_f32 v133, v133
    v_exp_f32 v134, v134
    v_exp_f32 v135, v135
    v_cvt_pk_bf16_f32 v148, v128, v129
    v_cvt_pk_bf16_f32 v149, v130, v131
    v_cvt_pk_bf16_f32 v150, v132, v133
    v_cvt_pk_bf16_f32 v151, v134, v135
    v_mfma_f32_32x32x16_bf16 v[120:135], v[176:179], v[24:27], 0
    s_waitcnt vmcnt(10)
    s_add_u32 s70, s70, 8192
    s_addc_u32 s71, s71, 0
    v_exp_f32 v104, v104
    v_exp_f32 v105, v105
    v_exp_f32 v106, v106
    v_exp_f32 v107, v107
    v_mfma_f32_32x32x16_bf16 v[120:135], v[180:183], v[28:31], v[120:135]
    v_exp_f32 v108, v108
    v_exp_f32 v109, v109
    v_exp_f32 v110, v110
    v_exp_f32 v111, v111
    v_cvt_pk_bf16_f32 v136, v104, v105
    v_cvt_pk_bf16_f32 v137, v106, v107
    v_mfma_f32_32x32x16_bf16 v[40:55], v[168:171], v[144:147], v[40:55]
    v_exp_f32 v112, v112
    v_exp_f32 v113, v113
    v_exp_f32 v114, v114
    v_exp_f32 v115, v115
    v_cvt_pk_bf16_f32 v138, v108, v109
    v_cvt_pk_bf16_f32 v139, v110, v111
    v_mfma_f32_32x32x16_bf16 v[40:55], v[172:175], v[148:151], v[40:55]
    global_load_dwordx4 v[160:163], v2, s[70:71] offset:-4096 sc1
    v_exp_f32 v116, v116
    v_exp_f32 v117, v117
    v_exp_f32 v118, v118
    v_exp_f32 v119, v119
    v_cvt_pk_bf16_f32 v140, v112, v113
    v_cvt_pk_bf16_f32 v141, v114, v115
    v_cvt_pk_bf16_f32 v142, v116, v117
    v_cvt_pk_bf16_f32 v143, v118, v119
    s_sub_u32 s57, s57, 1
    s_cmp_lg_u32 s57, 0
    s_cbranch_scc1 a2_loop
    v_mfma_f32_32x32x16_bf16 v[104:119], v[176:179], v[32:35], 0
    v_exp_f32 v120, v120
    v_exp_f32 v121, v121
    v_exp_f32 v122, v122
    v_exp_f32 v123, v123
    v_mfma_f32_32x32x16_bf16 v[104:119], v[180:183], v[36:39], v[104:119]
    v_exp_f32 v124, v124
    v_exp_f32 v125, v125
    v_exp_f32 v126, v126
    v_exp_f32 v127, v127
    v_cvt_pk_bf16_f32 v144, v120, v121
    v_cvt_pk_bf16_f32 v145, v122, v123
    v_mfma_f32_32x32x16_bf16 v[56:71], v[184:187], v[136:139], v[56:71]
    global_load_dwordx4 a[224:227], v2, s[74:75] offset:0
    v_exp_f32 v128, v128
    v_exp_f32 v129, v129
    v_exp_f32 v130, v130
    v_exp_f32 v131, v131
    v_cvt_pk_bf16_f32 v146, v124, v125
    v_cvt_pk_bf16_f32 v147, v126, v127
    v_mfma_f32_32x32x16_bf16 v[56:71], v[188:191], v[140:143], v[56:71]
    v_exp_f32 v132, v132
    v_exp_f32 v133, v133
    v_exp_f32 v134, v134
    v_exp_f32 v135, v135
    v_cvt_pk_bf16_f32 v148, v128, v129
    v_cvt_pk_bf16_f32 v149, v130, v131
    v_cvt_pk_bf16_f32 v150, v132, v133
    v_cvt_pk_bf16_f32 v151, v134, v135
    v_mfma_f32_32x32x16_bf16 v[120:135], v[176:179], v[8:11], 0
    s_waitcnt vmcnt(9)
    v_exp_f32 v104, v104
    v_exp_f32 v105, v105
    v_exp_f32 v106, v106
    v_exp_f32 v107, v107
    v_mfma_f32_32x32x16_bf16 v[120:135], v[180:183], v[12:15], v[120:135]
    v_exp_f32 v108, v108
    v_exp_f32 v109, v109
    v_exp_f32 v110, v110
    v_exp_f32 v111, v111
    v_cvt_pk_bf16_f32 v136, v104, v105
    v_cvt_pk_bf16_f32 v137, v106, v107
    v_mfma_f32_32x32x16_bf16 v[72:87], v[184:187], v[144:147], v[72:87]
    global_load_dwordx4 a[228:231], v2, s[74:75] offset:1024
    v_exp_f32 v112, v112
    v_exp_f32 v113, v113
    v_exp_f32 v114, v114
    v_exp_f32 v115, v115
    v_cvt_pk_bf16_f32 v138, v108, v109
    v_cvt_pk_bf16_f32 v139, v110, v111
    v_mfma_f32_32x32x16_bf16 v[72:87], v[188:191], v[148:151], v[72:87]
    v_exp_f32 v116, v116
    v_exp_f32 v117, v117
    v_exp_f32 v118, v118
    v_exp_f32 v119, v119
    v_cvt_pk_bf16_f32 v140, v112, v113
    v_cvt_pk_bf16_f32 v141, v114, v115
    v_cvt_pk_bf16_f32 v142, v116, v117
    v_cvt_pk_bf16_f32 v143, v118, v119
    v_mfma_f32_32x32x16_bf16 v[104:119], v[192:195], v[16:19], 0
    v_exp_f32 v120, v120
    v_exp_f32 v121, v121
    v_exp_f32 v122, v122
    v_exp_f32 v123, v123
    v_mfma_f32_32x32x16_bf16 v[104:119], v[196:199], v[20:23], v[104:119]
    v_exp_f32 v124, v124
    v_exp_f32 v125, v125
    v_exp_f32 v126, v126
    v_exp_f32 v127, v127
    v_cvt_pk_bf16_f32 v144, v120, v121
    v_cvt_pk_bf16_f32 v145, v122, v123
    v_mfma_f32_32x32x16_bf16 v[88:103], v[184:187], v[136:139], v[88:103]
    global_load_dwordx4 a[232:235], v2, s[74:75] offset:2048
    v_exp_f32 v128, v128
    v_exp_f32 v129, v129
    v_exp_f32 v130, v130
    v_exp_f32 v131, v131
    v_cvt_pk_bf16_f32 v146, v124, v125
    v_cvt_pk_bf16_f32 v147, v126, v127
    v_mfma_f32_32x32x16_bf16 v[88:103], v[188:191], v[140:143], v[88:103]
    v_exp_f32 v132, v132
    v_exp_f32 v133, v133
    v_exp_f32 v134, v134
    v_exp_f32 v135, v135
    v_cvt_pk_bf16_f32 v148, v128, v129
    v_cvt_pk_bf16_f32 v149, v130, v131
    v_cvt_pk_bf16_f32 v150, v132, v133
    v_cvt_pk_bf16_f32 v151, v134, v135
    v_mfma_f32_32x32x16_bf16 v[120:135], v[192:195], v[24:27], 0
    s_waitcnt vmcnt(9)
    v_exp_f32 v104, v104
    v_exp_f32 v105, v105
    v_exp_f32 v106, v106
    v_exp_f32 v107, v107
    v_mfma_f32_32x32x16_bf16 v[120:135], v[196:199], v[28:31], v[120:135]
    v_exp_f32 v108, v108
    v_exp_f32 v109, v109
    v_exp_f32 v110, v110
    v_exp_f32 v111, v111
    v_cvt_pk_bf16_f32 v136, v104, v105
    v_cvt_pk_bf16_f32 v137, v106, v107
    v_mfma_f32_32x32x16_bf16 v[40:55], v[184:187], v[144:147], v[40:55]
    global_load_dwordx4 a[236:239], v2, s[74:75] offset:3072
    v_exp_f32 v112, v112
    v_exp_f32 v113, v113
    v_exp_f32 v114, v114
    v_exp_f32 v115, v115
    v_cvt_pk_bf16_f32 v138, v108, v109
    v_cvt_pk_bf16_f32 v139, v110, v111
    v_mfma_f32_32x32x16_bf16 v[40:55], v[188:191], v[148:151], v[40:55]
    v_exp_f32 v116, v116
    v_exp_f32 v117, v117
    v_exp_f32 v118, v118
    v_exp_f32 v119, v119
    v_cvt_pk_bf16_f32 v140, v112, v113
    v_cvt_pk_bf16_f32 v141, v114, v115
    v_cvt_pk_bf16_f32 v142, v116, v117
    v_cvt_pk_bf16_f32 v143, v118, v119
    v_mfma_f32_32x32x16_bf16 v[104:119], v[192:195], v[32:35], 0
    v_exp_f32 v120, v120
    v_exp_f32 v121, v121
    v_exp_f32 v122, v122
    v_exp_f32 v123, v123
    v_mfma_f32_32x32x16_bf16 v[104:119], v[196:199], v[36:39], v[104:119]
    v_exp_f32 v124, v124
    v_exp_f32 v125, v125
    v_exp_f32 v126, v126
    v_exp_f32 v127, v127
    v_cvt_pk_bf16_f32 v144, v120, v121
    v_cvt_pk_bf16_f32 v145, v122, v123
    v_mfma_f32_32x32x16_bf16 v[56:71], v[200:203], v[136:139], v[56:71]
    global_load_dword v246, v244, s[80:81] sc1
    v_exp_f32 v128, v128
    v_exp_f32 v129, v129
    v_exp_f32 v130, v130
    v_exp_f32 v131, v131
    v_cvt_pk_bf16_f32 v146, v124, v125
    v_cvt_pk_bf16_f32 v147, v126, v127
    v_mfma_f32_32x32x16_bf16 v[56:71], v[204:207], v[140:143], v[56:71]
    v_exp_f32 v132, v132
    v_exp_f32 v133, v133
    v_exp_f32 v134, v134
    v_exp_f32 v135, v135
    v_cvt_pk_bf16_f32 v148, v128, v129
    v_cvt_pk_bf16_f32 v149, v130, v131
    v_cvt_pk_bf16_f32 v150, v132, v133
    v_cvt_pk_bf16_f32 v151, v134, v135
    v_mfma_f32_32x32x16_bf16 v[120:135], v[192:195], v[8:11], 0
    s_waitcnt vmcnt(8)
    v_exp_f32 v104, v104
    v_exp_f32 v105, v105
    v_exp_f32 v106, v106
    v_exp_f32 v107, v107
    v_mfma_f32_32x32x16_bf16 v[120:135], v[196:199], v[12:15], v[120:135]
    v_exp_f32 v108, v108
    v_exp_f32 v109, v109
    v_exp_f32 v110, v110
    v_exp_f32 v111, v111
    v_cvt_pk_bf16_f32 v136, v104, v105
    v_cvt_pk_bf16_f32 v137, v106, v107
    v_mfma_f32_32x32x16_bf16 v[72:87], v[200:203], v[144:147], v[72:87]
    v_exp_f32 v112, v112
    v_exp_f32 v113, v113
    v_exp_f32 v114, v114
    v_exp_f32 v115, v115
    v_cvt_pk_bf16_f32 v138, v108, v109
    v_cvt_pk_bf16_f32 v139, v110, v111
    v_mfma_f32_32x32x16_bf16 v[72:87], v[204:207], v[148:151], v[72:87]
    v_exp_f32 v116, v116
    v_exp_f32 v117, v117
    v_exp_f32 v118, v118
    v_exp_f32 v119, v119
    v_cvt_pk_bf16_f32 v140, v112, v113
    v_cvt_pk_bf16_f32 v141, v114, v115
    v_cvt_pk_bf16_f32 v142, v116, v117
    v_cvt_pk_bf16_f32 v143, v118, v119
    v_mfma_f32_32x32x16_bf16 v[104:119], v[208:211], v[16:19], 0
    v_exp_f32 v120, v120
    v_exp_f32 v121, v121
    v_exp_f32 v122, v122
    v_exp_f32 v123, v123
    v_mfma_f32_32x32x16_bf16 v[104:119], v[212:215], v[20:23], v[104:119]
    v_exp_f32 v124, v124
    v_exp_f32 v125, v125
    v_exp_f32 v126, v126
    v_exp_f32 v127, v127
    v_cvt_pk_bf16_f32 v144, v120, v121
    v_cvt_pk_bf16_f32 v145, v122, v123
    v_mfma_f32_32x32x16_bf16 v[88:103], v[200:203], v[136:139], v[88:103]
    v_exp_f32 v128, v128
    v_exp_f32 v129, v129
    v_exp_f32 v130, v130
    v_exp_f32 v131, v131
    v_cvt_pk_bf16_f32 v146, v124, v125
    v_cvt_pk_bf16_f32 v147, v126, v127
    v_mfma_f32_32x32x16_bf16 v[88:103], v[204:207], v[140:143], v[88:103]
    v_exp_f32 v132, v132
    v_exp_f32 v133, v133
    v_exp_f32 v134, v134
    v_exp_f32 v135, v135
    v_cvt_pk_bf16_f32 v148, v128, v129
    v_cvt_pk_bf16_f32 v149, v130, v131
    v_cvt_pk_bf16_f32 v150, v132, v133
    v_cvt_pk_bf16_f32 v151, v134, v135
    v_mfma_f32_32x32x16_bf16 v[120:135], v[208:211], v[24:27], 0
    s_waitcnt vmcnt(6)
    v_exp_f32 v104, v104
    v_exp_f32 v105, v105
    v_exp_f32 v106, v106
    v_exp_f32 v107, v107
    v_mfma_f32_32x32x16_bf16 v[120:135], v[212:215], v[28:31], v[120:135]
    v_exp_f32 v108, v108
    v_exp_f32 v109, v109
    v_exp_f32 v110, v110
    v_exp_f32 v111, v111
    v_cvt_pk_bf16_f32 v136, v104, v105
    v_cvt_pk_bf16_f32 v137, v106, v107
    v_mfma_f32_32x32x16_bf16 v[40:55], v[200:203], v[144:147], v[40:55]
    v_exp_f32 v112, v112
    v_exp_f32 v113, v113
    v_exp_f32 v114, v114
    v_exp_f32 v115, v115
    v_cvt_pk_bf16_f32 v138, v108, v109
    v_cvt_pk_bf16_f32 v139, v110, v111
    v_mfma_f32_32x32x16_bf16 v[40:55], v[204:207], v[148:151], v[40:55]
    v_exp_f32 v116, v116
    v_exp_f32 v117, v117
    v_exp_f32 v118, v118
    v_exp_f32 v119, v119
    v_cvt_pk_bf16_f32 v140, v112, v113
    v_cvt_pk_bf16_f32 v141, v114, v115
    v_cvt_pk_bf16_f32 v142, v116, v117
    v_cvt_pk_bf16_f32 v143, v118, v119
    v_mfma_f32_32x32x16_bf16 v[104:119], v[208:211], v[32:35], 0
    v_exp_f32 v120, v120
    v_exp_f32 v121, v121
    v_exp_f32 v122, v122
    v_exp_f32 v123, v123
    v_mfma_f32_32x32x16_bf16 v[104:119], v[212:215], v[36:39], v[104:119]
    v_exp_f32 v124, v124
    v_exp_f32 v125, v125
    v_exp_f32 v126, v126
    v_exp_f32 v127, v127
    v_cvt_pk_bf16_f32 v144, v120, v121
    v_cvt_pk_bf16_f32 v145, v122, v123
    v_mfma_f32_32x32x16_bf16 v[56:71], v[216:219], v[136:139], v[56:71]
    v_exp_f32 v128, v128
    v_exp_f32 v129, v129
    v_exp_f32 v130, v130
    v_exp_f32 v131, v131
    v_cvt_pk_bf16_f32 v146, v124, v125
    v_cvt_pk_bf16_f32 v147, v126, v127
    v_mfma_f32_32x32x16_bf16 v[56:71], v[220:223], v[140:143], v[56:71]
    v_exp_f32 v132, v132
    v_exp_f32 v133, v133
    v_exp_f32 v134, v134
    v_exp_f32 v135, v135
    v_cvt_pk_bf16_f32 v148, v128, v129
    v_cvt_pk_bf16_f32 v149, v130, v131
    v_cvt_pk_bf16_f32 v150, v132, v133
    v_cvt_pk_bf16_f32 v151, v134, v135
    v_mfma_f32_32x32x16_bf16 v[120:135], v[208:211], v[8:11], 0
    v_exp_f32 v104, v104
    v_exp_f32 v105, v105
    v_exp_f32 v106, v106
    v_exp_f32 v107, v107
    v_mfma_f32_32x32x16_bf16 v[120:135], v[212:215], v[12:15], v[120:135]
    v_exp_f32 v108, v108
    v_exp_f32 v109, v109
    v_exp_f32 v110, v110
    v_exp_f32 v111, v111
    v_cvt_pk_bf16_f32 v136, v104, v105
    v_cvt_pk_bf16_f32 v137, v106, v107
    v_mfma_f32_32x32x16_bf16 v[72:87], v[216:219], v[144:147], v[72:87]
    ds_write_b128 v241, v[56:59] offset:0
    ds_write_b128 v241, v[60:63] offset:1024
    v_exp_f32 v112, v112
    v_exp_f32 v113, v113
    v_exp_f32 v114, v114
    v_exp_f32 v115, v115
    v_cvt_pk_bf16_f32 v138, v108, v109
    v_cvt_pk_bf16_f32 v139, v110, v111
    v_mfma_f32_32x32x16_bf16 v[72:87], v[220:223], v[148:151], v[72:87]
    ds_write_b128 v241, v[64:67] offset:2048
    ds_write_b128 v241, v[68:71] offset:3072
    v_exp_f32 v116, v116
    v_exp_f32 v117, v117
    v_exp_f32 v118, v118
    v_exp_f32 v119, v119
    v_cvt_pk_bf16_f32 v140, v112, v113
    v_cvt_pk_bf16_f32 v141, v114, v115
    v_cvt_pk_bf16_f32 v142, v116, v117
    v_cvt_pk_bf16_f32 v143, v118, v119
    v_exp_f32 v120, v120
    v_exp_f32 v121, v121
    v_exp_f32 v122, v122
    v_exp_f32 v123, v123
    v_exp_f32 v124, v124
    v_exp_f32 v125, v125
    v_exp_f32 v126, v126
    v_exp_f32 v127, v127
    v_cvt_pk_bf16_f32 v144, v120, v121
    v_cvt_pk_bf16_f32 v145, v122, v123
    v_mfma_f32_32x32x16_bf16 v[88:103], v[216:219], v[136:139], v[88:103]
    ds_write_b128 v242, v[72:75] offset:4096
    ds_write_b128 v242, v[76:79] offset:5120
    v_exp_f32 v128, v128
    v_exp_f32 v129, v129
    v_exp_f32 v130, v130
    v_exp_f32 v131, v131
    v_cvt_pk_bf16_f32 v146, v124, v125
    v_cvt_pk_bf16_f32 v147, v126, v127
    v_mfma_f32_32x32x16_bf16 v[88:103], v[220:223], v[140:143], v[88:103]
    ds_write_b128 v242, v[80:83] offset:6144
    ds_write_b128 v242, v[84:87] offset:7168
    v_exp_f32 v132, v132
    v_exp_f32 v133, v133
    v_exp_f32 v134, v134
    v_exp_f32 v135, v135
    v_cvt_pk_bf16_f32 v148, v128, v129
    v_cvt_pk_bf16_f32 v149, v130, v131
    v_cvt_pk_bf16_f32 v150, v132, v133
    v_cvt_pk_bf16_f32 v151, v134, v135
    v_mfma_f32_32x32x16_bf16 v[40:55], v[216:219], v[144:147], v[40:55]
    s_nop 0
    v_mfma_f32_32x32x16_bf16 v[40:55], v[220:223], v[148:151], v[40:55]
    ds_write_b128 v243, v[88:91] offset:8192
    ds_write_b128 v243, v[92:95] offset:9216
    ds_write_b128 v243, v[96:99] offset:10240
    ds_write_b128 v243, v[100:103] offset:11264
    s_branch x_common
x_fin:
    s_endpgm
x_end:
    s_endpgm
attn_slow:
    s_mov_b32 s64, 1
    s_waitcnt vmcnt(0)
    s_mov_b64 exec, s[62:63]
    v_mov_b32 v14, 0
    v_mov_b32 v15, 0
    s_mov_b64 exec, -1
    v_mov_b32 v232, 0xff800000
    s_mov_b32 s58, s45
    s_mov_b32 s57, 64
attn_slow1:
    buffer_load_dwordx4 v[160:163], v2, s[4:7], s58 offen sc1
    buffer_load_dwordx4 v[164:167], v2, s[4:7], s58 offen offset:1024 sc1
    s_add_u32 s58, s58, 4096
    s_waitcnt vmcnt(1)
    v_mfma_f32_32x32x16_bf16 v[104:119], v[160:163], v[8:11], 0
    s_waitcnt vmcnt(0)
    v_mfma_f32_32x32x16_bf16 v[104:119], v[164:167], v[12:15], v[104:119]
    s_nop 11
    v_max3_f32 v224, v104, v105, v106
    v_max3_f32 v225, v107, v108, v109
    v_max3_f32 v224, v224, v110, v111
    v_max3_f32 v225, v225, v112, v113
    v_max3_f32 v224, v224, v114, v115
    v_max3_f32 v225, v225, v116, v117
    v_max3_f32 v224, v224, v118, v119
    v_max_f32 v224, v224, v225
    v_max_f32 v232, v232, v224
    s_sub_u32 s57, s57, 1
    s_cmp_lg_u32 s57, 0
    s_cbranch_scc1 attn_slow1
    v_mov_b32 v225, v232
    s_nop 1
    v_permlane32_swap_b32 v232, v225
    s_mov_b64 exec, s[62:63]
    v_min_f32 v232, -v232, -v225
    v_and_b32 v225, s60, v232
    v_sub_f32 v232, v232, v225
    v_and_b32 v226, s60, v232
    v_sub_f32 v232, v232, v226
    v_perm_b32 v14, v226, v225, s61
    v_lshrrev_b32 v15, 16, v232
    s_mov_b64 exec, -1
    v_mov_b32 v40, 0
    v_mov_b32 v41, 0
    v_mov_b32 v42, 0
    v_mov_b32 v43, 0
    v_mov_b32 v44, 0
    v_mov_b32 v45, 0
    v_mov_b32 v46, 0
    v_mov_b32 v47, 0
    v_mov_b32 v48, 0
    v_mov_b32 v49, 0
    v_mov_b32 v50, 0
    v_mov_b32 v51, 0
    v_mov_b32 v52, 0
    v_mov_b32 v53, 0
    v_mov_b32 v54, 0
    v_mov_b32 v55, 0
    s_mov_b32 s58, s45
    s_mov_b32 s57, 64
attn_slow2:
    buffer_load_dwordx4 v[160:163], v2, s[4:7], s58 offen offset:0 sc1
    buffer_load_dwordx4 v[164:167], v2, s[4:7], s58 offen offset:1024 sc1
    buffer_load_dwordx4 v[168:171], v2, s[4:7], s58 offen offset:2048 sc1
    buffer_load_dwordx4 v[172:175], v2, s[4:7], s58 offen offset:3072 sc1
    s_add_u32 s58, s58, 4096
    s_waitcnt vmcnt(3)
    v_mfma_f32_32x32x16_bf16 v[104:119], v[160:163], v[8:11], 0
    s_waitcnt vmcnt(2)
    v_mfma_f32_32x32x16_bf16 v[104:119], v[164:167], v[12:15], v[104:119]
    s_nop 11
    v_exp_f32 v104, v104
    v_exp_f32 v105, v105
    v_exp_f32 v106, v106
    v_exp_f32 v107, v107
    v_exp_f32 v108, v108
    v_exp_f32 v109, v109
    v_exp_f32 v110, v110
    v_exp_f32 v111, v111
    v_exp_f32 v112, v112
    v_exp_f32 v113, v113
    v_exp_f32 v114, v114
    v_exp_f32 v115, v115
    v_exp_f32 v116, v116
    v_exp_f32 v117, v117
    v_exp_f32 v118, v118
    v_exp_f32 v119, v119
    v_cvt_pk_bf16_f32 v136, v104, v105
    v_cvt_pk_bf16_f32 v137, v106, v107
    v_cvt_pk_bf16_f32 v138, v108, v109
    v_cvt_pk_bf16_f32 v139, v110, v111
    v_cvt_pk_bf16_f32 v140, v112, v113
    v_cvt_pk_bf16_f32 v141, v114, v115
    v_cvt_pk_bf16_f32 v142, v116, v117
    v_cvt_pk_bf16_f32 v143, v118, v119
    s_waitcnt vmcnt(1)
    v_mfma_f32_32x32x16_bf16 v[40:55], v[168:171], v[136:139], v[40:55]
    s_waitcnt vmcnt(0)
    v_mfma_f32_32x32x16_bf16 v[40:55], v[172:175], v[140:143], v[40:55]
    s_sub_u32 s57, s57, 1
    s_cmp_lg_u32 s57, 0
    s_cbranch_scc1 attn_slow2
    s_nop 8
    v_mov_b32 v226, v52
    v_mov_b32 v227, v52
    s_nop 1
    v_permlane32_swap_b32 v226, v227
    s_branch attn_fin
.p2align 10
x_code_end:
    s_endpgm

.section .rodata,"a"
.p2align 6
.amdhsa_kernel qkv1_kernel
  .amdhsa_next_free_vgpr 256
  .amdhsa_next_free_sgpr 102
  .amdhsa_accum_offset 256
  .amdhsa_group_segment_fixed_size 0
  .amdhsa_kernarg_size 104
  .amdhsa_user_sgpr_count 2
  .amdhsa_user_sgpr_kernarg_segment_ptr 1
  .amdhsa_system_sgpr_workgroup_id_x 1
.end_amdhsa_kernel
.p2align 6
.amdhsa_kernel x_kernel
  .amdhsa_next_free_vgpr 512
  .amdhsa_next_free_sgpr 102
  .amdhsa_accum_offset 256
  .amdhsa_group_segment_fixed_size 0
  .amdhsa_kernarg_size 104
  .amdhsa_user_sgpr_count 2
  .amdhsa_user_sgpr_kernarg_segment_ptr 1
  .amdhsa_system_sgpr_workgroup_id_x 1
.end_amdhsa_kernel
```
